```python
import torch

def _softmax(x, axis=-1):
    return torch.softmax(x, dim=axis)
def _gelu(x):
    return torch.nn.functional.gelu(x, approximate="tanh")
def _silu(x):
    return torch.nn.functional.silu(x)
def _sigmoid(x):
    return torch.sigmoid(x)
def _layernorm(x, axis=-1, eps=1e-5):
    m = x.mean(dim=axis, keepdim=True)
    v = x.var(dim=axis, keepdim=True, unbiased=False)
    return (x - m) / torch.sqrt(v + eps)
def _scatter_add(tgt, idx, src, axis=0):
    return tgt.clone().index_add_(axis, idx, src)
def _segment_sum(src, seg, n):
    out = torch.zeros((n,) + src.shape[1:], dtype=src.dtype)
    return out.index_add_(0, seg, src)
def _pad(x, pw):
    flat = tuple(v for pair in reversed(pw) for v in pair)
    return torch.nn.functional.pad(x, flat)

kernel_name = 'interleave_layers__grouped_kv_mqa__glu_gated_geglu__prompt'

def setup_inputs():

    _w = (lambda a: (lambda t: t.to(torch.bfloat16) if t.is_floating_point() else t)(torch.as_tensor(a)))
    def _A_setup():
        B, S, D, H = 1, 2048, 640, 32
        Dh = D // H
        return {
            "x": _w((lambda *s: torch.randn(*s, dtype=torch.bfloat16) * 0.05)(B, S, D)),
            "wq": _w((lambda *s: torch.randn(*s, dtype=torch.bfloat16) * 0.05)(D, H * Dh)),
            "wk": _w((lambda *s: torch.randn(*s, dtype=torch.bfloat16) * 0.05)(D, Dh)),
            "wv": _w((lambda *s: torch.randn(*s, dtype=torch.bfloat16) * 0.05)(D, Dh)),
            "wo": _w((lambda *s: torch.randn(*s, dtype=torch.bfloat16) * 0.05)(H * Dh, D)),
        }
    _A_in = _A_setup()

    def _B_setup():
        B, S, Dm, Df = 1, 2048, 640, 1728
        return {
            "x": _w((lambda *s: torch.randn(*s, dtype=torch.bfloat16) * 0.05)(B, S, Dm)),
            "w_gate": _w((lambda *s: torch.randn(*s, dtype=torch.bfloat16) * 0.8)(Dm, Df) * (Dm ** -0.5)),
            "w_up": _w((lambda *s: torch.randn(*s, dtype=torch.bfloat16) * 0.8)(Dm, Df) * (Dm ** -0.5)),
            "w_down": _w((lambda *s: torch.randn(*s, dtype=torch.bfloat16) * 0.8)(Df, Dm) * (Df ** -0.5)),
        }
    _B_in = _B_setup()

    return {
        "A_x": _A_in["x"],
        "A_wq": _A_in["wq"],
        "A_wk": _A_in["wk"],
        "A_wv": _A_in["wv"],
        "A_wo": _A_in["wo"],
        "B_x": _B_in["x"],
        "B_w_gate": _B_in["w_gate"],
        "B_w_up": _B_in["w_up"],
        "B_w_down": _B_in["w_down"],
    }

def reference(A_x, A_wq, A_wk, A_wv, A_wo, B_x, B_w_gate, B_w_up, B_w_down):
    def _A_ref(x, wq, wk, wv, wo):
        B, S, D = x.shape
        H = 32
        Dh = D // H
        q = (lambda x, *d: x.permute(*d))((x @ wq).reshape(B, S, H, Dh), 0, 2, 1, 3)
        k = x @ wk
        v = x @ wv
        scores = torch.einsum("bhqd,bkd->bhqk", q, k) * (Dh ** -0.5)
        p = _softmax(scores, axis=-1)
        o = torch.einsum("bhqk,bkd->bhqd", p, v)
        return (lambda x, *d: x.permute(*d))(o, 0, 2, 1, 3).reshape(B, S, H * Dh) @ wo

    def _B_ref(x, w_gate, w_up, w_down):
        g = torch.einsum("bsd,df->bsf", x, w_gate)
        u = torch.einsum("bsd,df->bsf", x, w_up)
        h = _gelu(g) * u
        return torch.einsum("bsf,fd->bsd", h, w_down)

    x = A_x
    x = x + _A_ref(_layernorm(x, axis=-1), A_wq, A_wk, A_wv, A_wo)
    x = x + _B_ref(_layernorm(x, axis=-1), B_w_gate, B_w_up, B_w_down)
    x = x + _A_ref(_layernorm(x, axis=-1), A_wq, A_wk, A_wv, A_wo)
    x = x + _B_ref(_layernorm(x, axis=-1), B_w_gate, B_w_up, B_w_down)
    return x
```

```asm
; @launch kernel=prep_kernel grid=(204,1,1) block=(256,1,1) lds=8192
; @launch kernel=qkv1_kernel grid=(192,1,1) block=(256,1,1) lds=73728
; @launch kernel=attn1_kernel grid=(1024,1,1) block=(256,1,1) lds=26624
; @launch kernel=wo1_kernel grid=(160,1,1) block=(256,1,1) lds=73728
; @launch kernel=gu1_kernel grid=(432,1,1) block=(256,1,1) lds=65536
; @launch kernel=dn1_kernel grid=(160,1,1) block=(256,1,1) lds=122880
; @launch kernel=qkv2_kernel grid=(192,1,1) block=(256,1,1) lds=73728
; @launch kernel=attn2_kernel grid=(1024,1,1) block=(256,1,1) lds=26624
; @launch kernel=wo2_kernel grid=(160,1,1) block=(256,1,1) lds=73728
; @launch kernel=gu2_kernel grid=(432,1,1) block=(256,1,1) lds=65536
; @launch kernel=dn2_kernel grid=(160,1,1) block=(256,1,1) lds=122880
.amdgcn_target "amdgcn-amd-amdhsa--gfx950"
.text
.globl prep_kernel
.p2align 8
.type prep_kernel,@function
prep_kernel:
    s_cmp_ge_u32 s2, 204
    s_cbranch_scc1 L_prep_kernel_end
    s_load_dwordx2 s[4:5], s[0:1], 0
    s_load_dwordx2 s[6:7], s[0:1], 88
    s_load_dwordx2 s[16:17], s[0:1], 16
    s_load_dwordx2 s[18:19], s[0:1], 24
    s_load_dwordx2 s[40:41], s[0:1], 8
    s_load_dwordx2 s[42:43], s[0:1], 48
    s_load_dwordx2 s[44:45], s[0:1], 56
    s_waitcnt lgkmcnt(0)
    s_cmp_ge_u32 s2, 128
    s_cbranch_scc1 L_prep_kernel_notA
    s_mov_b32 s8, s4
    s_mov_b32 s9, s5
    s_mov_b32 s10, 0x280000
    s_mov_b32 s11, 0x20000
    s_add_u32 s12, s6, 0x1628000
    s_addc_u32 s13, s7, 0
    s_mov_b32 s14, 0x50000
    s_mov_b32 s15, 0x20000
    v_lshrrev_b32 v1, 4, v0
    s_lshl_b32 s3, s2, 4
    v_add_u32 v1, s3, v1
    v_mul_u32_u24 v2, 0x500, v1
    v_and_b32 v5, 15, v0
    v_lshl_add_u32 v2, v5, 4, v2
    buffer_load_dwordx4 v[8:11], v2, s[8:11], 0 offen offset:0
    buffer_load_dwordx4 v[12:15], v2, s[8:11], 0 offen offset:256
    buffer_load_dwordx4 v[16:19], v2, s[8:11], 0 offen offset:512
    buffer_load_dwordx4 v[20:23], v2, s[8:11], 0 offen offset:768
    buffer_load_dwordx4 v[24:27], v2, s[8:11], 0 offen offset:1024
    v_mov_b32 v6, 0x3f803f80
    v_mov_b32 v3, 0
    v_mov_b32 v4, 0
    s_waitcnt vmcnt(0)
    v_dot2c_f32_bf16 v3, v8, v6
    v_dot2c_f32_bf16 v4, v8, v8
    v_dot2c_f32_bf16 v3, v9, v6
    v_dot2c_f32_bf16 v4, v9, v9
    v_dot2c_f32_bf16 v3, v10, v6
    v_dot2c_f32_bf16 v4, v10, v10
    v_dot2c_f32_bf16 v3, v11, v6
    v_dot2c_f32_bf16 v4, v11, v11
    v_dot2c_f32_bf16 v3, v12, v6
    v_dot2c_f32_bf16 v4, v12, v12
    v_dot2c_f32_bf16 v3, v13, v6
    v_dot2c_f32_bf16 v4, v13, v13
    v_dot2c_f32_bf16 v3, v14, v6
    v_dot2c_f32_bf16 v4, v14, v14
    v_dot2c_f32_bf16 v3, v15, v6
    v_dot2c_f32_bf16 v4, v15, v15
    v_dot2c_f32_bf16 v3, v16, v6
    v_dot2c_f32_bf16 v4, v16, v16
    v_dot2c_f32_bf16 v3, v17, v6
    v_dot2c_f32_bf16 v4, v17, v17
    v_dot2c_f32_bf16 v3, v18, v6
    v_dot2c_f32_bf16 v4, v18, v18
    v_dot2c_f32_bf16 v3, v19, v6
    v_dot2c_f32_bf16 v4, v19, v19
    v_dot2c_f32_bf16 v3, v20, v6
    v_dot2c_f32_bf16 v4, v20, v20
    v_dot2c_f32_bf16 v3, v21, v6
    v_dot2c_f32_bf16 v4, v21, v21
    v_dot2c_f32_bf16 v3, v22, v6
    v_dot2c_f32_bf16 v4, v22, v22
    v_dot2c_f32_bf16 v3, v23, v6
    v_dot2c_f32_bf16 v4, v23, v23
    v_dot2c_f32_bf16 v3, v24, v6
    v_dot2c_f32_bf16 v4, v24, v24
    v_dot2c_f32_bf16 v3, v25, v6
    v_dot2c_f32_bf16 v4, v25, v25
    v_dot2c_f32_bf16 v3, v26, v6
    v_dot2c_f32_bf16 v4, v26, v26
    v_dot2c_f32_bf16 v3, v27, v6
    v_dot2c_f32_bf16 v4, v27, v27
    s_nop 1
    v_add_f32_dpp v2, v3, v3 row_ror:8 row_mask:0xf bank_mask:0xf
    v_mov_b32 v3, v2
    s_nop 1
    v_add_f32_dpp v2, v3, v3 row_ror:4 row_mask:0xf bank_mask:0xf
    v_mov_b32 v3, v2
    s_nop 1
    v_add_f32_dpp v2, v3, v3 row_ror:2 row_mask:0xf bank_mask:0xf
    v_mov_b32 v3, v2
    s_nop 1
    v_add_f32_dpp v2, v3, v3 row_ror:1 row_mask:0xf bank_mask:0xf
    v_mov_b32 v3, v2
    v_add_f32_dpp v2, v4, v4 row_ror:8 row_mask:0xf bank_mask:0xf
    v_mov_b32 v4, v2
    s_nop 1
    v_add_f32_dpp v2, v4, v4 row_ror:4 row_mask:0xf bank_mask:0xf
    v_mov_b32 v4, v2
    s_nop 1
    v_add_f32_dpp v2, v4, v4 row_ror:2 row_mask:0xf bank_mask:0xf
    v_mov_b32 v4, v2
    s_nop 1
    v_add_f32_dpp v2, v4, v4 row_ror:1 row_mask:0xf bank_mask:0xf
    v_mov_b32 v4, v2
    v_cmp_eq_u32 vcc, 0, v5
    s_nop 1
    v_cndmask_b32 v28, 0, v3, vcc
    v_cndmask_b32 v29, 0, v4, vcc
    v_mov_b32 v30, 0
    v_mov_b32 v31, 0
    v_mul_u32_u24 v2, 160, v1
    v_lshl_add_u32 v2, v5, 4, v2
    v_cmp_gt_u32 vcc, 10, v5
    v_mov_b32 v3, 0x7fffffff
    s_nop 0
    v_cndmask_b32 v2, v3, v2, vcc
    buffer_store_dwordx4 v[28:31], v2, s[12:15], 0 offen
    s_endpgm
L_prep_kernel_notA:
    s_cmp_ge_u32 s2, 138
    s_cbranch_scc1 L_prep_kernel_notB
    s_mov_b32 s8, s16
    s_mov_b32 s9, s17
    s_mov_b32 s10, 0x6400
    s_mov_b32 s11, 0x20000
    s_mov_b32 s12, s18
    s_mov_b32 s13, s19
    s_mov_b32 s14, 0x6400
    s_mov_b32 s15, 0x20000
    s_add_u32 s24, s6, 0x540000
    s_addc_u32 s25, s7, 0
    s_mov_b32 s26, 0x28000
    s_mov_b32 s27, 0x20000
    s_sub_u32 s3, s2, 128
    s_lshl_b32 s3, s3, 6
    v_lshrrev_b32 v1, 2, v0
    v_add_u32 v1, s3, v1
    v_and_b32 v2, 3, v0
    v_mul_u32_u24 v3, 40, v1
    buffer_load_dwordx2 v[4:5], v3, s[8:11], 0 offen offset:0
    buffer_load_dwordx2 v[14:15], v3, s[12:15], 0 offen offset:0
    buffer_load_dwordx2 v[6:7], v3, s[8:11], 0 offen offset:8
    buffer_load_dwordx2 v[16:17], v3, s[12:15], 0 offen offset:8
    buffer_load_dwordx2 v[8:9], v3, s[8:11], 0 offen offset:16
    buffer_load_dwordx2 v[18:19], v3, s[12:15], 0 offen offset:16
    buffer_load_dwordx2 v[10:11], v3, s[8:11], 0 offen offset:24
    buffer_load_dwordx2 v[20:21], v3, s[12:15], 0 offen offset:24
    buffer_load_dwordx2 v[12:13], v3, s[8:11], 0 offen offset:32
    buffer_load_dwordx2 v[22:23], v3, s[12:15], 0 offen offset:32
    v_cmp_eq_u32 vcc, 2, v2
    v_and_b32 v3, 1, v2
    v_cmp_eq_u32 s[28:29], 1, v3
    s_waitcnt vmcnt(0)
    v_cndmask_b32 v24, v4, v14, vcc
    v_cndmask_b32 v24, v24, 0, s[28:29]
    v_cndmask_b32 v25, v5, v15, vcc
    v_cndmask_b32 v25, v25, 0, s[28:29]
    v_cndmask_b32 v26, v6, v16, vcc
    v_cndmask_b32 v26, v26, 0, s[28:29]
    v_cndmask_b32 v27, v7, v17, vcc
    v_cndmask_b32 v27, v27, 0, s[28:29]
    v_cndmask_b32 v28, v8, v18, vcc
    v_cndmask_b32 v28, v28, 0, s[28:29]
    v_cndmask_b32 v29, v9, v19, vcc
    v_cndmask_b32 v29, v29, 0, s[28:29]
    v_cndmask_b32 v30, v10, v20, vcc
    v_cndmask_b32 v30, v30, 0, s[28:29]
    v_cndmask_b32 v31, v11, v21, vcc
    v_cndmask_b32 v31, v31, 0, s[28:29]
    v_cndmask_b32 v32, v12, v22, vcc
    v_cndmask_b32 v32, v32, 0, s[28:29]
    v_cndmask_b32 v33, v13, v23, vcc
    v_cndmask_b32 v33, v33, 0, s[28:29]
    v_mov_b32 v34, 0
    v_mov_b32 v35, 0
    v_mov_b32 v36, 0
    v_mov_b32 v37, 0
    v_mov_b32 v38, 0
    v_mov_b32 v39, 0
    v_lshlrev_b32 v3, 8, v1
    v_lshl_add_u32 v3, v2, 6, v3
    buffer_store_dwordx4 v[24:27], v3, s[24:27], 0 offen offset:0
    buffer_store_dwordx4 v[28:31], v3, s[24:27], 0 offen offset:16
    buffer_store_dwordx4 v[32:35], v3, s[24:27], 0 offen offset:32
    buffer_store_dwordx4 v[36:39], v3, s[24:27], 0 offen offset:48
    s_endpgm
L_prep_kernel_notB:
    s_cmp_ge_u32 s2, 148
    s_cbranch_scc1 L_prep_kernel_notq
    s_mov_b32 s8, s40
    s_mov_b32 s9, s41
    s_mov_b32 s10, 0xc8000
    s_mov_b32 s11, 0x20000
    s_add_u32 s12, s6, 0x1678000
    s_addc_u32 s13, s7, 0
    s_mov_b32 s14, 0xc00
    s_mov_b32 s15, 0x20000
    s_sub_u32 s3, s2, 138
    v_and_b32 v1, 7, v0
    v_lshrrev_b32 v2, 3, v0
    v_mul_u32_u24 v3, 25600, v2
    v_lshl_add_u32 v3, v1, 4, v3
    s_lshl_b32 s28, s3, 7
    v_add_u32 v3, s28, v3
    v_mov_b32 v12, 0
    v_mov_b32 v13, 0
    v_mov_b32 v14, 0
    v_mov_b32 v15, 0
    v_mov_b32 v16, 0
    v_mov_b32 v17, 0
    v_mov_b32 v18, 0
    v_mov_b32 v19, 0
    s_mov_b32 s29, 0xffff0000
    s_mov_b32 s30, 0
    buffer_load_dwordx4 v[24:27], v3, s[8:11], s30 offen
    s_mov_b32 s30, 1280
    buffer_load_dwordx4 v[28:31], v3, s[8:11], s30 offen
    s_mov_b32 s30, 2560
    buffer_load_dwordx4 v[32:35], v3, s[8:11], s30 offen
    s_mov_b32 s30, 3840
    buffer_load_dwordx4 v[36:39], v3, s[8:11], s30 offen
    s_mov_b32 s30, 5120
    buffer_load_dwordx4 v[40:43], v3, s[8:11], s30 offen
    s_mov_b32 s30, 6400
    buffer_load_dwordx4 v[44:47], v3, s[8:11], s30 offen
    s_mov_b32 s30, 7680
    buffer_load_dwordx4 v[48:51], v3, s[8:11], s30 offen
    s_mov_b32 s30, 8960
    buffer_load_dwordx4 v[52:55], v3, s[8:11], s30 offen
    s_mov_b32 s30, 10240
    buffer_load_dwordx4 v[56:59], v3, s[8:11], s30 offen
    s_mov_b32 s30, 11520
    buffer_load_dwordx4 v[60:63], v3, s[8:11], s30 offen
    s_mov_b32 s30, 12800
    buffer_load_dwordx4 v[64:67], v3, s[8:11], s30 offen
    s_mov_b32 s30, 14080
    buffer_load_dwordx4 v[68:71], v3, s[8:11], s30 offen
    s_mov_b32 s30, 15360
    buffer_load_dwordx4 v[72:75], v3, s[8:11], s30 offen
    s_mov_b32 s30, 16640
    buffer_load_dwordx4 v[76:79], v3, s[8:11], s30 offen
    s_mov_b32 s30, 17920
    buffer_load_dwordx4 v[80:83], v3, s[8:11], s30 offen
    s_mov_b32 s30, 19200
    buffer_load_dwordx4 v[84:87], v3, s[8:11], s30 offen
    s_mov_b32 s30, 20480
    buffer_load_dwordx4 v[88:91], v3, s[8:11], s30 offen
    s_mov_b32 s30, 21760
    buffer_load_dwordx4 v[92:95], v3, s[8:11], s30 offen
    s_mov_b32 s30, 23040
    buffer_load_dwordx4 v[96:99], v3, s[8:11], s30 offen
    s_mov_b32 s30, 24320
    buffer_load_dwordx4 v[100:103], v3, s[8:11], s30 offen
    s_waitcnt vmcnt(19)
    v_lshlrev_b32 v20, 16, v24
    v_and_b32 v21, s29, v24
    v_pk_add_f32 v[12:13], v[12:13], v[20:21]
    v_lshlrev_b32 v20, 16, v25
    v_and_b32 v21, s29, v25
    v_pk_add_f32 v[14:15], v[14:15], v[20:21]
    v_lshlrev_b32 v20, 16, v26
    v_and_b32 v21, s29, v26
    v_pk_add_f32 v[16:17], v[16:17], v[20:21]
    v_lshlrev_b32 v20, 16, v27
    v_and_b32 v21, s29, v27
    v_pk_add_f32 v[18:19], v[18:19], v[20:21]
    s_waitcnt vmcnt(18)
    v_lshlrev_b32 v20, 16, v28
    v_and_b32 v21, s29, v28
    v_pk_add_f32 v[12:13], v[12:13], v[20:21]
    v_lshlrev_b32 v20, 16, v29
    v_and_b32 v21, s29, v29
    v_pk_add_f32 v[14:15], v[14:15], v[20:21]
    v_lshlrev_b32 v20, 16, v30
    v_and_b32 v21, s29, v30
    v_pk_add_f32 v[16:17], v[16:17], v[20:21]
    v_lshlrev_b32 v20, 16, v31
    v_and_b32 v21, s29, v31
    v_pk_add_f32 v[18:19], v[18:19], v[20:21]
    s_waitcnt vmcnt(17)
    v_lshlrev_b32 v20, 16, v32
    v_and_b32 v21, s29, v32
    v_pk_add_f32 v[12:13], v[12:13], v[20:21]
    v_lshlrev_b32 v20, 16, v33
    v_and_b32 v21, s29, v33
    v_pk_add_f32 v[14:15], v[14:15], v[20:21]
    v_lshlrev_b32 v20, 16, v34
    v_and_b32 v21, s29, v34
    v_pk_add_f32 v[16:17], v[16:17], v[20:21]
    v_lshlrev_b32 v20, 16, v35
    v_and_b32 v21, s29, v35
    v_pk_add_f32 v[18:19], v[18:19], v[20:21]
    s_waitcnt vmcnt(16)
    v_lshlrev_b32 v20, 16, v36
    v_and_b32 v21, s29, v36
    v_pk_add_f32 v[12:13], v[12:13], v[20:21]
    v_lshlrev_b32 v20, 16, v37
    v_and_b32 v21, s29, v37
    v_pk_add_f32 v[14:15], v[14:15], v[20:21]
    v_lshlrev_b32 v20, 16, v38
    v_and_b32 v21, s29, v38
    v_pk_add_f32 v[16:17], v[16:17], v[20:21]
    v_lshlrev_b32 v20, 16, v39
    v_and_b32 v21, s29, v39
    v_pk_add_f32 v[18:19], v[18:19], v[20:21]
    s_waitcnt vmcnt(15)
    v_lshlrev_b32 v20, 16, v40
    v_and_b32 v21, s29, v40
    v_pk_add_f32 v[12:13], v[12:13], v[20:21]
    v_lshlrev_b32 v20, 16, v41
    v_and_b32 v21, s29, v41
    v_pk_add_f32 v[14:15], v[14:15], v[20:21]
    v_lshlrev_b32 v20, 16, v42
    v_and_b32 v21, s29, v42
    v_pk_add_f32 v[16:17], v[16:17], v[20:21]
    v_lshlrev_b32 v20, 16, v43
    v_and_b32 v21, s29, v43
    v_pk_add_f32 v[18:19], v[18:19], v[20:21]
    s_waitcnt vmcnt(14)
    v_lshlrev_b32 v20, 16, v44
    v_and_b32 v21, s29, v44
    v_pk_add_f32 v[12:13], v[12:13], v[20:21]
    v_lshlrev_b32 v20, 16, v45
    v_and_b32 v21, s29, v45
    v_pk_add_f32 v[14:15], v[14:15], v[20:21]
    v_lshlrev_b32 v20, 16, v46
    v_and_b32 v21, s29, v46
    v_pk_add_f32 v[16:17], v[16:17], v[20:21]
    v_lshlrev_b32 v20, 16, v47
    v_and_b32 v21, s29, v47
    v_pk_add_f32 v[18:19], v[18:19], v[20:21]
    s_waitcnt vmcnt(13)
    v_lshlrev_b32 v20, 16, v48
    v_and_b32 v21, s29, v48
    v_pk_add_f32 v[12:13], v[12:13], v[20:21]
    v_lshlrev_b32 v20, 16, v49
    v_and_b32 v21, s29, v49
    v_pk_add_f32 v[14:15], v[14:15], v[20:21]
    v_lshlrev_b32 v20, 16, v50
    v_and_b32 v21, s29, v50
    v_pk_add_f32 v[16:17], v[16:17], v[20:21]
    v_lshlrev_b32 v20, 16, v51
    v_and_b32 v21, s29, v51
    v_pk_add_f32 v[18:19], v[18:19], v[20:21]
    s_waitcnt vmcnt(12)
    v_lshlrev_b32 v20, 16, v52
    v_and_b32 v21, s29, v52
    v_pk_add_f32 v[12:13], v[12:13], v[20:21]
    v_lshlrev_b32 v20, 16, v53
    v_and_b32 v21, s29, v53
    v_pk_add_f32 v[14:15], v[14:15], v[20:21]
    v_lshlrev_b32 v20, 16, v54
    v_and_b32 v21, s29, v54
    v_pk_add_f32 v[16:17], v[16:17], v[20:21]
    v_lshlrev_b32 v20, 16, v55
    v_and_b32 v21, s29, v55
    v_pk_add_f32 v[18:19], v[18:19], v[20:21]
    s_waitcnt vmcnt(11)
    v_lshlrev_b32 v20, 16, v56
    v_and_b32 v21, s29, v56
    v_pk_add_f32 v[12:13], v[12:13], v[20:21]
    v_lshlrev_b32 v20, 16, v57
    v_and_b32 v21, s29, v57
    v_pk_add_f32 v[14:15], v[14:15], v[20:21]
    v_lshlrev_b32 v20, 16, v58
    v_and_b32 v21, s29, v58
    v_pk_add_f32 v[16:17], v[16:17], v[20:21]
    v_lshlrev_b32 v20, 16, v59
    v_and_b32 v21, s29, v59
    v_pk_add_f32 v[18:19], v[18:19], v[20:21]
    s_waitcnt vmcnt(10)
    v_lshlrev_b32 v20, 16, v60
    v_and_b32 v21, s29, v60
    v_pk_add_f32 v[12:13], v[12:13], v[20:21]
    v_lshlrev_b32 v20, 16, v61
    v_and_b32 v21, s29, v61
    v_pk_add_f32 v[14:15], v[14:15], v[20:21]
    v_lshlrev_b32 v20, 16, v62
    v_and_b32 v21, s29, v62
    v_pk_add_f32 v[16:17], v[16:17], v[20:21]
    v_lshlrev_b32 v20, 16, v63
    v_and_b32 v21, s29, v63
    v_pk_add_f32 v[18:19], v[18:19], v[20:21]
    s_waitcnt vmcnt(9)
    v_lshlrev_b32 v20, 16, v64
    v_and_b32 v21, s29, v64
    v_pk_add_f32 v[12:13], v[12:13], v[20:21]
    v_lshlrev_b32 v20, 16, v65
    v_and_b32 v21, s29, v65
    v_pk_add_f32 v[14:15], v[14:15], v[20:21]
    v_lshlrev_b32 v20, 16, v66
    v_and_b32 v21, s29, v66
    v_pk_add_f32 v[16:17], v[16:17], v[20:21]
    v_lshlrev_b32 v20, 16, v67
    v_and_b32 v21, s29, v67
    v_pk_add_f32 v[18:19], v[18:19], v[20:21]
    s_waitcnt vmcnt(8)
    v_lshlrev_b32 v20, 16, v68
    v_and_b32 v21, s29, v68
    v_pk_add_f32 v[12:13], v[12:13], v[20:21]
    v_lshlrev_b32 v20, 16, v69
    v_and_b32 v21, s29, v69
    v_pk_add_f32 v[14:15], v[14:15], v[20:21]
    v_lshlrev_b32 v20, 16, v70
    v_and_b32 v21, s29, v70
    v_pk_add_f32 v[16:17], v[16:17], v[20:21]
    v_lshlrev_b32 v20, 16, v71
    v_and_b32 v21, s29, v71
    v_pk_add_f32 v[18:19], v[18:19], v[20:21]
    s_waitcnt vmcnt(7)
    v_lshlrev_b32 v20, 16, v72
    v_and_b32 v21, s29, v72
    v_pk_add_f32 v[12:13], v[12:13], v[20:21]
    v_lshlrev_b32 v20, 16, v73
    v_and_b32 v21, s29, v73
    v_pk_add_f32 v[14:15], v[14:15], v[20:21]
    v_lshlrev_b32 v20, 16, v74
    v_and_b32 v21, s29, v74
    v_pk_add_f32 v[16:17], v[16:17], v[20:21]
    v_lshlrev_b32 v20, 16, v75
    v_and_b32 v21, s29, v75
    v_pk_add_f32 v[18:19], v[18:19], v[20:21]
    s_waitcnt vmcnt(6)
    v_lshlrev_b32 v20, 16, v76
    v_and_b32 v21, s29, v76
    v_pk_add_f32 v[12:13], v[12:13], v[20:21]
    v_lshlrev_b32 v20, 16, v77
    v_and_b32 v21, s29, v77
    v_pk_add_f32 v[14:15], v[14:15], v[20:21]
    v_lshlrev_b32 v20, 16, v78
    v_and_b32 v21, s29, v78
    v_pk_add_f32 v[16:17], v[16:17], v[20:21]
    v_lshlrev_b32 v20, 16, v79
    v_and_b32 v21, s29, v79
    v_pk_add_f32 v[18:19], v[18:19], v[20:21]
    s_waitcnt vmcnt(5)
    v_lshlrev_b32 v20, 16, v80
    v_and_b32 v21, s29, v80
    v_pk_add_f32 v[12:13], v[12:13], v[20:21]
    v_lshlrev_b32 v20, 16, v81
    v_and_b32 v21, s29, v81
    v_pk_add_f32 v[14:15], v[14:15], v[20:21]
    v_lshlrev_b32 v20, 16, v82
    v_and_b32 v21, s29, v82
    v_pk_add_f32 v[16:17], v[16:17], v[20:21]
    v_lshlrev_b32 v20, 16, v83
    v_and_b32 v21, s29, v83
    v_pk_add_f32 v[18:19], v[18:19], v[20:21]
    s_waitcnt vmcnt(4)
    v_lshlrev_b32 v20, 16, v84
    v_and_b32 v21, s29, v84
    v_pk_add_f32 v[12:13], v[12:13], v[20:21]
    v_lshlrev_b32 v20, 16, v85
    v_and_b32 v21, s29, v85
    v_pk_add_f32 v[14:15], v[14:15], v[20:21]
    v_lshlrev_b32 v20, 16, v86
    v_and_b32 v21, s29, v86
    v_pk_add_f32 v[16:17], v[16:17], v[20:21]
    v_lshlrev_b32 v20, 16, v87
    v_and_b32 v21, s29, v87
    v_pk_add_f32 v[18:19], v[18:19], v[20:21]
    s_waitcnt vmcnt(3)
    v_lshlrev_b32 v20, 16, v88
    v_and_b32 v21, s29, v88
    v_pk_add_f32 v[12:13], v[12:13], v[20:21]
    v_lshlrev_b32 v20, 16, v89
    v_and_b32 v21, s29, v89
    v_pk_add_f32 v[14:15], v[14:15], v[20:21]
    v_lshlrev_b32 v20, 16, v90
    v_and_b32 v21, s29, v90
    v_pk_add_f32 v[16:17], v[16:17], v[20:21]
    v_lshlrev_b32 v20, 16, v91
    v_and_b32 v21, s29, v91
    v_pk_add_f32 v[18:19], v[18:19], v[20:21]
    s_waitcnt vmcnt(2)
    v_lshlrev_b32 v20, 16, v92
    v_and_b32 v21, s29, v92
    v_pk_add_f32 v[12:13], v[12:13], v[20:21]
    v_lshlrev_b32 v20, 16, v93
    v_and_b32 v21, s29, v93
    v_pk_add_f32 v[14:15], v[14:15], v[20:21]
    v_lshlrev_b32 v20, 16, v94
    v_and_b32 v21, s29, v94
    v_pk_add_f32 v[16:17], v[16:17], v[20:21]
    v_lshlrev_b32 v20, 16, v95
    v_and_b32 v21, s29, v95
    v_pk_add_f32 v[18:19], v[18:19], v[20:21]
    s_waitcnt vmcnt(1)
    v_lshlrev_b32 v20, 16, v96
    v_and_b32 v21, s29, v96
    v_pk_add_f32 v[12:13], v[12:13], v[20:21]
    v_lshlrev_b32 v20, 16, v97
    v_and_b32 v21, s29, v97
    v_pk_add_f32 v[14:15], v[14:15], v[20:21]
    v_lshlrev_b32 v20, 16, v98
    v_and_b32 v21, s29, v98
    v_pk_add_f32 v[16:17], v[16:17], v[20:21]
    v_lshlrev_b32 v20, 16, v99
    v_and_b32 v21, s29, v99
    v_pk_add_f32 v[18:19], v[18:19], v[20:21]
    s_waitcnt vmcnt(0)
    v_lshlrev_b32 v20, 16, v100
    v_and_b32 v21, s29, v100
    v_pk_add_f32 v[12:13], v[12:13], v[20:21]
    v_lshlrev_b32 v20, 16, v101
    v_and_b32 v21, s29, v101
    v_pk_add_f32 v[14:15], v[14:15], v[20:21]
    v_lshlrev_b32 v20, 16, v102
    v_and_b32 v21, s29, v102
    v_pk_add_f32 v[16:17], v[16:17], v[20:21]
    v_lshlrev_b32 v20, 16, v103
    v_and_b32 v21, s29, v103
    v_pk_add_f32 v[18:19], v[18:19], v[20:21]
    v_lshlrev_b32 v3, 8, v2
    v_lshl_add_u32 v3, v1, 5, v3
    ds_write_b128 v3, v[12:15]
    ds_write_b128 v3, v[16:19] offset:16
    s_waitcnt lgkmcnt(0)
    s_barrier
    v_cmp_gt_u32 vcc, 64, v0
    s_and_saveexec_b64 s[32:33], vcc
    s_cbranch_execz L_prep_kernel_end
    v_lshlrev_b32 v3, 2, v0
    v_mov_b32 v12, 0
    ds_read_b32 v8, v3 offset:0
    ds_read_b32 v9, v3 offset:256
    ds_read_b32 v10, v3 offset:512
    ds_read_b32 v11, v3 offset:768
    s_waitcnt lgkmcnt(0)
    v_add_f32 v12, v12, v8
    v_add_f32 v12, v12, v9
    v_add_f32 v12, v12, v10
    v_add_f32 v12, v12, v11
    ds_read_b32 v8, v3 offset:1024
    ds_read_b32 v9, v3 offset:1280
    ds_read_b32 v10, v3 offset:1536
    ds_read_b32 v11, v3 offset:1792
    s_waitcnt lgkmcnt(0)
    v_add_f32 v12, v12, v8
    v_add_f32 v12, v12, v9
    v_add_f32 v12, v12, v10
    v_add_f32 v12, v12, v11
    ds_read_b32 v8, v3 offset:2048
    ds_read_b32 v9, v3 offset:2304
    ds_read_b32 v10, v3 offset:2560
    ds_read_b32 v11, v3 offset:2816
    s_waitcnt lgkmcnt(0)
    v_add_f32 v12, v12, v8
    v_add_f32 v12, v12, v9
    v_add_f32 v12, v12, v10
    v_add_f32 v12, v12, v11
    ds_read_b32 v8, v3 offset:3072
    ds_read_b32 v9, v3 offset:3328
    ds_read_b32 v10, v3 offset:3584
    ds_read_b32 v11, v3 offset:3840
    s_waitcnt lgkmcnt(0)
    v_add_f32 v12, v12, v8
    v_add_f32 v12, v12, v9
    v_add_f32 v12, v12, v10
    v_add_f32 v12, v12, v11
    ds_read_b32 v8, v3 offset:4096
    ds_read_b32 v9, v3 offset:4352
    ds_read_b32 v10, v3 offset:4608
    ds_read_b32 v11, v3 offset:4864
    s_waitcnt lgkmcnt(0)
    v_add_f32 v12, v12, v8
    v_add_f32 v12, v12, v9
    v_add_f32 v12, v12, v10
    v_add_f32 v12, v12, v11
    ds_read_b32 v8, v3 offset:5120
    ds_read_b32 v9, v3 offset:5376
    ds_read_b32 v10, v3 offset:5632
    ds_read_b32 v11, v3 offset:5888
    s_waitcnt lgkmcnt(0)
    v_add_f32 v12, v12, v8
    v_add_f32 v12, v12, v9
    v_add_f32 v12, v12, v10
    v_add_f32 v12, v12, v11
    ds_read_b32 v8, v3 offset:6144
    ds_read_b32 v9, v3 offset:6400
    ds_read_b32 v10, v3 offset:6656
    ds_read_b32 v11, v3 offset:6912
    s_waitcnt lgkmcnt(0)
    v_add_f32 v12, v12, v8
    v_add_f32 v12, v12, v9
    v_add_f32 v12, v12, v10
    v_add_f32 v12, v12, v11
    ds_read_b32 v8, v3 offset:7168
    ds_read_b32 v9, v3 offset:7424
    ds_read_b32 v10, v3 offset:7680
    ds_read_b32 v11, v3 offset:7936
    s_waitcnt lgkmcnt(0)
    v_add_f32 v12, v12, v8
    v_add_f32 v12, v12, v9
    v_add_f32 v12, v12, v10
    v_add_f32 v12, v12, v11
    s_lshl_b32 s28, s3, 8
    v_add_u32 v3, s28, v3
    buffer_store_dword v12, v3, s[12:15], 0 offen
    s_endpgm
L_prep_kernel_notq:
    s_cmp_ge_u32 s2, 175
    s_cbranch_scc1 L_prep_kernel_notg
    s_mov_b32 s8, s42
    s_mov_b32 s9, s43
    s_mov_b32 s10, 0x21c000
    s_mov_b32 s11, 0x20000
    s_add_u32 s12, s6, 0x1679000
    s_addc_u32 s13, s7, 0
    s_mov_b32 s14, 0x1b00
    s_mov_b32 s15, 0x20000
    s_sub_u32 s3, s2, 148
    v_and_b32 v1, 7, v0
    v_lshrrev_b32 v2, 3, v0
    v_mul_u32_u24 v3, 69120, v2
    v_lshl_add_u32 v3, v1, 4, v3
    s_lshl_b32 s28, s3, 7
    v_add_u32 v3, s28, v3
    v_mov_b32 v12, 0
    v_mov_b32 v13, 0
    v_mov_b32 v14, 0
    v_mov_b32 v15, 0
    v_mov_b32 v16, 0
    v_mov_b32 v17, 0
    v_mov_b32 v18, 0
    v_mov_b32 v19, 0
    s_mov_b32 s29, 0xffff0000
    s_mov_b32 s30, 0
    buffer_load_dwordx4 v[24:27], v3, s[8:11], s30 offen
    s_mov_b32 s30, 3456
    buffer_load_dwordx4 v[28:31], v3, s[8:11], s30 offen
    s_mov_b32 s30, 6912
    buffer_load_dwordx4 v[32:35], v3, s[8:11], s30 offen
    s_mov_b32 s30, 10368
    buffer_load_dwordx4 v[36:39], v3, s[8:11], s30 offen
    s_mov_b32 s30, 13824
    buffer_load_dwordx4 v[40:43], v3, s[8:11], s30 offen
    s_mov_b32 s30, 17280
    buffer_load_dwordx4 v[44:47], v3, s[8:11], s30 offen
    s_mov_b32 s30, 20736
    buffer_load_dwordx4 v[48:51], v3, s[8:11], s30 offen
    s_mov_b32 s30, 24192
    buffer_load_dwordx4 v[52:55], v3, s[8:11], s30 offen
    s_mov_b32 s30, 27648
    buffer_load_dwordx4 v[56:59], v3, s[8:11], s30 offen
    s_mov_b32 s30, 31104
    buffer_load_dwordx4 v[60:63], v3, s[8:11], s30 offen
    s_mov_b32 s30, 34560
    buffer_load_dwordx4 v[64:67], v3, s[8:11], s30 offen
    s_mov_b32 s30, 38016
    buffer_load_dwordx4 v[68:71], v3, s[8:11], s30 offen
    s_mov_b32 s30, 41472
    buffer_load_dwordx4 v[72:75], v3, s[8:11], s30 offen
    s_mov_b32 s30, 44928
    buffer_load_dwordx4 v[76:79], v3, s[8:11], s30 offen
    s_mov_b32 s30, 48384
    buffer_load_dwordx4 v[80:83], v3, s[8:11], s30 offen
    s_mov_b32 s30, 51840
    buffer_load_dwordx4 v[84:87], v3, s[8:11], s30 offen
    s_mov_b32 s30, 55296
    buffer_load_dwordx4 v[88:91], v3, s[8:11], s30 offen
    s_mov_b32 s30, 58752
    buffer_load_dwordx4 v[92:95], v3, s[8:11], s30 offen
    s_mov_b32 s30, 62208
    buffer_load_dwordx4 v[96:99], v3, s[8:11], s30 offen
    s_mov_b32 s30, 65664
    buffer_load_dwordx4 v[100:103], v3, s[8:11], s30 offen
    s_waitcnt vmcnt(19)
    v_lshlrev_b32 v20, 16, v24
    v_and_b32 v21, s29, v24
    v_pk_add_f32 v[12:13], v[12:13], v[20:21]
    v_lshlrev_b32 v20, 16, v25
    v_and_b32 v21, s29, v25
    v_pk_add_f32 v[14:15], v[14:15], v[20:21]
    v_lshlrev_b32 v20, 16, v26
    v_and_b32 v21, s29, v26
    v_pk_add_f32 v[16:17], v[16:17], v[20:21]
    v_lshlrev_b32 v20, 16, v27
    v_and_b32 v21, s29, v27
    v_pk_add_f32 v[18:19], v[18:19], v[20:21]
    s_waitcnt vmcnt(18)
    v_lshlrev_b32 v20, 16, v28
    v_and_b32 v21, s29, v28
    v_pk_add_f32 v[12:13], v[12:13], v[20:21]
    v_lshlrev_b32 v20, 16, v29
    v_and_b32 v21, s29, v29
    v_pk_add_f32 v[14:15], v[14:15], v[20:21]
    v_lshlrev_b32 v20, 16, v30
    v_and_b32 v21, s29, v30
    v_pk_add_f32 v[16:17], v[16:17], v[20:21]
    v_lshlrev_b32 v20, 16, v31
    v_and_b32 v21, s29, v31
    v_pk_add_f32 v[18:19], v[18:19], v[20:21]
    s_waitcnt vmcnt(17)
    v_lshlrev_b32 v20, 16, v32
    v_and_b32 v21, s29, v32
    v_pk_add_f32 v[12:13], v[12:13], v[20:21]
    v_lshlrev_b32 v20, 16, v33
    v_and_b32 v21, s29, v33
    v_pk_add_f32 v[14:15], v[14:15], v[20:21]
    v_lshlrev_b32 v20, 16, v34
    v_and_b32 v21, s29, v34
    v_pk_add_f32 v[16:17], v[16:17], v[20:21]
    v_lshlrev_b32 v20, 16, v35
    v_and_b32 v21, s29, v35
    v_pk_add_f32 v[18:19], v[18:19], v[20:21]
    s_waitcnt vmcnt(16)
    v_lshlrev_b32 v20, 16, v36
    v_and_b32 v21, s29, v36
    v_pk_add_f32 v[12:13], v[12:13], v[20:21]
    v_lshlrev_b32 v20, 16, v37
    v_and_b32 v21, s29, v37
    v_pk_add_f32 v[14:15], v[14:15], v[20:21]
    v_lshlrev_b32 v20, 16, v38
    v_and_b32 v21, s29, v38
    v_pk_add_f32 v[16:17], v[16:17], v[20:21]
    v_lshlrev_b32 v20, 16, v39
    v_and_b32 v21, s29, v39
    v_pk_add_f32 v[18:19], v[18:19], v[20:21]
    s_waitcnt vmcnt(15)
    v_lshlrev_b32 v20, 16, v40
    v_and_b32 v21, s29, v40
    v_pk_add_f32 v[12:13], v[12:13], v[20:21]
    v_lshlrev_b32 v20, 16, v41
    v_and_b32 v21, s29, v41
    v_pk_add_f32 v[14:15], v[14:15], v[20:21]
    v_lshlrev_b32 v20, 16, v42
    v_and_b32 v21, s29, v42
    v_pk_add_f32 v[16:17], v[16:17], v[20:21]
    v_lshlrev_b32 v20, 16, v43
    v_and_b32 v21, s29, v43
    v_pk_add_f32 v[18:19], v[18:19], v[20:21]
    s_waitcnt vmcnt(14)
    v_lshlrev_b32 v20, 16, v44
    v_and_b32 v21, s29, v44
    v_pk_add_f32 v[12:13], v[12:13], v[20:21]
    v_lshlrev_b32 v20, 16, v45
    v_and_b32 v21, s29, v45
    v_pk_add_f32 v[14:15], v[14:15], v[20:21]
    v_lshlrev_b32 v20, 16, v46
    v_and_b32 v21, s29, v46
    v_pk_add_f32 v[16:17], v[16:17], v[20:21]
    v_lshlrev_b32 v20, 16, v47
    v_and_b32 v21, s29, v47
    v_pk_add_f32 v[18:19], v[18:19], v[20:21]
    s_waitcnt vmcnt(13)
    v_lshlrev_b32 v20, 16, v48
    v_and_b32 v21, s29, v48
    v_pk_add_f32 v[12:13], v[12:13], v[20:21]
    v_lshlrev_b32 v20, 16, v49
    v_and_b32 v21, s29, v49
    v_pk_add_f32 v[14:15], v[14:15], v[20:21]
    v_lshlrev_b32 v20, 16, v50
    v_and_b32 v21, s29, v50
    v_pk_add_f32 v[16:17], v[16:17], v[20:21]
    v_lshlrev_b32 v20, 16, v51
    v_and_b32 v21, s29, v51
    v_pk_add_f32 v[18:19], v[18:19], v[20:21]
    s_waitcnt vmcnt(12)
    v_lshlrev_b32 v20, 16, v52
    v_and_b32 v21, s29, v52
    v_pk_add_f32 v[12:13], v[12:13], v[20:21]
    v_lshlrev_b32 v20, 16, v53
    v_and_b32 v21, s29, v53
    v_pk_add_f32 v[14:15], v[14:15], v[20:21]
    v_lshlrev_b32 v20, 16, v54
    v_and_b32 v21, s29, v54
    v_pk_add_f32 v[16:17], v[16:17], v[20:21]
    v_lshlrev_b32 v20, 16, v55
    v_and_b32 v21, s29, v55
    v_pk_add_f32 v[18:19], v[18:19], v[20:21]
    s_waitcnt vmcnt(11)
    v_lshlrev_b32 v20, 16, v56
    v_and_b32 v21, s29, v56
    v_pk_add_f32 v[12:13], v[12:13], v[20:21]
    v_lshlrev_b32 v20, 16, v57
    v_and_b32 v21, s29, v57
    v_pk_add_f32 v[14:15], v[14:15], v[20:21]
    v_lshlrev_b32 v20, 16, v58
    v_and_b32 v21, s29, v58
    v_pk_add_f32 v[16:17], v[16:17], v[20:21]
    v_lshlrev_b32 v20, 16, v59
    v_and_b32 v21, s29, v59
    v_pk_add_f32 v[18:19], v[18:19], v[20:21]
    s_waitcnt vmcnt(10)
    v_lshlrev_b32 v20, 16, v60
    v_and_b32 v21, s29, v60
    v_pk_add_f32 v[12:13], v[12:13], v[20:21]
    v_lshlrev_b32 v20, 16, v61
    v_and_b32 v21, s29, v61
    v_pk_add_f32 v[14:15], v[14:15], v[20:21]
    v_lshlrev_b32 v20, 16, v62
    v_and_b32 v21, s29, v62
    v_pk_add_f32 v[16:17], v[16:17], v[20:21]
    v_lshlrev_b32 v20, 16, v63
    v_and_b32 v21, s29, v63
    v_pk_add_f32 v[18:19], v[18:19], v[20:21]
    s_waitcnt vmcnt(9)
    v_lshlrev_b32 v20, 16, v64
    v_and_b32 v21, s29, v64
    v_pk_add_f32 v[12:13], v[12:13], v[20:21]
    v_lshlrev_b32 v20, 16, v65
    v_and_b32 v21, s29, v65
    v_pk_add_f32 v[14:15], v[14:15], v[20:21]
    v_lshlrev_b32 v20, 16, v66
    v_and_b32 v21, s29, v66
    v_pk_add_f32 v[16:17], v[16:17], v[20:21]
    v_lshlrev_b32 v20, 16, v67
    v_and_b32 v21, s29, v67
    v_pk_add_f32 v[18:19], v[18:19], v[20:21]
    s_waitcnt vmcnt(8)
    v_lshlrev_b32 v20, 16, v68
    v_and_b32 v21, s29, v68
    v_pk_add_f32 v[12:13], v[12:13], v[20:21]
    v_lshlrev_b32 v20, 16, v69
    v_and_b32 v21, s29, v69
    v_pk_add_f32 v[14:15], v[14:15], v[20:21]
    v_lshlrev_b32 v20, 16, v70
    v_and_b32 v21, s29, v70
    v_pk_add_f32 v[16:17], v[16:17], v[20:21]
    v_lshlrev_b32 v20, 16, v71
    v_and_b32 v21, s29, v71
    v_pk_add_f32 v[18:19], v[18:19], v[20:21]
    s_waitcnt vmcnt(7)
    v_lshlrev_b32 v20, 16, v72
    v_and_b32 v21, s29, v72
    v_pk_add_f32 v[12:13], v[12:13], v[20:21]
    v_lshlrev_b32 v20, 16, v73
    v_and_b32 v21, s29, v73
    v_pk_add_f32 v[14:15], v[14:15], v[20:21]
    v_lshlrev_b32 v20, 16, v74
    v_and_b32 v21, s29, v74
    v_pk_add_f32 v[16:17], v[16:17], v[20:21]
    v_lshlrev_b32 v20, 16, v75
    v_and_b32 v21, s29, v75
    v_pk_add_f32 v[18:19], v[18:19], v[20:21]
    s_waitcnt vmcnt(6)
    v_lshlrev_b32 v20, 16, v76
    v_and_b32 v21, s29, v76
    v_pk_add_f32 v[12:13], v[12:13], v[20:21]
    v_lshlrev_b32 v20, 16, v77
    v_and_b32 v21, s29, v77
    v_pk_add_f32 v[14:15], v[14:15], v[20:21]
    v_lshlrev_b32 v20, 16, v78
    v_and_b32 v21, s29, v78
    v_pk_add_f32 v[16:17], v[16:17], v[20:21]
    v_lshlrev_b32 v20, 16, v79
    v_and_b32 v21, s29, v79
    v_pk_add_f32 v[18:19], v[18:19], v[20:21]
    s_waitcnt vmcnt(5)
    v_lshlrev_b32 v20, 16, v80
    v_and_b32 v21, s29, v80
    v_pk_add_f32 v[12:13], v[12:13], v[20:21]
    v_lshlrev_b32 v20, 16, v81
    v_and_b32 v21, s29, v81
    v_pk_add_f32 v[14:15], v[14:15], v[20:21]
    v_lshlrev_b32 v20, 16, v82
    v_and_b32 v21, s29, v82
    v_pk_add_f32 v[16:17], v[16:17], v[20:21]
    v_lshlrev_b32 v20, 16, v83
    v_and_b32 v21, s29, v83
    v_pk_add_f32 v[18:19], v[18:19], v[20:21]
    s_waitcnt vmcnt(4)
    v_lshlrev_b32 v20, 16, v84
    v_and_b32 v21, s29, v84
    v_pk_add_f32 v[12:13], v[12:13], v[20:21]
    v_lshlrev_b32 v20, 16, v85
    v_and_b32 v21, s29, v85
    v_pk_add_f32 v[14:15], v[14:15], v[20:21]
    v_lshlrev_b32 v20, 16, v86
    v_and_b32 v21, s29, v86
    v_pk_add_f32 v[16:17], v[16:17], v[20:21]
    v_lshlrev_b32 v20, 16, v87
    v_and_b32 v21, s29, v87
    v_pk_add_f32 v[18:19], v[18:19], v[20:21]
    s_waitcnt vmcnt(3)
    v_lshlrev_b32 v20, 16, v88
    v_and_b32 v21, s29, v88
    v_pk_add_f32 v[12:13], v[12:13], v[20:21]
    v_lshlrev_b32 v20, 16, v89
    v_and_b32 v21, s29, v89
    v_pk_add_f32 v[14:15], v[14:15], v[20:21]
    v_lshlrev_b32 v20, 16, v90
    v_and_b32 v21, s29, v90
    v_pk_add_f32 v[16:17], v[16:17], v[20:21]
    v_lshlrev_b32 v20, 16, v91
    v_and_b32 v21, s29, v91
    v_pk_add_f32 v[18:19], v[18:19], v[20:21]
    s_waitcnt vmcnt(2)
    v_lshlrev_b32 v20, 16, v92
    v_and_b32 v21, s29, v92
    v_pk_add_f32 v[12:13], v[12:13], v[20:21]
    v_lshlrev_b32 v20, 16, v93
    v_and_b32 v21, s29, v93
    v_pk_add_f32 v[14:15], v[14:15], v[20:21]
    v_lshlrev_b32 v20, 16, v94
    v_and_b32 v21, s29, v94
    v_pk_add_f32 v[16:17], v[16:17], v[20:21]
    v_lshlrev_b32 v20, 16, v95
    v_and_b32 v21, s29, v95
    v_pk_add_f32 v[18:19], v[18:19], v[20:21]
    s_waitcnt vmcnt(1)
    v_lshlrev_b32 v20, 16, v96
    v_and_b32 v21, s29, v96
    v_pk_add_f32 v[12:13], v[12:13], v[20:21]
    v_lshlrev_b32 v20, 16, v97
    v_and_b32 v21, s29, v97
    v_pk_add_f32 v[14:15], v[14:15], v[20:21]
    v_lshlrev_b32 v20, 16, v98
    v_and_b32 v21, s29, v98
    v_pk_add_f32 v[16:17], v[16:17], v[20:21]
    v_lshlrev_b32 v20, 16, v99
    v_and_b32 v21, s29, v99
    v_pk_add_f32 v[18:19], v[18:19], v[20:21]
    s_waitcnt vmcnt(0)
    v_lshlrev_b32 v20, 16, v100
    v_and_b32 v21, s29, v100
    v_pk_add_f32 v[12:13], v[12:13], v[20:21]
    v_lshlrev_b32 v20, 16, v101
    v_and_b32 v21, s29, v101
    v_pk_add_f32 v[14:15], v[14:15], v[20:21]
    v_lshlrev_b32 v20, 16, v102
    v_and_b32 v21, s29, v102
    v_pk_add_f32 v[16:17], v[16:17], v[20:21]
    v_lshlrev_b32 v20, 16, v103
    v_and_b32 v21, s29, v103
    v_pk_add_f32 v[18:19], v[18:19], v[20:21]
    v_lshlrev_b32 v3, 8, v2
    v_lshl_add_u32 v3, v1, 5, v3
    ds_write_b128 v3, v[12:15]
    ds_write_b128 v3, v[16:19] offset:16
    s_waitcnt lgkmcnt(0)
    s_barrier
    v_cmp_gt_u32 vcc, 64, v0
    s_and_saveexec_b64 s[32:33], vcc
    s_cbranch_execz L_prep_kernel_end
    v_lshlrev_b32 v3, 2, v0
    v_mov_b32 v12, 0
    ds_read_b32 v8, v3 offset:0
    ds_read_b32 v9, v3 offset:256
    ds_read_b32 v10, v3 offset:512
    ds_read_b32 v11, v3 offset:768
    s_waitcnt lgkmcnt(0)
    v_add_f32 v12, v12, v8
    v_add_f32 v12, v12, v9
    v_add_f32 v12, v12, v10
    v_add_f32 v12, v12, v11
    ds_read_b32 v8, v3 offset:1024
    ds_read_b32 v9, v3 offset:1280
    ds_read_b32 v10, v3 offset:1536
    ds_read_b32 v11, v3 offset:1792
    s_waitcnt lgkmcnt(0)
    v_add_f32 v12, v12, v8
    v_add_f32 v12, v12, v9
    v_add_f32 v12, v12, v10
    v_add_f32 v12, v12, v11
    ds_read_b32 v8, v3 offset:2048
    ds_read_b32 v9, v3 offset:2304
    ds_read_b32 v10, v3 offset:2560
    ds_read_b32 v11, v3 offset:2816
    s_waitcnt lgkmcnt(0)
    v_add_f32 v12, v12, v8
    v_add_f32 v12, v12, v9
    v_add_f32 v12, v12, v10
    v_add_f32 v12, v12, v11
    ds_read_b32 v8, v3 offset:3072
    ds_read_b32 v9, v3 offset:3328
    ds_read_b32 v10, v3 offset:3584
    ds_read_b32 v11, v3 offset:3840
    s_waitcnt lgkmcnt(0)
    v_add_f32 v12, v12, v8
    v_add_f32 v12, v12, v9
    v_add_f32 v12, v12, v10
    v_add_f32 v12, v12, v11
    ds_read_b32 v8, v3 offset:4096
    ds_read_b32 v9, v3 offset:4352
    ds_read_b32 v10, v3 offset:4608
    ds_read_b32 v11, v3 offset:4864
    s_waitcnt lgkmcnt(0)
    v_add_f32 v12, v12, v8
    v_add_f32 v12, v12, v9
    v_add_f32 v12, v12, v10
    v_add_f32 v12, v12, v11
    ds_read_b32 v8, v3 offset:5120
    ds_read_b32 v9, v3 offset:5376
    ds_read_b32 v10, v3 offset:5632
    ds_read_b32 v11, v3 offset:5888
    s_waitcnt lgkmcnt(0)
    v_add_f32 v12, v12, v8
    v_add_f32 v12, v12, v9
    v_add_f32 v12, v12, v10
    v_add_f32 v12, v12, v11
    ds_read_b32 v8, v3 offset:6144
    ds_read_b32 v9, v3 offset:6400
    ds_read_b32 v10, v3 offset:6656
    ds_read_b32 v11, v3 offset:6912
    s_waitcnt lgkmcnt(0)
    v_add_f32 v12, v12, v8
    v_add_f32 v12, v12, v9
    v_add_f32 v12, v12, v10
    v_add_f32 v12, v12, v11
    ds_read_b32 v8, v3 offset:7168
    ds_read_b32 v9, v3 offset:7424
    ds_read_b32 v10, v3 offset:7680
    ds_read_b32 v11, v3 offset:7936
    s_waitcnt lgkmcnt(0)
    v_add_f32 v12, v12, v8
    v_add_f32 v12, v12, v9
    v_add_f32 v12, v12, v10
    v_add_f32 v12, v12, v11
    s_lshl_b32 s28, s3, 8
    v_add_u32 v3, s28, v3
    buffer_store_dword v12, v3, s[12:15], 0 offen
    s_endpgm
L_prep_kernel_notg:
    s_cmp_ge_u32 s2, 202
    s_cbranch_scc1 L_prep_kernel_notu
    s_mov_b32 s8, s44
    s_mov_b32 s9, s45
    s_mov_b32 s10, 0x21c000
    s_mov_b32 s11, 0x20000
    s_add_u32 s12, s6, 0x167b000
    s_addc_u32 s13, s7, 0
    s_mov_b32 s14, 0x1b00
    s_mov_b32 s15, 0x20000
    s_sub_u32 s3, s2, 175
    v_and_b32 v1, 7, v0
    v_lshrrev_b32 v2, 3, v0
    v_mul_u32_u24 v3, 69120, v2
    v_lshl_add_u32 v3, v1, 4, v3
    s_lshl_b32 s28, s3, 7
    v_add_u32 v3, s28, v3
    v_mov_b32 v12, 0
    v_mov_b32 v13, 0
    v_mov_b32 v14, 0
    v_mov_b32 v15, 0
    v_mov_b32 v16, 0
    v_mov_b32 v17, 0
    v_mov_b32 v18, 0
    v_mov_b32 v19, 0
    s_mov_b32 s29, 0xffff0000
    s_mov_b32 s30, 0
    buffer_load_dwordx4 v[24:27], v3, s[8:11], s30 offen
    s_mov_b32 s30, 3456
    buffer_load_dwordx4 v[28:31], v3, s[8:11], s30 offen
    s_mov_b32 s30, 6912
    buffer_load_dwordx4 v[32:35], v3, s[8:11], s30 offen
    s_mov_b32 s30, 10368
    buffer_load_dwordx4 v[36:39], v3, s[8:11], s30 offen
    s_mov_b32 s30, 13824
    buffer_load_dwordx4 v[40:43], v3, s[8:11], s30 offen
    s_mov_b32 s30, 17280
    buffer_load_dwordx4 v[44:47], v3, s[8:11], s30 offen
    s_mov_b32 s30, 20736
    buffer_load_dwordx4 v[48:51], v3, s[8:11], s30 offen
    s_mov_b32 s30, 24192
    buffer_load_dwordx4 v[52:55], v3, s[8:11], s30 offen
    s_mov_b32 s30, 27648
    buffer_load_dwordx4 v[56:59], v3, s[8:11], s30 offen
    s_mov_b32 s30, 31104
    buffer_load_dwordx4 v[60:63], v3, s[8:11], s30 offen
    s_mov_b32 s30, 34560
    buffer_load_dwordx4 v[64:67], v3, s[8:11], s30 offen
    s_mov_b32 s30, 38016
    buffer_load_dwordx4 v[68:71], v3, s[8:11], s30 offen
    s_mov_b32 s30, 41472
    buffer_load_dwordx4 v[72:75], v3, s[8:11], s30 offen
    s_mov_b32 s30, 44928
    buffer_load_dwordx4 v[76:79], v3, s[8:11], s30 offen
    s_mov_b32 s30, 48384
    buffer_load_dwordx4 v[80:83], v3, s[8:11], s30 offen
    s_mov_b32 s30, 51840
    buffer_load_dwordx4 v[84:87], v3, s[8:11], s30 offen
    s_mov_b32 s30, 55296
    buffer_load_dwordx4 v[88:91], v3, s[8:11], s30 offen
    s_mov_b32 s30, 58752
    buffer_load_dwordx4 v[92:95], v3, s[8:11], s30 offen
    s_mov_b32 s30, 62208
    buffer_load_dwordx4 v[96:99], v3, s[8:11], s30 offen
    s_mov_b32 s30, 65664
    buffer_load_dwordx4 v[100:103], v3, s[8:11], s30 offen
    s_waitcnt vmcnt(19)
    v_lshlrev_b32 v20, 16, v24
    v_and_b32 v21, s29, v24
    v_pk_add_f32 v[12:13], v[12:13], v[20:21]
    v_lshlrev_b32 v20, 16, v25
    v_and_b32 v21, s29, v25
    v_pk_add_f32 v[14:15], v[14:15], v[20:21]
    v_lshlrev_b32 v20, 16, v26
    v_and_b32 v21, s29, v26
    v_pk_add_f32 v[16:17], v[16:17], v[20:21]
    v_lshlrev_b32 v20, 16, v27
    v_and_b32 v21, s29, v27
    v_pk_add_f32 v[18:19], v[18:19], v[20:21]
    s_waitcnt vmcnt(18)
    v_lshlrev_b32 v20, 16, v28
    v_and_b32 v21, s29, v28
    v_pk_add_f32 v[12:13], v[12:13], v[20:21]
    v_lshlrev_b32 v20, 16, v29
    v_and_b32 v21, s29, v29
    v_pk_add_f32 v[14:15], v[14:15], v[20:21]
    v_lshlrev_b32 v20, 16, v30
    v_and_b32 v21, s29, v30
    v_pk_add_f32 v[16:17], v[16:17], v[20:21]
    v_lshlrev_b32 v20, 16, v31
    v_and_b32 v21, s29, v31
    v_pk_add_f32 v[18:19], v[18:19], v[20:21]
    s_waitcnt vmcnt(17)
    v_lshlrev_b32 v20, 16, v32
    v_and_b32 v21, s29, v32
    v_pk_add_f32 v[12:13], v[12:13], v[20:21]
    v_lshlrev_b32 v20, 16, v33
    v_and_b32 v21, s29, v33
    v_pk_add_f32 v[14:15], v[14:15], v[20:21]
    v_lshlrev_b32 v20, 16, v34
    v_and_b32 v21, s29, v34
    v_pk_add_f32 v[16:17], v[16:17], v[20:21]
    v_lshlrev_b32 v20, 16, v35
    v_and_b32 v21, s29, v35
    v_pk_add_f32 v[18:19], v[18:19], v[20:21]
    s_waitcnt vmcnt(16)
    v_lshlrev_b32 v20, 16, v36
    v_and_b32 v21, s29, v36
    v_pk_add_f32 v[12:13], v[12:13], v[20:21]
    v_lshlrev_b32 v20, 16, v37
    v_and_b32 v21, s29, v37
    v_pk_add_f32 v[14:15], v[14:15], v[20:21]
    v_lshlrev_b32 v20, 16, v38
    v_and_b32 v21, s29, v38
    v_pk_add_f32 v[16:17], v[16:17], v[20:21]
    v_lshlrev_b32 v20, 16, v39
    v_and_b32 v21, s29, v39
    v_pk_add_f32 v[18:19], v[18:19], v[20:21]
    s_waitcnt vmcnt(15)
    v_lshlrev_b32 v20, 16, v40
    v_and_b32 v21, s29, v40
    v_pk_add_f32 v[12:13], v[12:13], v[20:21]
    v_lshlrev_b32 v20, 16, v41
    v_and_b32 v21, s29, v41
    v_pk_add_f32 v[14:15], v[14:15], v[20:21]
    v_lshlrev_b32 v20, 16, v42
    v_and_b32 v21, s29, v42
    v_pk_add_f32 v[16:17], v[16:17], v[20:21]
    v_lshlrev_b32 v20, 16, v43
    v_and_b32 v21, s29, v43
    v_pk_add_f32 v[18:19], v[18:19], v[20:21]
    s_waitcnt vmcnt(14)
    v_lshlrev_b32 v20, 16, v44
    v_and_b32 v21, s29, v44
    v_pk_add_f32 v[12:13], v[12:13], v[20:21]
    v_lshlrev_b32 v20, 16, v45
    v_and_b32 v21, s29, v45
    v_pk_add_f32 v[14:15], v[14:15], v[20:21]
    v_lshlrev_b32 v20, 16, v46
    v_and_b32 v21, s29, v46
    v_pk_add_f32 v[16:17], v[16:17], v[20:21]
    v_lshlrev_b32 v20, 16, v47
    v_and_b32 v21, s29, v47
    v_pk_add_f32 v[18:19], v[18:19], v[20:21]
    s_waitcnt vmcnt(13)
    v_lshlrev_b32 v20, 16, v48
    v_and_b32 v21, s29, v48
    v_pk_add_f32 v[12:13], v[12:13], v[20:21]
    v_lshlrev_b32 v20, 16, v49
    v_and_b32 v21, s29, v49
    v_pk_add_f32 v[14:15], v[14:15], v[20:21]
    v_lshlrev_b32 v20, 16, v50
    v_and_b32 v21, s29, v50
    v_pk_add_f32 v[16:17], v[16:17], v[20:21]
    v_lshlrev_b32 v20, 16, v51
    v_and_b32 v21, s29, v51
    v_pk_add_f32 v[18:19], v[18:19], v[20:21]
    s_waitcnt vmcnt(12)
    v_lshlrev_b32 v20, 16, v52
    v_and_b32 v21, s29, v52
    v_pk_add_f32 v[12:13], v[12:13], v[20:21]
    v_lshlrev_b32 v20, 16, v53
    v_and_b32 v21, s29, v53
    v_pk_add_f32 v[14:15], v[14:15], v[20:21]
    v_lshlrev_b32 v20, 16, v54
    v_and_b32 v21, s29, v54
    v_pk_add_f32 v[16:17], v[16:17], v[20:21]
    v_lshlrev_b32 v20, 16, v55
    v_and_b32 v21, s29, v55
    v_pk_add_f32 v[18:19], v[18:19], v[20:21]
    s_waitcnt vmcnt(11)
    v_lshlrev_b32 v20, 16, v56
    v_and_b32 v21, s29, v56
    v_pk_add_f32 v[12:13], v[12:13], v[20:21]
    v_lshlrev_b32 v20, 16, v57
    v_and_b32 v21, s29, v57
    v_pk_add_f32 v[14:15], v[14:15], v[20:21]
    v_lshlrev_b32 v20, 16, v58
    v_and_b32 v21, s29, v58
    v_pk_add_f32 v[16:17], v[16:17], v[20:21]
    v_lshlrev_b32 v20, 16, v59
    v_and_b32 v21, s29, v59
    v_pk_add_f32 v[18:19], v[18:19], v[20:21]
    s_waitcnt vmcnt(10)
    v_lshlrev_b32 v20, 16, v60
    v_and_b32 v21, s29, v60
    v_pk_add_f32 v[12:13], v[12:13], v[20:21]
    v_lshlrev_b32 v20, 16, v61
    v_and_b32 v21, s29, v61
    v_pk_add_f32 v[14:15], v[14:15], v[20:21]
    v_lshlrev_b32 v20, 16, v62
    v_and_b32 v21, s29, v62
    v_pk_add_f32 v[16:17], v[16:17], v[20:21]
    v_lshlrev_b32 v20, 16, v63
    v_and_b32 v21, s29, v63
    v_pk_add_f32 v[18:19], v[18:19], v[20:21]
    s_waitcnt vmcnt(9)
    v_lshlrev_b32 v20, 16, v64
    v_and_b32 v21, s29, v64
    v_pk_add_f32 v[12:13], v[12:13], v[20:21]
    v_lshlrev_b32 v20, 16, v65
    v_and_b32 v21, s29, v65
    v_pk_add_f32 v[14:15], v[14:15], v[20:21]
    v_lshlrev_b32 v20, 16, v66
    v_and_b32 v21, s29, v66
    v_pk_add_f32 v[16:17], v[16:17], v[20:21]
    v_lshlrev_b32 v20, 16, v67
    v_and_b32 v21, s29, v67
    v_pk_add_f32 v[18:19], v[18:19], v[20:21]
    s_waitcnt vmcnt(8)
    v_lshlrev_b32 v20, 16, v68
    v_and_b32 v21, s29, v68
    v_pk_add_f32 v[12:13], v[12:13], v[20:21]
    v_lshlrev_b32 v20, 16, v69
    v_and_b32 v21, s29, v69
    v_pk_add_f32 v[14:15], v[14:15], v[20:21]
    v_lshlrev_b32 v20, 16, v70
    v_and_b32 v21, s29, v70
    v_pk_add_f32 v[16:17], v[16:17], v[20:21]
    v_lshlrev_b32 v20, 16, v71
    v_and_b32 v21, s29, v71
    v_pk_add_f32 v[18:19], v[18:19], v[20:21]
    s_waitcnt vmcnt(7)
    v_lshlrev_b32 v20, 16, v72
    v_and_b32 v21, s29, v72
    v_pk_add_f32 v[12:13], v[12:13], v[20:21]
    v_lshlrev_b32 v20, 16, v73
    v_and_b32 v21, s29, v73
    v_pk_add_f32 v[14:15], v[14:15], v[20:21]
    v_lshlrev_b32 v20, 16, v74
    v_and_b32 v21, s29, v74
    v_pk_add_f32 v[16:17], v[16:17], v[20:21]
    v_lshlrev_b32 v20, 16, v75
    v_and_b32 v21, s29, v75
    v_pk_add_f32 v[18:19], v[18:19], v[20:21]
    s_waitcnt vmcnt(6)
    v_lshlrev_b32 v20, 16, v76
    v_and_b32 v21, s29, v76
    v_pk_add_f32 v[12:13], v[12:13], v[20:21]
    v_lshlrev_b32 v20, 16, v77
    v_and_b32 v21, s29, v77
    v_pk_add_f32 v[14:15], v[14:15], v[20:21]
    v_lshlrev_b32 v20, 16, v78
    v_and_b32 v21, s29, v78
    v_pk_add_f32 v[16:17], v[16:17], v[20:21]
    v_lshlrev_b32 v20, 16, v79
    v_and_b32 v21, s29, v79
    v_pk_add_f32 v[18:19], v[18:19], v[20:21]
    s_waitcnt vmcnt(5)
    v_lshlrev_b32 v20, 16, v80
    v_and_b32 v21, s29, v80
    v_pk_add_f32 v[12:13], v[12:13], v[20:21]
    v_lshlrev_b32 v20, 16, v81
    v_and_b32 v21, s29, v81
    v_pk_add_f32 v[14:15], v[14:15], v[20:21]
    v_lshlrev_b32 v20, 16, v82
    v_and_b32 v21, s29, v82
    v_pk_add_f32 v[16:17], v[16:17], v[20:21]
    v_lshlrev_b32 v20, 16, v83
    v_and_b32 v21, s29, v83
    v_pk_add_f32 v[18:19], v[18:19], v[20:21]
    s_waitcnt vmcnt(4)
    v_lshlrev_b32 v20, 16, v84
    v_and_b32 v21, s29, v84
    v_pk_add_f32 v[12:13], v[12:13], v[20:21]
    v_lshlrev_b32 v20, 16, v85
    v_and_b32 v21, s29, v85
    v_pk_add_f32 v[14:15], v[14:15], v[20:21]
    v_lshlrev_b32 v20, 16, v86
    v_and_b32 v21, s29, v86
    v_pk_add_f32 v[16:17], v[16:17], v[20:21]
    v_lshlrev_b32 v20, 16, v87
    v_and_b32 v21, s29, v87
    v_pk_add_f32 v[18:19], v[18:19], v[20:21]
    s_waitcnt vmcnt(3)
    v_lshlrev_b32 v20, 16, v88
    v_and_b32 v21, s29, v88
    v_pk_add_f32 v[12:13], v[12:13], v[20:21]
    v_lshlrev_b32 v20, 16, v89
    v_and_b32 v21, s29, v89
    v_pk_add_f32 v[14:15], v[14:15], v[20:21]
    v_lshlrev_b32 v20, 16, v90
    v_and_b32 v21, s29, v90
    v_pk_add_f32 v[16:17], v[16:17], v[20:21]
    v_lshlrev_b32 v20, 16, v91
    v_and_b32 v21, s29, v91
    v_pk_add_f32 v[18:19], v[18:19], v[20:21]
    s_waitcnt vmcnt(2)
    v_lshlrev_b32 v20, 16, v92
    v_and_b32 v21, s29, v92
    v_pk_add_f32 v[12:13], v[12:13], v[20:21]
    v_lshlrev_b32 v20, 16, v93
    v_and_b32 v21, s29, v93
    v_pk_add_f32 v[14:15], v[14:15], v[20:21]
    v_lshlrev_b32 v20, 16, v94
    v_and_b32 v21, s29, v94
    v_pk_add_f32 v[16:17], v[16:17], v[20:21]
    v_lshlrev_b32 v20, 16, v95
    v_and_b32 v21, s29, v95
    v_pk_add_f32 v[18:19], v[18:19], v[20:21]
    s_waitcnt vmcnt(1)
    v_lshlrev_b32 v20, 16, v96
    v_and_b32 v21, s29, v96
    v_pk_add_f32 v[12:13], v[12:13], v[20:21]
    v_lshlrev_b32 v20, 16, v97
    v_and_b32 v21, s29, v97
    v_pk_add_f32 v[14:15], v[14:15], v[20:21]
    v_lshlrev_b32 v20, 16, v98
    v_and_b32 v21, s29, v98
    v_pk_add_f32 v[16:17], v[16:17], v[20:21]
    v_lshlrev_b32 v20, 16, v99
    v_and_b32 v21, s29, v99
    v_pk_add_f32 v[18:19], v[18:19], v[20:21]
    s_waitcnt vmcnt(0)
    v_lshlrev_b32 v20, 16, v100
    v_and_b32 v21, s29, v100
    v_pk_add_f32 v[12:13], v[12:13], v[20:21]
    v_lshlrev_b32 v20, 16, v101
    v_and_b32 v21, s29, v101
    v_pk_add_f32 v[14:15], v[14:15], v[20:21]
    v_lshlrev_b32 v20, 16, v102
    v_and_b32 v21, s29, v102
    v_pk_add_f32 v[16:17], v[16:17], v[20:21]
    v_lshlrev_b32 v20, 16, v103
    v_and_b32 v21, s29, v103
    v_pk_add_f32 v[18:19], v[18:19], v[20:21]
    v_lshlrev_b32 v3, 8, v2
    v_lshl_add_u32 v3, v1, 5, v3
    ds_write_b128 v3, v[12:15]
    ds_write_b128 v3, v[16:19] offset:16
    s_waitcnt lgkmcnt(0)
    s_barrier
    v_cmp_gt_u32 vcc, 64, v0
    s_and_saveexec_b64 s[32:33], vcc
    s_cbranch_execz L_prep_kernel_end
    v_lshlrev_b32 v3, 2, v0
    v_mov_b32 v12, 0
    ds_read_b32 v8, v3 offset:0
    ds_read_b32 v9, v3 offset:256
    ds_read_b32 v10, v3 offset:512
    ds_read_b32 v11, v3 offset:768
    s_waitcnt lgkmcnt(0)
    v_add_f32 v12, v12, v8
    v_add_f32 v12, v12, v9
    v_add_f32 v12, v12, v10
    v_add_f32 v12, v12, v11
    ds_read_b32 v8, v3 offset:1024
    ds_read_b32 v9, v3 offset:1280
    ds_read_b32 v10, v3 offset:1536
    ds_read_b32 v11, v3 offset:1792
    s_waitcnt lgkmcnt(0)
    v_add_f32 v12, v12, v8
    v_add_f32 v12, v12, v9
    v_add_f32 v12, v12, v10
    v_add_f32 v12, v12, v11
    ds_read_b32 v8, v3 offset:2048
    ds_read_b32 v9, v3 offset:2304
    ds_read_b32 v10, v3 offset:2560
    ds_read_b32 v11, v3 offset:2816
    s_waitcnt lgkmcnt(0)
    v_add_f32 v12, v12, v8
    v_add_f32 v12, v12, v9
    v_add_f32 v12, v12, v10
    v_add_f32 v12, v12, v11
    ds_read_b32 v8, v3 offset:3072
    ds_read_b32 v9, v3 offset:3328
    ds_read_b32 v10, v3 offset:3584
    ds_read_b32 v11, v3 offset:3840
    s_waitcnt lgkmcnt(0)
    v_add_f32 v12, v12, v8
    v_add_f32 v12, v12, v9
    v_add_f32 v12, v12, v10
    v_add_f32 v12, v12, v11
    ds_read_b32 v8, v3 offset:4096
    ds_read_b32 v9, v3 offset:4352
    ds_read_b32 v10, v3 offset:4608
    ds_read_b32 v11, v3 offset:4864
    s_waitcnt lgkmcnt(0)
    v_add_f32 v12, v12, v8
    v_add_f32 v12, v12, v9
    v_add_f32 v12, v12, v10
    v_add_f32 v12, v12, v11
    ds_read_b32 v8, v3 offset:5120
    ds_read_b32 v9, v3 offset:5376
    ds_read_b32 v10, v3 offset:5632
    ds_read_b32 v11, v3 offset:5888
    s_waitcnt lgkmcnt(0)
    v_add_f32 v12, v12, v8
    v_add_f32 v12, v12, v9
    v_add_f32 v12, v12, v10
    v_add_f32 v12, v12, v11
    ds_read_b32 v8, v3 offset:6144
    ds_read_b32 v9, v3 offset:6400
    ds_read_b32 v10, v3 offset:6656
    ds_read_b32 v11, v3 offset:6912
    s_waitcnt lgkmcnt(0)
    v_add_f32 v12, v12, v8
    v_add_f32 v12, v12, v9
    v_add_f32 v12, v12, v10
    v_add_f32 v12, v12, v11
    ds_read_b32 v8, v3 offset:7168
    ds_read_b32 v9, v3 offset:7424
    ds_read_b32 v10, v3 offset:7680
    ds_read_b32 v11, v3 offset:7936
    s_waitcnt lgkmcnt(0)
    v_add_f32 v12, v12, v8
    v_add_f32 v12, v12, v9
    v_add_f32 v12, v12, v10
    v_add_f32 v12, v12, v11
    s_lshl_b32 s28, s3, 8
    v_add_u32 v3, s28, v3
    buffer_store_dword v12, v3, s[12:15], 0 offen
    s_endpgm
L_prep_kernel_notu:
    s_cmp_ge_u32 s2, 203
    s_cbranch_scc1 L_prep_kernel_notk
    s_mov_b32 s8, s16
    s_mov_b32 s9, s17
    s_mov_b32 s10, 0x6400
    s_mov_b32 s11, 0x20000
    s_add_u32 s12, s6, 0x1678000
    s_addc_u32 s13, s7, 0
    s_mov_b32 s14, 0xc00
    s_mov_b32 s15, 0x20000
    s_sub_u32 s3, s2, 202
    v_and_b32 v1, 7, v0
    v_lshrrev_b32 v2, 3, v0
    v_mul_u32_u24 v3, 800, v2
    v_lshl_add_u32 v3, v1, 4, v3
    s_lshl_b32 s28, s3, 7
    v_add_u32 v3, s28, v3
    v_mov_b32 v12, 0
    v_mov_b32 v13, 0
    v_mov_b32 v14, 0
    v_mov_b32 v15, 0
    v_mov_b32 v16, 0
    v_mov_b32 v17, 0
    v_mov_b32 v18, 0
    v_mov_b32 v19, 0
    s_mov_b32 s29, 0xffff0000
    s_mov_b32 s30, 0
    buffer_load_dwordx2 v[24:25], v3, s[8:11], s30 offen
    buffer_load_dwordx2 v[26:27], v3, s[8:11], s30 offen offset:8
    s_mov_b32 s30, 40
    buffer_load_dwordx2 v[28:29], v3, s[8:11], s30 offen
    buffer_load_dwordx2 v[30:31], v3, s[8:11], s30 offen offset:8
    s_mov_b32 s30, 80
    buffer_load_dwordx2 v[32:33], v3, s[8:11], s30 offen
    buffer_load_dwordx2 v[34:35], v3, s[8:11], s30 offen offset:8
    s_mov_b32 s30, 120
    buffer_load_dwordx2 v[36:37], v3, s[8:11], s30 offen
    buffer_load_dwordx2 v[38:39], v3, s[8:11], s30 offen offset:8
    s_mov_b32 s30, 160
    buffer_load_dwordx2 v[40:41], v3, s[8:11], s30 offen
    buffer_load_dwordx2 v[42:43], v3, s[8:11], s30 offen offset:8
    s_mov_b32 s30, 200
    buffer_load_dwordx2 v[44:45], v3, s[8:11], s30 offen
    buffer_load_dwordx2 v[46:47], v3, s[8:11], s30 offen offset:8
    s_mov_b32 s30, 240
    buffer_load_dwordx2 v[48:49], v3, s[8:11], s30 offen
    buffer_load_dwordx2 v[50:51], v3, s[8:11], s30 offen offset:8
    s_mov_b32 s30, 280
    buffer_load_dwordx2 v[52:53], v3, s[8:11], s30 offen
    buffer_load_dwordx2 v[54:55], v3, s[8:11], s30 offen offset:8
    s_mov_b32 s30, 320
    buffer_load_dwordx2 v[56:57], v3, s[8:11], s30 offen
    buffer_load_dwordx2 v[58:59], v3, s[8:11], s30 offen offset:8
    s_mov_b32 s30, 360
    buffer_load_dwordx2 v[60:61], v3, s[8:11], s30 offen
    buffer_load_dwordx2 v[62:63], v3, s[8:11], s30 offen offset:8
    s_mov_b32 s30, 400
    buffer_load_dwordx2 v[64:65], v3, s[8:11], s30 offen
    buffer_load_dwordx2 v[66:67], v3, s[8:11], s30 offen offset:8
    s_mov_b32 s30, 440
    buffer_load_dwordx2 v[68:69], v3, s[8:11], s30 offen
    buffer_load_dwordx2 v[70:71], v3, s[8:11], s30 offen offset:8
    s_mov_b32 s30, 480
    buffer_load_dwordx2 v[72:73], v3, s[8:11], s30 offen
    buffer_load_dwordx2 v[74:75], v3, s[8:11], s30 offen offset:8
    s_mov_b32 s30, 520
    buffer_load_dwordx2 v[76:77], v3, s[8:11], s30 offen
    buffer_load_dwordx2 v[78:79], v3, s[8:11], s30 offen offset:8
    s_mov_b32 s30, 560
    buffer_load_dwordx2 v[80:81], v3, s[8:11], s30 offen
    buffer_load_dwordx2 v[82:83], v3, s[8:11], s30 offen offset:8
    s_mov_b32 s30, 600
    buffer_load_dwordx2 v[84:85], v3, s[8:11], s30 offen
    buffer_load_dwordx2 v[86:87], v3, s[8:11], s30 offen offset:8
    s_mov_b32 s30, 640
    buffer_load_dwordx2 v[88:89], v3, s[8:11], s30 offen
    buffer_load_dwordx2 v[90:91], v3, s[8:11], s30 offen offset:8
    s_mov_b32 s30, 680
    buffer_load_dwordx2 v[92:93], v3, s[8:11], s30 offen
    buffer_load_dwordx2 v[94:95], v3, s[8:11], s30 offen offset:8
    s_mov_b32 s30, 720
    buffer_load_dwordx2 v[96:97], v3, s[8:11], s30 offen
    buffer_load_dwordx2 v[98:99], v3, s[8:11], s30 offen offset:8
    s_mov_b32 s30, 760
    buffer_load_dwordx2 v[100:101], v3, s[8:11], s30 offen
    buffer_load_dwordx2 v[102:103], v3, s[8:11], s30 offen offset:8
    s_waitcnt vmcnt(38)
    v_lshlrev_b32 v20, 16, v24
    v_and_b32 v21, s29, v24
    v_pk_add_f32 v[12:13], v[12:13], v[20:21]
    v_lshlrev_b32 v20, 16, v25
    v_and_b32 v21, s29, v25
    v_pk_add_f32 v[14:15], v[14:15], v[20:21]
    v_lshlrev_b32 v20, 16, v26
    v_and_b32 v21, s29, v26
    v_pk_add_f32 v[16:17], v[16:17], v[20:21]
    v_lshlrev_b32 v20, 16, v27
    v_and_b32 v21, s29, v27
    v_pk_add_f32 v[18:19], v[18:19], v[20:21]
    s_waitcnt vmcnt(36)
    v_lshlrev_b32 v20, 16, v28
    v_and_b32 v21, s29, v28
    v_pk_add_f32 v[12:13], v[12:13], v[20:21]
    v_lshlrev_b32 v20, 16, v29
    v_and_b32 v21, s29, v29
    v_pk_add_f32 v[14:15], v[14:15], v[20:21]
    v_lshlrev_b32 v20, 16, v30
    v_and_b32 v21, s29, v30
    v_pk_add_f32 v[16:17], v[16:17], v[20:21]
    v_lshlrev_b32 v20, 16, v31
    v_and_b32 v21, s29, v31
    v_pk_add_f32 v[18:19], v[18:19], v[20:21]
    s_waitcnt vmcnt(34)
    v_lshlrev_b32 v20, 16, v32
    v_and_b32 v21, s29, v32
    v_pk_add_f32 v[12:13], v[12:13], v[20:21]
    v_lshlrev_b32 v20, 16, v33
    v_and_b32 v21, s29, v33
    v_pk_add_f32 v[14:15], v[14:15], v[20:21]
    v_lshlrev_b32 v20, 16, v34
    v_and_b32 v21, s29, v34
    v_pk_add_f32 v[16:17], v[16:17], v[20:21]
    v_lshlrev_b32 v20, 16, v35
    v_and_b32 v21, s29, v35
    v_pk_add_f32 v[18:19], v[18:19], v[20:21]
    s_waitcnt vmcnt(32)
    v_lshlrev_b32 v20, 16, v36
    v_and_b32 v21, s29, v36
    v_pk_add_f32 v[12:13], v[12:13], v[20:21]
    v_lshlrev_b32 v20, 16, v37
    v_and_b32 v21, s29, v37
    v_pk_add_f32 v[14:15], v[14:15], v[20:21]
    v_lshlrev_b32 v20, 16, v38
    v_and_b32 v21, s29, v38
    v_pk_add_f32 v[16:17], v[16:17], v[20:21]
    v_lshlrev_b32 v20, 16, v39
    v_and_b32 v21, s29, v39
    v_pk_add_f32 v[18:19], v[18:19], v[20:21]
    s_waitcnt vmcnt(30)
    v_lshlrev_b32 v20, 16, v40
    v_and_b32 v21, s29, v40
    v_pk_add_f32 v[12:13], v[12:13], v[20:21]
    v_lshlrev_b32 v20, 16, v41
    v_and_b32 v21, s29, v41
    v_pk_add_f32 v[14:15], v[14:15], v[20:21]
    v_lshlrev_b32 v20, 16, v42
    v_and_b32 v21, s29, v42
    v_pk_add_f32 v[16:17], v[16:17], v[20:21]
    v_lshlrev_b32 v20, 16, v43
    v_and_b32 v21, s29, v43
    v_pk_add_f32 v[18:19], v[18:19], v[20:21]
    s_waitcnt vmcnt(28)
    v_lshlrev_b32 v20, 16, v44
    v_and_b32 v21, s29, v44
    v_pk_add_f32 v[12:13], v[12:13], v[20:21]
    v_lshlrev_b32 v20, 16, v45
    v_and_b32 v21, s29, v45
    v_pk_add_f32 v[14:15], v[14:15], v[20:21]
    v_lshlrev_b32 v20, 16, v46
    v_and_b32 v21, s29, v46
    v_pk_add_f32 v[16:17], v[16:17], v[20:21]
    v_lshlrev_b32 v20, 16, v47
    v_and_b32 v21, s29, v47
    v_pk_add_f32 v[18:19], v[18:19], v[20:21]
    s_waitcnt vmcnt(26)
    v_lshlrev_b32 v20, 16, v48
    v_and_b32 v21, s29, v48
    v_pk_add_f32 v[12:13], v[12:13], v[20:21]
    v_lshlrev_b32 v20, 16, v49
    v_and_b32 v21, s29, v49
    v_pk_add_f32 v[14:15], v[14:15], v[20:21]
    v_lshlrev_b32 v20, 16, v50
    v_and_b32 v21, s29, v50
    v_pk_add_f32 v[16:17], v[16:17], v[20:21]
    v_lshlrev_b32 v20, 16, v51
    v_and_b32 v21, s29, v51
    v_pk_add_f32 v[18:19], v[18:19], v[20:21]
    s_waitcnt vmcnt(24)
    v_lshlrev_b32 v20, 16, v52
    v_and_b32 v21, s29, v52
    v_pk_add_f32 v[12:13], v[12:13], v[20:21]
    v_lshlrev_b32 v20, 16, v53
    v_and_b32 v21, s29, v53
    v_pk_add_f32 v[14:15], v[14:15], v[20:21]
    v_lshlrev_b32 v20, 16, v54
    v_and_b32 v21, s29, v54
    v_pk_add_f32 v[16:17], v[16:17], v[20:21]
    v_lshlrev_b32 v20, 16, v55
    v_and_b32 v21, s29, v55
    v_pk_add_f32 v[18:19], v[18:19], v[20:21]
    s_waitcnt vmcnt(22)
    v_lshlrev_b32 v20, 16, v56
    v_and_b32 v21, s29, v56
    v_pk_add_f32 v[12:13], v[12:13], v[20:21]
    v_lshlrev_b32 v20, 16, v57
    v_and_b32 v21, s29, v57
    v_pk_add_f32 v[14:15], v[14:15], v[20:21]
    v_lshlrev_b32 v20, 16, v58
    v_and_b32 v21, s29, v58
    v_pk_add_f32 v[16:17], v[16:17], v[20:21]
    v_lshlrev_b32 v20, 16, v59
    v_and_b32 v21, s29, v59
    v_pk_add_f32 v[18:19], v[18:19], v[20:21]
    s_waitcnt vmcnt(20)
    v_lshlrev_b32 v20, 16, v60
    v_and_b32 v21, s29, v60
    v_pk_add_f32 v[12:13], v[12:13], v[20:21]
    v_lshlrev_b32 v20, 16, v61
    v_and_b32 v21, s29, v61
    v_pk_add_f32 v[14:15], v[14:15], v[20:21]
    v_lshlrev_b32 v20, 16, v62
    v_and_b32 v21, s29, v62
    v_pk_add_f32 v[16:17], v[16:17], v[20:21]
    v_lshlrev_b32 v20, 16, v63
    v_and_b32 v21, s29, v63
    v_pk_add_f32 v[18:19], v[18:19], v[20:21]
    s_waitcnt vmcnt(18)
    v_lshlrev_b32 v20, 16, v64
    v_and_b32 v21, s29, v64
    v_pk_add_f32 v[12:13], v[12:13], v[20:21]
    v_lshlrev_b32 v20, 16, v65
    v_and_b32 v21, s29, v65
    v_pk_add_f32 v[14:15], v[14:15], v[20:21]
    v_lshlrev_b32 v20, 16, v66
    v_and_b32 v21, s29, v66
    v_pk_add_f32 v[16:17], v[16:17], v[20:21]
    v_lshlrev_b32 v20, 16, v67
    v_and_b32 v21, s29, v67
    v_pk_add_f32 v[18:19], v[18:19], v[20:21]
    s_waitcnt vmcnt(16)
    v_lshlrev_b32 v20, 16, v68
    v_and_b32 v21, s29, v68
    v_pk_add_f32 v[12:13], v[12:13], v[20:21]
    v_lshlrev_b32 v20, 16, v69
    v_and_b32 v21, s29, v69
    v_pk_add_f32 v[14:15], v[14:15], v[20:21]
    v_lshlrev_b32 v20, 16, v70
    v_and_b32 v21, s29, v70
    v_pk_add_f32 v[16:17], v[16:17], v[20:21]
    v_lshlrev_b32 v20, 16, v71
    v_and_b32 v21, s29, v71
    v_pk_add_f32 v[18:19], v[18:19], v[20:21]
    s_waitcnt vmcnt(14)
    v_lshlrev_b32 v20, 16, v72
    v_and_b32 v21, s29, v72
    v_pk_add_f32 v[12:13], v[12:13], v[20:21]
    v_lshlrev_b32 v20, 16, v73
    v_and_b32 v21, s29, v73
    v_pk_add_f32 v[14:15], v[14:15], v[20:21]
    v_lshlrev_b32 v20, 16, v74
    v_and_b32 v21, s29, v74
    v_pk_add_f32 v[16:17], v[16:17], v[20:21]
    v_lshlrev_b32 v20, 16, v75
    v_and_b32 v21, s29, v75
    v_pk_add_f32 v[18:19], v[18:19], v[20:21]
    s_waitcnt vmcnt(12)
    v_lshlrev_b32 v20, 16, v76
    v_and_b32 v21, s29, v76
    v_pk_add_f32 v[12:13], v[12:13], v[20:21]
    v_lshlrev_b32 v20, 16, v77
    v_and_b32 v21, s29, v77
    v_pk_add_f32 v[14:15], v[14:15], v[20:21]
    v_lshlrev_b32 v20, 16, v78
    v_and_b32 v21, s29, v78
    v_pk_add_f32 v[16:17], v[16:17], v[20:21]
    v_lshlrev_b32 v20, 16, v79
    v_and_b32 v21, s29, v79
    v_pk_add_f32 v[18:19], v[18:19], v[20:21]
    s_waitcnt vmcnt(10)
    v_lshlrev_b32 v20, 16, v80
    v_and_b32 v21, s29, v80
    v_pk_add_f32 v[12:13], v[12:13], v[20:21]
    v_lshlrev_b32 v20, 16, v81
    v_and_b32 v21, s29, v81
    v_pk_add_f32 v[14:15], v[14:15], v[20:21]
    v_lshlrev_b32 v20, 16, v82
    v_and_b32 v21, s29, v82
    v_pk_add_f32 v[16:17], v[16:17], v[20:21]
    v_lshlrev_b32 v20, 16, v83
    v_and_b32 v21, s29, v83
    v_pk_add_f32 v[18:19], v[18:19], v[20:21]
    s_waitcnt vmcnt(8)
    v_lshlrev_b32 v20, 16, v84
    v_and_b32 v21, s29, v84
    v_pk_add_f32 v[12:13], v[12:13], v[20:21]
    v_lshlrev_b32 v20, 16, v85
    v_and_b32 v21, s29, v85
    v_pk_add_f32 v[14:15], v[14:15], v[20:21]
    v_lshlrev_b32 v20, 16, v86
    v_and_b32 v21, s29, v86
    v_pk_add_f32 v[16:17], v[16:17], v[20:21]
    v_lshlrev_b32 v20, 16, v87
    v_and_b32 v21, s29, v87
    v_pk_add_f32 v[18:19], v[18:19], v[20:21]
    s_waitcnt vmcnt(6)
    v_lshlrev_b32 v20, 16, v88
    v_and_b32 v21, s29, v88
    v_pk_add_f32 v[12:13], v[12:13], v[20:21]
    v_lshlrev_b32 v20, 16, v89
    v_and_b32 v21, s29, v89
    v_pk_add_f32 v[14:15], v[14:15], v[20:21]
    v_lshlrev_b32 v20, 16, v90
    v_and_b32 v21, s29, v90
    v_pk_add_f32 v[16:17], v[16:17], v[20:21]
    v_lshlrev_b32 v20, 16, v91
    v_and_b32 v21, s29, v91
    v_pk_add_f32 v[18:19], v[18:19], v[20:21]
    s_waitcnt vmcnt(4)
    v_lshlrev_b32 v20, 16, v92
    v_and_b32 v21, s29, v92
    v_pk_add_f32 v[12:13], v[12:13], v[20:21]
    v_lshlrev_b32 v20, 16, v93
    v_and_b32 v21, s29, v93
    v_pk_add_f32 v[14:15], v[14:15], v[20:21]
    v_lshlrev_b32 v20, 16, v94
    v_and_b32 v21, s29, v94
    v_pk_add_f32 v[16:17], v[16:17], v[20:21]
    v_lshlrev_b32 v20, 16, v95
    v_and_b32 v21, s29, v95
    v_pk_add_f32 v[18:19], v[18:19], v[20:21]
    s_waitcnt vmcnt(2)
    v_lshlrev_b32 v20, 16, v96
    v_and_b32 v21, s29, v96
    v_pk_add_f32 v[12:13], v[12:13], v[20:21]
    v_lshlrev_b32 v20, 16, v97
    v_and_b32 v21, s29, v97
    v_pk_add_f32 v[14:15], v[14:15], v[20:21]
    v_lshlrev_b32 v20, 16, v98
    v_and_b32 v21, s29, v98
    v_pk_add_f32 v[16:17], v[16:17], v[20:21]
    v_lshlrev_b32 v20, 16, v99
    v_and_b32 v21, s29, v99
    v_pk_add_f32 v[18:19], v[18:19], v[20:21]
    s_waitcnt vmcnt(0)
    v_lshlrev_b32 v20, 16, v100
    v_and_b32 v21, s29, v100
    v_pk_add_f32 v[12:13], v[12:13], v[20:21]
    v_lshlrev_b32 v20, 16, v101
    v_and_b32 v21, s29, v101
    v_pk_add_f32 v[14:15], v[14:15], v[20:21]
    v_lshlrev_b32 v20, 16, v102
    v_and_b32 v21, s29, v102
    v_pk_add_f32 v[16:17], v[16:17], v[20:21]
    v_lshlrev_b32 v20, 16, v103
    v_and_b32 v21, s29, v103
    v_pk_add_f32 v[18:19], v[18:19], v[20:21]
    v_lshlrev_b32 v3, 8, v2
    v_lshl_add_u32 v3, v1, 5, v3
    ds_write_b128 v3, v[12:15]
    ds_write_b128 v3, v[16:19] offset:16
    s_waitcnt lgkmcnt(0)
    s_barrier
    v_cmp_gt_u32 vcc, 64, v0
    s_and_saveexec_b64 s[32:33], vcc
    s_cbranch_execz L_prep_kernel_end
    v_lshlrev_b32 v3, 2, v0
    v_mov_b32 v12, 0
    ds_read_b32 v8, v3 offset:0
    ds_read_b32 v9, v3 offset:256
    ds_read_b32 v10, v3 offset:512
    ds_read_b32 v11, v3 offset:768
    s_waitcnt lgkmcnt(0)
    v_add_f32 v12, v12, v8
    v_add_f32 v12, v12, v9
    v_add_f32 v12, v12, v10
    v_add_f32 v12, v12, v11
    ds_read_b32 v8, v3 offset:1024
    ds_read_b32 v9, v3 offset:1280
    ds_read_b32 v10, v3 offset:1536
    ds_read_b32 v11, v3 offset:1792
    s_waitcnt lgkmcnt(0)
    v_add_f32 v12, v12, v8
    v_add_f32 v12, v12, v9
    v_add_f32 v12, v12, v10
    v_add_f32 v12, v12, v11
    ds_read_b32 v8, v3 offset:2048
    ds_read_b32 v9, v3 offset:2304
    ds_read_b32 v10, v3 offset:2560
    ds_read_b32 v11, v3 offset:2816
    s_waitcnt lgkmcnt(0)
    v_add_f32 v12, v12, v8
    v_add_f32 v12, v12, v9
    v_add_f32 v12, v12, v10
    v_add_f32 v12, v12, v11
    ds_read_b32 v8, v3 offset:3072
    ds_read_b32 v9, v3 offset:3328
    ds_read_b32 v10, v3 offset:3584
    ds_read_b32 v11, v3 offset:3840
    s_waitcnt lgkmcnt(0)
    v_add_f32 v12, v12, v8
    v_add_f32 v12, v12, v9
    v_add_f32 v12, v12, v10
    v_add_f32 v12, v12, v11
    ds_read_b32 v8, v3 offset:4096
    ds_read_b32 v9, v3 offset:4352
    ds_read_b32 v10, v3 offset:4608
    ds_read_b32 v11, v3 offset:4864
    s_waitcnt lgkmcnt(0)
    v_add_f32 v12, v12, v8
    v_add_f32 v12, v12, v9
    v_add_f32 v12, v12, v10
    v_add_f32 v12, v12, v11
    ds_read_b32 v8, v3 offset:5120
    ds_read_b32 v9, v3 offset:5376
    ds_read_b32 v10, v3 offset:5632
    ds_read_b32 v11, v3 offset:5888
    s_waitcnt lgkmcnt(0)
    v_add_f32 v12, v12, v8
    v_add_f32 v12, v12, v9
    v_add_f32 v12, v12, v10
    v_add_f32 v12, v12, v11
    ds_read_b32 v8, v3 offset:6144
    ds_read_b32 v9, v3 offset:6400
    ds_read_b32 v10, v3 offset:6656
    ds_read_b32 v11, v3 offset:6912
    s_waitcnt lgkmcnt(0)
    v_add_f32 v12, v12, v8
    v_add_f32 v12, v12, v9
    v_add_f32 v12, v12, v10
    v_add_f32 v12, v12, v11
    ds_read_b32 v8, v3 offset:7168
    ds_read_b32 v9, v3 offset:7424
    ds_read_b32 v10, v3 offset:7680
    ds_read_b32 v11, v3 offset:7936
    s_waitcnt lgkmcnt(0)
    v_add_f32 v12, v12, v8
    v_add_f32 v12, v12, v9
    v_add_f32 v12, v12, v10
    v_add_f32 v12, v12, v11
    s_lshl_b32 s28, s3, 8
    v_add_u32 v3, s28, v3
    v_add_u32 v3, 2560, v3
    v_cmp_gt_u32 vcc, 20, v0
    s_nop 1
    v_cndmask_b32 v12, 0, v12, vcc
    buffer_store_dword v12, v3, s[12:15], 0 offen
    s_endpgm
L_prep_kernel_notk:
    s_cmp_ge_u32 s2, 204
    s_cbranch_scc1 L_prep_kernel_notv
    s_mov_b32 s8, s18
    s_mov_b32 s9, s19
    s_mov_b32 s10, 0x6400
    s_mov_b32 s11, 0x20000
    s_add_u32 s12, s6, 0x1678000
    s_addc_u32 s13, s7, 0
    s_mov_b32 s14, 0xc00
    s_mov_b32 s15, 0x20000
    s_sub_u32 s3, s2, 203
    v_and_b32 v1, 7, v0
    v_lshrrev_b32 v2, 3, v0
    v_mul_u32_u24 v3, 800, v2
    v_lshl_add_u32 v3, v1, 4, v3
    s_lshl_b32 s28, s3, 7
    v_add_u32 v3, s28, v3
    v_mov_b32 v12, 0
    v_mov_b32 v13, 0
    v_mov_b32 v14, 0
    v_mov_b32 v15, 0
    v_mov_b32 v16, 0
    v_mov_b32 v17, 0
    v_mov_b32 v18, 0
    v_mov_b32 v19, 0
    s_mov_b32 s29, 0xffff0000
    s_mov_b32 s30, 0
    buffer_load_dwordx2 v[24:25], v3, s[8:11], s30 offen
    buffer_load_dwordx2 v[26:27], v3, s[8:11], s30 offen offset:8
    s_mov_b32 s30, 40
    buffer_load_dwordx2 v[28:29], v3, s[8:11], s30 offen
    buffer_load_dwordx2 v[30:31], v3, s[8:11], s30 offen offset:8
    s_mov_b32 s30, 80
    buffer_load_dwordx2 v[32:33], v3, s[8:11], s30 offen
    buffer_load_dwordx2 v[34:35], v3, s[8:11], s30 offen offset:8
    s_mov_b32 s30, 120
    buffer_load_dwordx2 v[36:37], v3, s[8:11], s30 offen
    buffer_load_dwordx2 v[38:39], v3, s[8:11], s30 offen offset:8
    s_mov_b32 s30, 160
    buffer_load_dwordx2 v[40:41], v3, s[8:11], s30 offen
    buffer_load_dwordx2 v[42:43], v3, s[8:11], s30 offen offset:8
    s_mov_b32 s30, 200
    buffer_load_dwordx2 v[44:45], v3, s[8:11], s30 offen
    buffer_load_dwordx2 v[46:47], v3, s[8:11], s30 offen offset:8
    s_mov_b32 s30, 240
    buffer_load_dwordx2 v[48:49], v3, s[8:11], s30 offen
    buffer_load_dwordx2 v[50:51], v3, s[8:11], s30 offen offset:8
    s_mov_b32 s30, 280
    buffer_load_dwordx2 v[52:53], v3, s[8:11], s30 offen
    buffer_load_dwordx2 v[54:55], v3, s[8:11], s30 offen offset:8
    s_mov_b32 s30, 320
    buffer_load_dwordx2 v[56:57], v3, s[8:11], s30 offen
    buffer_load_dwordx2 v[58:59], v3, s[8:11], s30 offen offset:8
    s_mov_b32 s30, 360
    buffer_load_dwordx2 v[60:61], v3, s[8:11], s30 offen
    buffer_load_dwordx2 v[62:63], v3, s[8:11], s30 offen offset:8
    s_mov_b32 s30, 400
    buffer_load_dwordx2 v[64:65], v3, s[8:11], s30 offen
    buffer_load_dwordx2 v[66:67], v3, s[8:11], s30 offen offset:8
    s_mov_b32 s30, 440
    buffer_load_dwordx2 v[68:69], v3, s[8:11], s30 offen
    buffer_load_dwordx2 v[70:71], v3, s[8:11], s30 offen offset:8
    s_mov_b32 s30, 480
    buffer_load_dwordx2 v[72:73], v3, s[8:11], s30 offen
    buffer_load_dwordx2 v[74:75], v3, s[8:11], s30 offen offset:8
    s_mov_b32 s30, 520
    buffer_load_dwordx2 v[76:77], v3, s[8:11], s30 offen
    buffer_load_dwordx2 v[78:79], v3, s[8:11], s30 offen offset:8
    s_mov_b32 s30, 560
    buffer_load_dwordx2 v[80:81], v3, s[8:11], s30 offen
    buffer_load_dwordx2 v[82:83], v3, s[8:11], s30 offen offset:8
    s_mov_b32 s30, 600
    buffer_load_dwordx2 v[84:85], v3, s[8:11], s30 offen
    buffer_load_dwordx2 v[86:87], v3, s[8:11], s30 offen offset:8
    s_mov_b32 s30, 640
    buffer_load_dwordx2 v[88:89], v3, s[8:11], s30 offen
    buffer_load_dwordx2 v[90:91], v3, s[8:11], s30 offen offset:8
    s_mov_b32 s30, 680
    buffer_load_dwordx2 v[92:93], v3, s[8:11], s30 offen
    buffer_load_dwordx2 v[94:95], v3, s[8:11], s30 offen offset:8
    s_mov_b32 s30, 720
    buffer_load_dwordx2 v[96:97], v3, s[8:11], s30 offen
    buffer_load_dwordx2 v[98:99], v3, s[8:11], s30 offen offset:8
    s_mov_b32 s30, 760
    buffer_load_dwordx2 v[100:101], v3, s[8:11], s30 offen
    buffer_load_dwordx2 v[102:103], v3, s[8:11], s30 offen offset:8
    s_waitcnt vmcnt(38)
    v_lshlrev_b32 v20, 16, v24
    v_and_b32 v21, s29, v24
    v_pk_add_f32 v[12:13], v[12:13], v[20:21]
    v_lshlrev_b32 v20, 16, v25
    v_and_b32 v21, s29, v25
    v_pk_add_f32 v[14:15], v[14:15], v[20:21]
    v_lshlrev_b32 v20, 16, v26
    v_and_b32 v21, s29, v26
    v_pk_add_f32 v[16:17], v[16:17], v[20:21]
    v_lshlrev_b32 v20, 16, v27
    v_and_b32 v21, s29, v27
    v_pk_add_f32 v[18:19], v[18:19], v[20:21]
    s_waitcnt vmcnt(36)
    v_lshlrev_b32 v20, 16, v28
    v_and_b32 v21, s29, v28
    v_pk_add_f32 v[12:13], v[12:13], v[20:21]
    v_lshlrev_b32 v20, 16, v29
    v_and_b32 v21, s29, v29
    v_pk_add_f32 v[14:15], v[14:15], v[20:21]
    v_lshlrev_b32 v20, 16, v30
    v_and_b32 v21, s29, v30
    v_pk_add_f32 v[16:17], v[16:17], v[20:21]
    v_lshlrev_b32 v20, 16, v31
    v_and_b32 v21, s29, v31
    v_pk_add_f32 v[18:19], v[18:19], v[20:21]
    s_waitcnt vmcnt(34)
    v_lshlrev_b32 v20, 16, v32
    v_and_b32 v21, s29, v32
    v_pk_add_f32 v[12:13], v[12:13], v[20:21]
    v_lshlrev_b32 v20, 16, v33
    v_and_b32 v21, s29, v33
    v_pk_add_f32 v[14:15], v[14:15], v[20:21]
    v_lshlrev_b32 v20, 16, v34
    v_and_b32 v21, s29, v34
    v_pk_add_f32 v[16:17], v[16:17], v[20:21]
    v_lshlrev_b32 v20, 16, v35
    v_and_b32 v21, s29, v35
    v_pk_add_f32 v[18:19], v[18:19], v[20:21]
    s_waitcnt vmcnt(32)
    v_lshlrev_b32 v20, 16, v36
    v_and_b32 v21, s29, v36
    v_pk_add_f32 v[12:13], v[12:13], v[20:21]
    v_lshlrev_b32 v20, 16, v37
    v_and_b32 v21, s29, v37
    v_pk_add_f32 v[14:15], v[14:15], v[20:21]
    v_lshlrev_b32 v20, 16, v38
    v_and_b32 v21, s29, v38
    v_pk_add_f32 v[16:17], v[16:17], v[20:21]
    v_lshlrev_b32 v20, 16, v39
    v_and_b32 v21, s29, v39
    v_pk_add_f32 v[18:19], v[18:19], v[20:21]
    s_waitcnt vmcnt(30)
    v_lshlrev_b32 v20, 16, v40
    v_and_b32 v21, s29, v40
    v_pk_add_f32 v[12:13], v[12:13], v[20:21]
    v_lshlrev_b32 v20, 16, v41
    v_and_b32 v21, s29, v41
    v_pk_add_f32 v[14:15], v[14:15], v[20:21]
    v_lshlrev_b32 v20, 16, v42
    v_and_b32 v21, s29, v42
    v_pk_add_f32 v[16:17], v[16:17], v[20:21]
    v_lshlrev_b32 v20, 16, v43
    v_and_b32 v21, s29, v43
    v_pk_add_f32 v[18:19], v[18:19], v[20:21]
    s_waitcnt vmcnt(28)
    v_lshlrev_b32 v20, 16, v44
    v_and_b32 v21, s29, v44
    v_pk_add_f32 v[12:13], v[12:13], v[20:21]
    v_lshlrev_b32 v20, 16, v45
    v_and_b32 v21, s29, v45
    v_pk_add_f32 v[14:15], v[14:15], v[20:21]
    v_lshlrev_b32 v20, 16, v46
    v_and_b32 v21, s29, v46
    v_pk_add_f32 v[16:17], v[16:17], v[20:21]
    v_lshlrev_b32 v20, 16, v47
    v_and_b32 v21, s29, v47
    v_pk_add_f32 v[18:19], v[18:19], v[20:21]
    s_waitcnt vmcnt(26)
    v_lshlrev_b32 v20, 16, v48
    v_and_b32 v21, s29, v48
    v_pk_add_f32 v[12:13], v[12:13], v[20:21]
    v_lshlrev_b32 v20, 16, v49
    v_and_b32 v21, s29, v49
    v_pk_add_f32 v[14:15], v[14:15], v[20:21]
    v_lshlrev_b32 v20, 16, v50
    v_and_b32 v21, s29, v50
    v_pk_add_f32 v[16:17], v[16:17], v[20:21]
    v_lshlrev_b32 v20, 16, v51
    v_and_b32 v21, s29, v51
    v_pk_add_f32 v[18:19], v[18:19], v[20:21]
    s_waitcnt vmcnt(24)
    v_lshlrev_b32 v20, 16, v52
    v_and_b32 v21, s29, v52
    v_pk_add_f32 v[12:13], v[12:13], v[20:21]
    v_lshlrev_b32 v20, 16, v53
    v_and_b32 v21, s29, v53
    v_pk_add_f32 v[14:15], v[14:15], v[20:21]
    v_lshlrev_b32 v20, 16, v54
    v_and_b32 v21, s29, v54
    v_pk_add_f32 v[16:17], v[16:17], v[20:21]
    v_lshlrev_b32 v20, 16, v55
    v_and_b32 v21, s29, v55
    v_pk_add_f32 v[18:19], v[18:19], v[20:21]
    s_waitcnt vmcnt(22)
    v_lshlrev_b32 v20, 16, v56
    v_and_b32 v21, s29, v56
    v_pk_add_f32 v[12:13], v[12:13], v[20:21]
    v_lshlrev_b32 v20, 16, v57
    v_and_b32 v21, s29, v57
    v_pk_add_f32 v[14:15], v[14:15], v[20:21]
    v_lshlrev_b32 v20, 16, v58
    v_and_b32 v21, s29, v58
    v_pk_add_f32 v[16:17], v[16:17], v[20:21]
    v_lshlrev_b32 v20, 16, v59
    v_and_b32 v21, s29, v59
    v_pk_add_f32 v[18:19], v[18:19], v[20:21]
    s_waitcnt vmcnt(20)
    v_lshlrev_b32 v20, 16, v60
    v_and_b32 v21, s29, v60
    v_pk_add_f32 v[12:13], v[12:13], v[20:21]
    v_lshlrev_b32 v20, 16, v61
    v_and_b32 v21, s29, v61
    v_pk_add_f32 v[14:15], v[14:15], v[20:21]
    v_lshlrev_b32 v20, 16, v62
    v_and_b32 v21, s29, v62
    v_pk_add_f32 v[16:17], v[16:17], v[20:21]
    v_lshlrev_b32 v20, 16, v63
    v_and_b32 v21, s29, v63
    v_pk_add_f32 v[18:19], v[18:19], v[20:21]
    s_waitcnt vmcnt(18)
    v_lshlrev_b32 v20, 16, v64
    v_and_b32 v21, s29, v64
    v_pk_add_f32 v[12:13], v[12:13], v[20:21]
    v_lshlrev_b32 v20, 16, v65
    v_and_b32 v21, s29, v65
    v_pk_add_f32 v[14:15], v[14:15], v[20:21]
    v_lshlrev_b32 v20, 16, v66
    v_and_b32 v21, s29, v66
    v_pk_add_f32 v[16:17], v[16:17], v[20:21]
    v_lshlrev_b32 v20, 16, v67
    v_and_b32 v21, s29, v67
    v_pk_add_f32 v[18:19], v[18:19], v[20:21]
    s_waitcnt vmcnt(16)
    v_lshlrev_b32 v20, 16, v68
    v_and_b32 v21, s29, v68
    v_pk_add_f32 v[12:13], v[12:13], v[20:21]
    v_lshlrev_b32 v20, 16, v69
    v_and_b32 v21, s29, v69
    v_pk_add_f32 v[14:15], v[14:15], v[20:21]
    v_lshlrev_b32 v20, 16, v70
    v_and_b32 v21, s29, v70
    v_pk_add_f32 v[16:17], v[16:17], v[20:21]
    v_lshlrev_b32 v20, 16, v71
    v_and_b32 v21, s29, v71
    v_pk_add_f32 v[18:19], v[18:19], v[20:21]
    s_waitcnt vmcnt(14)
    v_lshlrev_b32 v20, 16, v72
    v_and_b32 v21, s29, v72
    v_pk_add_f32 v[12:13], v[12:13], v[20:21]
    v_lshlrev_b32 v20, 16, v73
    v_and_b32 v21, s29, v73
    v_pk_add_f32 v[14:15], v[14:15], v[20:21]
    v_lshlrev_b32 v20, 16, v74
    v_and_b32 v21, s29, v74
    v_pk_add_f32 v[16:17], v[16:17], v[20:21]
    v_lshlrev_b32 v20, 16, v75
    v_and_b32 v21, s29, v75
    v_pk_add_f32 v[18:19], v[18:19], v[20:21]
    s_waitcnt vmcnt(12)
    v_lshlrev_b32 v20, 16, v76
    v_and_b32 v21, s29, v76
    v_pk_add_f32 v[12:13], v[12:13], v[20:21]
    v_lshlrev_b32 v20, 16, v77
    v_and_b32 v21, s29, v77
    v_pk_add_f32 v[14:15], v[14:15], v[20:21]
    v_lshlrev_b32 v20, 16, v78
    v_and_b32 v21, s29, v78
    v_pk_add_f32 v[16:17], v[16:17], v[20:21]
    v_lshlrev_b32 v20, 16, v79
    v_and_b32 v21, s29, v79
    v_pk_add_f32 v[18:19], v[18:19], v[20:21]
    s_waitcnt vmcnt(10)
    v_lshlrev_b32 v20, 16, v80
    v_and_b32 v21, s29, v80
    v_pk_add_f32 v[12:13], v[12:13], v[20:21]
    v_lshlrev_b32 v20, 16, v81
    v_and_b32 v21, s29, v81
    v_pk_add_f32 v[14:15], v[14:15], v[20:21]
    v_lshlrev_b32 v20, 16, v82
    v_and_b32 v21, s29, v82
    v_pk_add_f32 v[16:17], v[16:17], v[20:21]
    v_lshlrev_b32 v20, 16, v83
    v_and_b32 v21, s29, v83
    v_pk_add_f32 v[18:19], v[18:19], v[20:21]
    s_waitcnt vmcnt(8)
    v_lshlrev_b32 v20, 16, v84
    v_and_b32 v21, s29, v84
    v_pk_add_f32 v[12:13], v[12:13], v[20:21]
    v_lshlrev_b32 v20, 16, v85
    v_and_b32 v21, s29, v85
    v_pk_add_f32 v[14:15], v[14:15], v[20:21]
    v_lshlrev_b32 v20, 16, v86
    v_and_b32 v21, s29, v86
    v_pk_add_f32 v[16:17], v[16:17], v[20:21]
    v_lshlrev_b32 v20, 16, v87
    v_and_b32 v21, s29, v87
    v_pk_add_f32 v[18:19], v[18:19], v[20:21]
    s_waitcnt vmcnt(6)
    v_lshlrev_b32 v20, 16, v88
    v_and_b32 v21, s29, v88
    v_pk_add_f32 v[12:13], v[12:13], v[20:21]
    v_lshlrev_b32 v20, 16, v89
    v_and_b32 v21, s29, v89
    v_pk_add_f32 v[14:15], v[14:15], v[20:21]
    v_lshlrev_b32 v20, 16, v90
    v_and_b32 v21, s29, v90
    v_pk_add_f32 v[16:17], v[16:17], v[20:21]
    v_lshlrev_b32 v20, 16, v91
    v_and_b32 v21, s29, v91
    v_pk_add_f32 v[18:19], v[18:19], v[20:21]
    s_waitcnt vmcnt(4)
    v_lshlrev_b32 v20, 16, v92
    v_and_b32 v21, s29, v92
    v_pk_add_f32 v[12:13], v[12:13], v[20:21]
    v_lshlrev_b32 v20, 16, v93
    v_and_b32 v21, s29, v93
    v_pk_add_f32 v[14:15], v[14:15], v[20:21]
    v_lshlrev_b32 v20, 16, v94
    v_and_b32 v21, s29, v94
    v_pk_add_f32 v[16:17], v[16:17], v[20:21]
    v_lshlrev_b32 v20, 16, v95
    v_and_b32 v21, s29, v95
    v_pk_add_f32 v[18:19], v[18:19], v[20:21]
    s_waitcnt vmcnt(2)
    v_lshlrev_b32 v20, 16, v96
    v_and_b32 v21, s29, v96
    v_pk_add_f32 v[12:13], v[12:13], v[20:21]
    v_lshlrev_b32 v20, 16, v97
    v_and_b32 v21, s29, v97
    v_pk_add_f32 v[14:15], v[14:15], v[20:21]
    v_lshlrev_b32 v20, 16, v98
    v_and_b32 v21, s29, v98
    v_pk_add_f32 v[16:17], v[16:17], v[20:21]
    v_lshlrev_b32 v20, 16, v99
    v_and_b32 v21, s29, v99
    v_pk_add_f32 v[18:19], v[18:19], v[20:21]
    s_waitcnt vmcnt(0)
    v_lshlrev_b32 v20, 16, v100
    v_and_b32 v21, s29, v100
    v_pk_add_f32 v[12:13], v[12:13], v[20:21]
    v_lshlrev_b32 v20, 16, v101
    v_and_b32 v21, s29, v101
    v_pk_add_f32 v[14:15], v[14:15], v[20:21]
    v_lshlrev_b32 v20, 16, v102
    v_and_b32 v21, s29, v102
    v_pk_add_f32 v[16:17], v[16:17], v[20:21]
    v_lshlrev_b32 v20, 16, v103
    v_and_b32 v21, s29, v103
    v_pk_add_f32 v[18:19], v[18:19], v[20:21]
    v_lshlrev_b32 v3, 8, v2
    v_lshl_add_u32 v3, v1, 5, v3
    ds_write_b128 v3, v[12:15]
    ds_write_b128 v3, v[16:19] offset:16
    s_waitcnt lgkmcnt(0)
    s_barrier
    v_cmp_gt_u32 vcc, 64, v0
    s_and_saveexec_b64 s[32:33], vcc
    s_cbranch_execz L_prep_kernel_end
    v_lshlrev_b32 v3, 2, v0
    v_mov_b32 v12, 0
    ds_read_b32 v8, v3 offset:0
    ds_read_b32 v9, v3 offset:256
    ds_read_b32 v10, v3 offset:512
    ds_read_b32 v11, v3 offset:768
    s_waitcnt lgkmcnt(0)
    v_add_f32 v12, v12, v8
    v_add_f32 v12, v12, v9
    v_add_f32 v12, v12, v10
    v_add_f32 v12, v12, v11
    ds_read_b32 v8, v3 offset:1024
    ds_read_b32 v9, v3 offset:1280
    ds_read_b32 v10, v3 offset:1536
    ds_read_b32 v11, v3 offset:1792
    s_waitcnt lgkmcnt(0)
    v_add_f32 v12, v12, v8
    v_add_f32 v12, v12, v9
    v_add_f32 v12, v12, v10
    v_add_f32 v12, v12, v11
    ds_read_b32 v8, v3 offset:2048
    ds_read_b32 v9, v3 offset:2304
    ds_read_b32 v10, v3 offset:2560
    ds_read_b32 v11, v3 offset:2816
    s_waitcnt lgkmcnt(0)
    v_add_f32 v12, v12, v8
    v_add_f32 v12, v12, v9
    v_add_f32 v12, v12, v10
    v_add_f32 v12, v12, v11
    ds_read_b32 v8, v3 offset:3072
    ds_read_b32 v9, v3 offset:3328
    ds_read_b32 v10, v3 offset:3584
    ds_read_b32 v11, v3 offset:3840
    s_waitcnt lgkmcnt(0)
    v_add_f32 v12, v12, v8
    v_add_f32 v12, v12, v9
    v_add_f32 v12, v12, v10
    v_add_f32 v12, v12, v11
    ds_read_b32 v8, v3 offset:4096
    ds_read_b32 v9, v3 offset:4352
    ds_read_b32 v10, v3 offset:4608
    ds_read_b32 v11, v3 offset:4864
    s_waitcnt lgkmcnt(0)
    v_add_f32 v12, v12, v8
    v_add_f32 v12, v12, v9
    v_add_f32 v12, v12, v10
    v_add_f32 v12, v12, v11
    ds_read_b32 v8, v3 offset:5120
    ds_read_b32 v9, v3 offset:5376
    ds_read_b32 v10, v3 offset:5632
    ds_read_b32 v11, v3 offset:5888
    s_waitcnt lgkmcnt(0)
    v_add_f32 v12, v12, v8
    v_add_f32 v12, v12, v9
    v_add_f32 v12, v12, v10
    v_add_f32 v12, v12, v11
    ds_read_b32 v8, v3 offset:6144
    ds_read_b32 v9, v3 offset:6400
    ds_read_b32 v10, v3 offset:6656
    ds_read_b32 v11, v3 offset:6912
    s_waitcnt lgkmcnt(0)
    v_add_f32 v12, v12, v8
    v_add_f32 v12, v12, v9
    v_add_f32 v12, v12, v10
    v_add_f32 v12, v12, v11
    ds_read_b32 v8, v3 offset:7168
    ds_read_b32 v9, v3 offset:7424
    ds_read_b32 v10, v3 offset:7680
    ds_read_b32 v11, v3 offset:7936
    s_waitcnt lgkmcnt(0)
    v_add_f32 v12, v12, v8
    v_add_f32 v12, v12, v9
    v_add_f32 v12, v12, v10
    v_add_f32 v12, v12, v11
    s_lshl_b32 s28, s3, 8
    v_add_u32 v3, s28, v3
    v_add_u32 v3, 2816, v3
    v_cmp_gt_u32 vcc, 20, v0
    s_nop 1
    v_cndmask_b32 v12, 0, v12, vcc
    buffer_store_dword v12, v3, s[12:15], 0 offen
    s_endpgm
L_prep_kernel_notv:
L_prep_kernel_end:
    s_endpgm
.globl qkv1_kernel
.p2align 8
.type qkv1_kernel,@function
qkv1_kernel:
    s_cmp_ge_u32 s2, 192
    s_cbranch_scc1 L_qkv1_kernel_end
    s_load_dwordx2 s[4:5], s[0:1], 0
    s_load_dwordx2 s[6:7], s[0:1], 88
    s_load_dwordx2 s[40:41], s[0:1], 8
    s_and_b32 s28, s2, 7
    s_mul_i32 s28, s28, 24
    s_lshr_b32 s29, s2, 3
    s_add_u32 s28, s28, s29
    s_lshr_b32 s29, s28, 5
    s_and_b32 s28, s28, 31
    v_lshrrev_b32 v1, 6, v0
    v_and_b32 v5, 63, v0
    v_readfirstlane_b32 s39, v1
    v_and_b32 v6, 31, v0
    v_lshrrev_b32 v7, 5, v5
    s_waitcnt lgkmcnt(0)
    s_and_b32 s37, s39, 1
    s_lshr_b32 s38, s39, 1
    s_add_u32 s24, s6, 0x1628000
    s_addc_u32 s25, s7, 0
    s_mov_b32 s26, 0x50000
    s_mov_b32 s27, 0x20000
    s_mul_i32 s3, s28, 64
    s_mul_i32 s50, s38, 32
    s_add_u32 s3, s3, s50
    v_add_u32 v2, s3, v6
    v_mul_u32_u24 v2, 160, v2
    s_mov_b32 s50, 5120
    buffer_load_dwordx4 v[8:11], v2, s[24:27], 0 offen offset:0
    buffer_load_dwordx4 v[12:15], v2, s[24:27], 0 offen offset:16
    buffer_load_dwordx4 v[16:19], v2, s[24:27], 0 offen offset:32
    buffer_load_dwordx4 v[20:23], v2, s[24:27], 0 offen offset:48
    buffer_load_dwordx4 v[24:27], v2, s[24:27], 0 offen offset:64
    buffer_load_dwordx4 v[28:31], v2, s[24:27], 0 offen offset:80
    buffer_load_dwordx4 v[32:35], v2, s[24:27], 0 offen offset:96
    buffer_load_dwordx4 v[36:39], v2, s[24:27], 0 offen offset:112
    buffer_load_dwordx4 v[40:43], v2, s[24:27], 0 offen offset:128
    buffer_load_dwordx4 v[44:47], v2, s[24:27], 0 offen offset:144
    s_mov_b32 s8, s4
    s_mov_b32 s9, s5
    s_mov_b32 s10, 0x280000
    s_mov_b32 s11, 0x20000
    s_mul_i32 s30, s28, 81920
    s_lshl_b32 s3, s29, 8
    s_add_u32 s12, s40, s3
    s_addc_u32 s13, s41, 0
    s_sub_u32 s14, 0xc8000, s3
    s_mov_b32 s33, 0x500
    s_cmp_lt_u32 s29, 5
    s_cbranch_scc1 L_qkv1_kernel_wq
    s_add_u32 s12, s6, 0x540000
    s_addc_u32 s13, s7, 0
    s_mov_b32 s14, 0x28000
    s_mov_b32 s33, 256
L_qkv1_kernel_wq:
    s_mov_b32 s15, 0x20000
    s_add_u32 s16, s12, 128
    s_addc_u32 s17, s13, 0
    s_sub_u32 s18, s14, 128
    s_mov_b32 s19, 0x20000
    s_lshl_b32 s32, s33, 6
    s_mov_b32 s31, 0
    s_mul_i32 s34, s39, 2048
    s_lshl_b32 s35, s39, 11
    s_add_u32 s35, s35, 8192
    v_lshrrev_b32 v1, 3, v5
    v_lshrrev_b32 v2, 4, v5
    v_and_b32 v3, 7, v5
    s_mul_i32 s3, s39, 16
    v_add_u32 v4, 0, v2
    v_and_b32 v4, 7, v4
    v_xor_b32 v4, v4, v3
    v_add_u32 v64, s3, v1
    v_mul_u32_u24 v64, 0x500, v64
    v_lshl_add_u32 v64, v4, 4, v64
    v_add_u32 v4, 4, v2
    v_and_b32 v4, 7, v4
    v_xor_b32 v4, v4, v3
    v_add_u32 v65, s3, v1
    v_add_u32 v65, 8, v65
    v_mul_u32_u24 v65, 0x500, v65
    v_lshl_add_u32 v65, v4, 4, v65
    v_subrev_u32 v65, 1024, v65
    v_and_b32 v4, 1, v2
    v_lshlrev_b32 v4, 2, v4
    v_xor_b32 v4, v4, v3
    s_lshl_b32 s3, s39, 4
    v_add_u32 v66, s3, v1
    v_mul_lo_u32 v66, v66, s33
    v_lshl_add_u32 v66, v4, 4, v66
    v_add_u32 v67, s3, v1
    v_add_u32 v67, 8, v67
    v_mul_lo_u32 v67, v67, s33
    v_lshl_add_u32 v67, v4, 4, v67
    v_subrev_u32 v67, 1024, v67
    s_mul_i32 s3, s38, 32
    v_add_u32 v1, s3, v6
    v_lshlrev_b32 v1, 7, v1
    v_bfe_u32 v2, v5, 1, 3
    v_add_u32 v3, 0, v7
    v_xor_b32 v3, v3, v2
    v_lshl_add_u32 v68, v3, 4, v1
    v_add_u32 v3, 2, v7
    v_xor_b32 v3, v3, v2
    v_lshl_add_u32 v69, v3, 4, v1
    v_add_u32 v3, 4, v7
    v_xor_b32 v3, v3, v2
    v_lshl_add_u32 v70, v3, 4, v1
    v_add_u32 v3, 6, v7
    v_xor_b32 v3, v3, v2
    v_lshl_add_u32 v71, v3, 4, v1
    v_lshrrev_b32 v1, 5, v5
    v_lshlrev_b32 v1, 3, v1
    v_bfe_u32 v2, v5, 2, 2
    v_add_u32 v1, v1, v2
    v_lshlrev_b32 v72, 7, v1
    v_bfe_u32 v1, v5, 4, 1
    v_lshlrev_b32 v1, 1, v1
    v_bfe_u32 v2, v5, 1, 1
    v_add_u32 v1, v1, v2
    s_lshl_b32 s3, s37, 2
    v_add_u32 v1, s3, v1
    v_bfe_u32 v2, v5, 3, 1
    v_lshlrev_b32 v2, 2, v2
    v_xor_b32 v1, v1, v2
    v_lshl_add_u32 v72, v1, 4, v72
    v_and_b32 v1, 1, v5
    v_lshl_add_u32 v72, v1, 3, v72
    v_add_u32 v72, 8192, v72
    s_mov_b32 s36, 0
    s_mov_b32 s58, 0
    s_add_u32 m0, s36, s34
    s_nop 0
    buffer_load_dwordx4 v64, s[8:11], s30 offen offset:0 lds
    buffer_load_dwordx4 v65, s[8:11], s30 offen offset:1024 lds
    s_add_u32 m0, s36, s35
    s_nop 0
    buffer_load_dwordx4 v66, s[12:15], s31 offen lds
    buffer_load_dwordx4 v67, s[12:15], s31 offen offset:1024 lds
    s_add_u32 m0, m0, 0x2000
    s_nop 0
    buffer_load_dwordx4 v66, s[16:19], s31 offen lds
    buffer_load_dwordx4 v67, s[16:19], s31 offen offset:1024 lds
    s_add_u32 s30, s30, 128
    s_add_u32 s31, s31, s32
    s_add_u32 s36, s36, 24576
    s_add_u32 s58, s58, 1
    s_cmp_eq_u32 s58, 3
    s_cselect_b32 s36, 0, s36
    s_cselect_b32 s58, 0, s58
    s_add_u32 m0, s36, s34
    s_nop 0
    buffer_load_dwordx4 v64, s[8:11], s30 offen offset:0 lds
    buffer_load_dwordx4 v65, s[8:11], s30 offen offset:1024 lds
    s_add_u32 m0, s36, s35
    s_nop 0
    buffer_load_dwordx4 v66, s[12:15], s31 offen lds
    buffer_load_dwordx4 v67, s[12:15], s31 offen offset:1024 lds
    s_add_u32 m0, m0, 0x2000
    s_nop 0
    buffer_load_dwordx4 v66, s[16:19], s31 offen lds
    buffer_load_dwordx4 v67, s[16:19], s31 offen offset:1024 lds
    s_add_u32 s30, s30, 128
    s_add_u32 s31, s31, s32
    s_add_u32 s36, s36, 24576
    s_add_u32 s58, s58, 1
    s_cmp_eq_u32 s58, 3
    s_cselect_b32 s36, 0, s36
    s_cselect_b32 s58, 0, s58
    s_mov_b32 s59, 0
    s_mov_b32 s60, 0xffff4000
    s_mov_b32 s61, 24576
    s_mov_b32 s49, 0
    s_waitcnt vmcnt(12)
    s_mov_b32 s51, 0xffff0000
    s_mov_b32 s52, 0x3acccccd
    s_mov_b32 s53, 0x3727c5ac
    v_pk_add_f32 v[8:9], v[8:9], v[10:11]
    v_pk_add_f32 v[8:9], v[8:9], v[12:13]
    v_pk_add_f32 v[8:9], v[8:9], v[14:15]
    v_pk_add_f32 v[8:9], v[8:9], v[16:17]
    v_pk_add_f32 v[8:9], v[8:9], v[18:19]
    v_pk_add_f32 v[8:9], v[8:9], v[20:21]
    v_pk_add_f32 v[8:9], v[8:9], v[22:23]
    v_pk_add_f32 v[8:9], v[8:9], v[24:25]
    v_pk_add_f32 v[8:9], v[8:9], v[26:27]
    v_pk_add_f32 v[8:9], v[8:9], v[28:29]
    v_pk_add_f32 v[8:9], v[8:9], v[30:31]
    v_pk_add_f32 v[8:9], v[8:9], v[32:33]
    v_pk_add_f32 v[8:9], v[8:9], v[34:35]
    v_pk_add_f32 v[8:9], v[8:9], v[36:37]
    v_pk_add_f32 v[8:9], v[8:9], v[38:39]
    v_pk_add_f32 v[8:9], v[8:9], v[40:41]
    v_pk_add_f32 v[8:9], v[8:9], v[42:43]
    v_pk_add_f32 v[8:9], v[8:9], v[44:45]
    v_pk_add_f32 v[8:9], v[8:9], v[46:47]
    v_mul_f32 v8, s52, v8
    v_mul_f32 v9, s52, v9
    v_fma_f32 v9, -v8, v8, v9
    v_max_f32 v9, 0, v9
    v_cvt_pk_bf16_f32 v10, v8, v9
    v_lshlrev_b32 v8, 16, v10
    v_and_b32 v9, s51, v10
    v_add_f32 v9, s53, v9
    v_cvt_pk_bf16_f32 v9, v9, v9
    v_lshlrev_b32 v9, 16, v9
    v_sqrt_f32 v9, v9
    s_nop 0
    v_cvt_pk_bf16_f32 v9, v9, v9
    v_lshlrev_b32 v9, 16, v9
    v_rcp_f32 v10, v9
    s_nop 0
    v_fma_f32 v11, -v9, v10, 2.0
    v_mul_f32 v10, v10, v11
    v_sub_f32 v74, 0, v8
    v_sub_f32 v75, 0, v8
    v_mov_b32 v76, v10
    v_mov_b32 v77, v10
    v_mov_b32 v8, 0
    v_mov_b32 v9, 0
    v_mov_b32 v10, 0
    v_mov_b32 v11, 0
    v_mov_b32 v12, 0
    v_mov_b32 v13, 0
    v_mov_b32 v14, 0
    v_mov_b32 v15, 0
    v_mov_b32 v16, 0
    v_mov_b32 v17, 0
    v_mov_b32 v18, 0
    v_mov_b32 v19, 0
    v_mov_b32 v20, 0
    v_mov_b32 v21, 0
    v_mov_b32 v22, 0
    v_mov_b32 v23, 0
    v_mov_b32 v24, 0
    v_mov_b32 v25, 0
    v_mov_b32 v26, 0
    v_mov_b32 v27, 0
    v_mov_b32 v28, 0
    v_mov_b32 v29, 0
    v_mov_b32 v30, 0
    v_mov_b32 v31, 0
    v_mov_b32 v32, 0
    v_mov_b32 v33, 0
    v_mov_b32 v34, 0
    v_mov_b32 v35, 0
    v_mov_b32 v36, 0
    v_mov_b32 v37, 0
    v_mov_b32 v38, 0
    v_mov_b32 v39, 0
L_qkv1_kernel_loop:
    s_waitcnt vmcnt(6)
    s_barrier
    s_add_u32 m0, s36, s34
    s_nop 0
    buffer_load_dwordx4 v64, s[8:11], s30 offen offset:0 lds
    buffer_load_dwordx4 v65, s[8:11], s30 offen offset:1024 lds
    s_add_u32 m0, s36, s35
    s_nop 0
    buffer_load_dwordx4 v66, s[12:15], s31 offen lds
    buffer_load_dwordx4 v67, s[12:15], s31 offen offset:1024 lds
    s_add_u32 m0, m0, 0x2000
    s_nop 0
    buffer_load_dwordx4 v66, s[16:19], s31 offen lds
    buffer_load_dwordx4 v67, s[16:19], s31 offen offset:1024 lds
    s_add_u32 s30, s30, 128
    s_add_u32 s31, s31, s32
    s_add_u32 s36, s36, 24576
    s_add_u32 s58, s58, 1
    s_cmp_eq_u32 s58, 3
    s_cselect_b32 s36, 0, s36
    s_cselect_b32 s58, 0, s58
    ds_read_b128 v[48:51], v68 offset:0
    ds_read_b64_tr_b16 v[40:41], v72 offset:0
    ds_read_b64_tr_b16 v[42:43], v72 offset:512
    ds_read_b64_tr_b16 v[44:45], v72 offset:8192
    ds_read_b64_tr_b16 v[46:47], v72 offset:8704
    ds_read_b128 v[60:63], v69 offset:0
    ds_read_b64_tr_b16 v[52:53], v72 offset:2048
    ds_read_b64_tr_b16 v[54:55], v72 offset:2560
    ds_read_b64_tr_b16 v[56:57], v72 offset:10240
    ds_read_b64_tr_b16 v[58:59], v72 offset:10752
    s_waitcnt lgkmcnt(5)
    v_mfma_f32_32x32x16_bf16 v[8:23], v[40:43], v[48:51], v[8:23]
    v_mfma_f32_32x32x16_bf16 v[24:39], v[44:47], v[48:51], v[24:39]
    ds_read_b128 v[48:51], v70 offset:0
    ds_read_b64_tr_b16 v[40:41], v72 offset:4096
    ds_read_b64_tr_b16 v[42:43], v72 offset:4608
    ds_read_b64_tr_b16 v[44:45], v72 offset:12288
    ds_read_b64_tr_b16 v[46:47], v72 offset:12800
    s_waitcnt lgkmcnt(5)
    v_mfma_f32_32x32x16_bf16 v[8:23], v[52:55], v[60:63], v[8:23]
    v_mfma_f32_32x32x16_bf16 v[24:39], v[56:59], v[60:63], v[24:39]
    ds_read_b128 v[60:63], v71 offset:0
    ds_read_b64_tr_b16 v[52:53], v72 offset:6144
    ds_read_b64_tr_b16 v[54:55], v72 offset:6656
    ds_read_b64_tr_b16 v[56:57], v72 offset:14336
    ds_read_b64_tr_b16 v[58:59], v72 offset:14848
    s_waitcnt lgkmcnt(5)
    v_mfma_f32_32x32x16_bf16 v[8:23], v[40:43], v[48:51], v[8:23]
    v_mfma_f32_32x32x16_bf16 v[24:39], v[44:47], v[48:51], v[24:39]
    s_waitcnt lgkmcnt(0)
    v_mfma_f32_32x32x16_bf16 v[8:23], v[52:55], v[60:63], v[8:23]
    v_mfma_f32_32x32x16_bf16 v[24:39], v[56:59], v[60:63], v[24:39]
    s_add_u32 s59, s59, 1
    s_cmp_eq_u32 s59, 3
    s_cselect_b32 s48, s60, s61
    s_cselect_b32 s59, 0, s59
    v_add_u32 v68, s48, v68
    v_add_u32 v69, s48, v69
    v_add_u32 v70, s48, v70
    v_add_u32 v71, s48, v71
    v_add_u32 v72, s48, v72
    s_add_u32 s49, s49, 1
    s_cmp_lt_u32 s49, 10
    s_cbranch_scc1 L_qkv1_kernel_loop
    s_waitcnt vmcnt(0)
    s_mul_i32 s3, s28, 64
    s_mul_i32 s50, s38, 32
    s_add_u32 s3, s3, s50
    v_add_u32 v1, s3, v6
    s_mov_b32 s51, 0xffff0000
    s_add_u32 s24, s6, 0x1678000
    s_addc_u32 s25, s7, 0
    s_mov_b32 s26, 0xc00
    s_mov_b32 s27, 0x20000
    s_lshl_b32 s3, s29, 9
    s_lshl_b32 s50, s37, 7
    s_add_u32 s3, s3, s50
    v_lshlrev_b32 v3, 4, v7
    v_add_u32 v3, s3, v3
    buffer_load_dwordx4 v[80:83], v3, s[24:27], 0 offen offset:0
    buffer_load_dwordx4 v[84:87], v3, s[24:27], 0 offen offset:32
    buffer_load_dwordx4 v[88:91], v3, s[24:27], 0 offen offset:64
    buffer_load_dwordx4 v[92:95], v3, s[24:27], 0 offen offset:96
    s_add_u32 s24, s6, 0x1678000
    s_addc_u32 s25, s7, 0
    s_mov_b32 s26, 0xc00
    s_mov_b32 s27, 0x20000
    s_lshl_b32 s3, s29, 9
    s_lshl_b32 s50, s37, 7
    s_add_u32 s3, s3, s50
    s_add_u32 s3, s3, 256
    v_lshlrev_b32 v3, 4, v7
    v_add_u32 v3, s3, v3
    buffer_load_dwordx4 v[96:99], v3, s[24:27], 0 offen offset:0
    buffer_load_dwordx4 v[100:103], v3, s[24:27], 0 offen offset:32
    buffer_load_dwordx4 v[104:107], v3, s[24:27], 0 offen offset:64
    buffer_load_dwordx4 v[108:111], v3, s[24:27], 0 offen offset:96
    s_waitcnt vmcnt(0)
    v_pk_fma_f32 v[8:9], v[80:81], v[74:75], v[8:9]
    v_pk_fma_f32 v[10:11], v[82:83], v[74:75], v[10:11]
    v_pk_mul_f32 v[8:9], v[8:9], v[76:77]
    v_pk_mul_f32 v[10:11], v[10:11], v[76:77]
    v_pk_fma_f32 v[12:13], v[84:85], v[74:75], v[12:13]
    v_pk_fma_f32 v[14:15], v[86:87], v[74:75], v[14:15]
    v_pk_mul_f32 v[12:13], v[12:13], v[76:77]
    v_pk_mul_f32 v[14:15], v[14:15], v[76:77]
    v_pk_fma_f32 v[16:17], v[88:89], v[74:75], v[16:17]
    v_pk_fma_f32 v[18:19], v[90:91], v[74:75], v[18:19]
    v_pk_mul_f32 v[16:17], v[16:17], v[76:77]
    v_pk_mul_f32 v[18:19], v[18:19], v[76:77]
    v_pk_fma_f32 v[20:21], v[92:93], v[74:75], v[20:21]
    v_pk_fma_f32 v[22:23], v[94:95], v[74:75], v[22:23]
    v_pk_mul_f32 v[20:21], v[20:21], v[76:77]
    v_pk_mul_f32 v[22:23], v[22:23], v[76:77]
    v_pk_fma_f32 v[24:25], v[96:97], v[74:75], v[24:25]
    v_pk_fma_f32 v[26:27], v[98:99], v[74:75], v[26:27]
    v_pk_mul_f32 v[24:25], v[24:25], v[76:77]
    v_pk_mul_f32 v[26:27], v[26:27], v[76:77]
    v_pk_fma_f32 v[28:29], v[100:101], v[74:75], v[28:29]
    v_pk_fma_f32 v[30:31], v[102:103], v[74:75], v[30:31]
    v_pk_mul_f32 v[28:29], v[28:29], v[76:77]
    v_pk_mul_f32 v[30:31], v[30:31], v[76:77]
    v_pk_fma_f32 v[32:33], v[104:105], v[74:75], v[32:33]
    v_pk_fma_f32 v[34:35], v[106:107], v[74:75], v[34:35]
    v_pk_mul_f32 v[32:33], v[32:33], v[76:77]
    v_pk_mul_f32 v[34:35], v[34:35], v[76:77]
    v_pk_fma_f32 v[36:37], v[108:109], v[74:75], v[36:37]
    v_pk_fma_f32 v[38:39], v[110:111], v[74:75], v[38:39]
    v_pk_mul_f32 v[36:37], v[36:37], v[76:77]
    v_pk_mul_f32 v[38:39], v[38:39], v[76:77]
    s_cmp_ge_u32 s29, 5
    s_cbranch_scc1 L_qkv1_kernel_kv
    s_add_u32 s20, s6, 0x280000
    s_addc_u32 s21, s7, 0
    s_mov_b32 s22, 0x280000
    s_mov_b32 s23, 0x20000
    v_mul_u32_u24 v2, 0x500, v1
    s_lshl_b32 s3, s29, 8
    s_lshl_b32 s50, s37, 6
    s_add_u32 s3, s3, s50
    v_add_u32 v2, s3, v2
    v_lshl_add_u32 v2, v7, 3, v2
    s_mov_b32 s52, 0xa000
    s_mov_b32 s54, 0x3ea52b5c
    s_mov_b32 s55, 0x3ea52b5c
    v_pk_mul_f32 v[8:9], v[8:9], s[54:55]
    v_pk_mul_f32 v[10:11], v[10:11], s[54:55]
    v_cvt_pk_bf16_f32 v8, v8, v9
    v_cvt_pk_bf16_f32 v9, v10, v11
    buffer_store_dwordx2 v[8:9], v2, s[20:23], 0 offen offset:0
    v_pk_mul_f32 v[12:13], v[12:13], s[54:55]
    v_pk_mul_f32 v[14:15], v[14:15], s[54:55]
    v_cvt_pk_bf16_f32 v12, v12, v13
    v_cvt_pk_bf16_f32 v13, v14, v15
    buffer_store_dwordx2 v[12:13], v2, s[20:23], 0 offen offset:16
    v_pk_mul_f32 v[16:17], v[16:17], s[54:55]
    v_pk_mul_f32 v[18:19], v[18:19], s[54:55]
    v_cvt_pk_bf16_f32 v16, v16, v17
    v_cvt_pk_bf16_f32 v17, v18, v19
    buffer_store_dwordx2 v[16:17], v2, s[20:23], 0 offen offset:32
    v_pk_mul_f32 v[20:21], v[20:21], s[54:55]
    v_pk_mul_f32 v[22:23], v[22:23], s[54:55]
    v_cvt_pk_bf16_f32 v20, v20, v21
    v_cvt_pk_bf16_f32 v21, v22, v23
    buffer_store_dwordx2 v[20:21], v2, s[20:23], 0 offen offset:48
    v_pk_mul_f32 v[24:25], v[24:25], s[54:55]
    v_pk_mul_f32 v[26:27], v[26:27], s[54:55]
    v_cvt_pk_bf16_f32 v24, v24, v25
    v_cvt_pk_bf16_f32 v25, v26, v27
    buffer_store_dwordx2 v[24:25], v2, s[20:23], 0 offen offset:128
    v_pk_mul_f32 v[28:29], v[28:29], s[54:55]
    v_pk_mul_f32 v[30:31], v[30:31], s[54:55]
    v_cvt_pk_bf16_f32 v28, v28, v29
    v_cvt_pk_bf16_f32 v29, v30, v31
    buffer_store_dwordx2 v[28:29], v2, s[20:23], 0 offen offset:144
    v_pk_mul_f32 v[32:33], v[32:33], s[54:55]
    v_pk_mul_f32 v[34:35], v[34:35], s[54:55]
    v_cvt_pk_bf16_f32 v32, v32, v33
    v_cvt_pk_bf16_f32 v33, v34, v35
    buffer_store_dwordx2 v[32:33], v2, s[20:23], 0 offen offset:160
    v_pk_mul_f32 v[36:37], v[36:37], s[54:55]
    v_pk_mul_f32 v[38:39], v[38:39], s[54:55]
    v_cvt_pk_bf16_f32 v36, v36, v37
    v_cvt_pk_bf16_f32 v37, v38, v39
    buffer_store_dwordx2 v[36:37], v2, s[20:23], 0 offen offset:176
    s_endpgm
L_qkv1_kernel_kv:
    s_cmp_lg_u32 s37, 0
    s_cbranch_scc1 L_qkv1_kernel_end
    s_add_u32 s20, s6, 0x500000
    s_addc_u32 s21, s7, 0
    s_mov_b32 s22, 0x20000
    s_mov_b32 s23, 0x20000
    s_add_u32 s24, s6, 0x520000
    s_addc_u32 s25, s7, 0
    s_mov_b32 s26, 0x20000
    s_mov_b32 s27, 0x20000
    s_mov_b32 s56, 0
    s_mov_b32 s57, -1
    v_mov_b32 v4, 0
    v_mov_b32 v112, 0x3f80
    v_add_u32 v2, 0, v1
    v_lshlrev_b32 v2, 6, v2
    v_lshl_add_u32 v2, v7, 3, v2
    v_cvt_pk_bf16_f32 v8, v8, v9
    v_cvt_pk_bf16_f32 v9, v10, v11
    v_cvt_pk_bf16_f32 v12, v12, v13
    v_cvt_pk_bf16_f32 v13, v14, v15
    v_cvt_pk_bf16_f32 v16, v16, v17
    v_cvt_pk_bf16_f32 v17, v18, v19
    v_cndmask_b32 v16, v16, v112, s[56:57]
    v_cndmask_b32 v17, v17, v4, s[56:57]
    v_mov_b32 v20, 0
    v_mov_b32 v21, 0
    buffer_store_dwordx2 v[8:9], v2, s[20:23], 0 offen offset:0
    buffer_store_dwordx2 v[12:13], v2, s[20:23], 0 offen offset:16
    buffer_store_dwordx2 v[16:17], v2, s[20:23], 0 offen offset:32
    buffer_store_dwordx2 v[20:21], v2, s[20:23], 0 offen offset:48
    v_add_u32 v2, 0, v1
    v_lshrrev_b32 v3, 5, v2
    v_lshlrev_b32 v3, 11, v3
    v_and_b32 v114, 0x13, v2
    v_bfe_u32 v115, v2, 2, 1
    v_lshl_add_u32 v114, v115, 3, v114
    v_bfe_u32 v115, v2, 3, 1
    v_lshl_add_u32 v114, v115, 2, v114
    v_lshl_add_u32 v3, v114, 1, v3
    v_lshl_add_u32 v3, v7, 8, v3
    v_cvt_pk_bf16_f32 v24, v24, v25
    v_cvt_pk_bf16_f32 v25, v26, v27
    v_cvt_pk_bf16_f32 v28, v28, v29
    v_cvt_pk_bf16_f32 v29, v30, v31
    v_cvt_pk_bf16_f32 v32, v32, v33
    v_cvt_pk_bf16_f32 v33, v34, v35
    v_cndmask_b32 v32, v32, v112, s[56:57]
    v_cndmask_b32 v33, v33, v4, s[56:57]
    v_mov_b32 v36, 0
    v_mov_b32 v37, 0
    buffer_store_short v24, v3, s[24:27], 0 offen offset:0
    buffer_store_short_d16_hi v24, v3, s[24:27], 0 offen offset:64
    buffer_store_short v25, v3, s[24:27], 0 offen offset:128
    buffer_store_short_d16_hi v25, v3, s[24:27], 0 offen offset:192
    buffer_store_short v28, v3, s[24:27], 0 offen offset:512
    buffer_store_short_d16_hi v28, v3, s[24:27], 0 offen offset:576
    buffer_store_short v29, v3, s[24:27], 0 offen offset:640
    buffer_store_short_d16_hi v29, v3, s[24:27], 0 offen offset:704
    buffer_store_short v32, v3, s[24:27], 0 offen offset:1024
    buffer_store_short_d16_hi v32, v3, s[24:27], 0 offen offset:1088
    buffer_store_short v33, v3, s[24:27], 0 offen offset:1152
    buffer_store_short_d16_hi v33, v3, s[24:27], 0 offen offset:1216
    buffer_store_short v36, v3, s[24:27], 0 offen offset:1536
    buffer_store_short_d16_hi v36, v3, s[24:27], 0 offen offset:1600
    buffer_store_short v37, v3, s[24:27], 0 offen offset:1664
    buffer_store_short_d16_hi v37, v3, s[24:27], 0 offen offset:1728
L_qkv1_kernel_end:
    s_endpgm
.globl attn1_kernel
.p2align 8
.type attn1_kernel,@function
attn1_kernel:
    s_cmp_ge_u32 s2, 1024
    s_cbranch_scc1 L_attn1_kernel_end
    s_load_dwordx2 s[6:7], s[0:1], 88
    v_and_b32 v1, 63, v0
    v_lshrrev_b32 v4, 6, v0
    v_and_b32 v2, 31, v0
    v_readfirstlane_b32 s39, v4
    v_lshrrev_b32 v3, 5, v1
    s_waitcnt lgkmcnt(0)
    s_add_u32 s8, s6, 0x280000
    s_addc_u32 s9, s7, 0
    s_mov_b32 s10, 0x280000
    s_mov_b32 s11, 0x20000
    s_add_u32 s12, s6, 0x500000
    s_addc_u32 s13, s7, 0
    s_mov_b32 s14, 0x20000
    s_mov_b32 s15, 0x20000
    s_add_u32 s16, s6, 0x520000
    s_addc_u32 s17, s7, 0
    s_mov_b32 s18, 0x20000
    s_mov_b32 s19, 0x20000
    s_add_u32 s20, s6, 0x568000
    s_addc_u32 s21, s7, 0
    s_mov_b32 s22, 0x280000
    s_mov_b32 s23, 0x20000
    s_lshl_b32 s3, s2, 6
    v_add_u32 v4, s3, v2
    v_add_u32 v5, 0, v4
    v_mul_u32_u24 v5, 40, v5
    v_lshl_add_u32 v6, v3, 4, v5
    buffer_load_dwordx4 v[8:11], v6, s[8:11], 0 offen
    v_lshl_add_u32 v6, v3, 28, v5
    buffer_load_dwordx2 v[16:17], v6, s[8:11], 0 offen offset:32
    v_mov_b32 v18, 0
    v_mov_b32 v19, 0
    v_add_u32 v5, 32, v4
    v_mul_u32_u24 v5, 40, v5
    v_lshl_add_u32 v6, v3, 4, v5
    buffer_load_dwordx4 v[12:15], v6, s[8:11], 0 offen
    v_lshl_add_u32 v6, v3, 28, v5
    buffer_load_dwordx2 v[20:21], v6, s[8:11], 0 offen offset:32
    v_mov_b32 v22, 0
    v_mov_b32 v23, 0
    v_lshlrev_b32 v104, 6, v2
    v_lshl_add_u32 v104, v3, 4, v104
    v_mov_b32 v105, v104
    s_lshl_b32 s30, s39, 15
    s_mov_b32 s31, s30
    buffer_load_dwordx4 v[88:91], v104, s[12:15], s30 offen
    buffer_load_dwordx4 v[92:95], v104, s[12:15], s30 offen offset:32
    buffer_load_dwordx4 v[96:99], v105, s[16:19], s31 offen
    buffer_load_dwordx4 v[100:103], v105, s[16:19], s31 offen offset:32
    v_mov_b32 v56, 0
    v_mov_b32 v57, 0
    v_mov_b32 v58, 0
    v_mov_b32 v59, 0
    v_mov_b32 v60, 0
    v_mov_b32 v61, 0
    v_mov_b32 v62, 0
    v_mov_b32 v63, 0
    v_mov_b32 v64, 0
    v_mov_b32 v65, 0
    v_mov_b32 v66, 0
    v_mov_b32 v67, 0
    v_mov_b32 v68, 0
    v_mov_b32 v69, 0
    v_mov_b32 v70, 0
    v_mov_b32 v71, 0
    v_mov_b32 v106, 0
    v_mov_b32 v108, 0xff7fffff
    v_mov_b32 v72, 0
    v_mov_b32 v73, 0
    v_mov_b32 v74, 0
    v_mov_b32 v75, 0
    v_mov_b32 v76, 0
    v_mov_b32 v77, 0
    v_mov_b32 v78, 0
    v_mov_b32 v79, 0
    v_mov_b32 v80, 0
    v_mov_b32 v81, 0
    v_mov_b32 v82, 0
    v_mov_b32 v83, 0
    v_mov_b32 v84, 0
    v_mov_b32 v85, 0
    v_mov_b32 v86, 0
    v_mov_b32 v87, 0
    v_mov_b32 v107, 0
    v_mov_b32 v109, 0xff7fffff
    v_subrev_u32 v110, 1, v3
    v_and_b32 v110, 0xffff, v110
    s_mov_b32 s32, 0
    s_waitcnt vmcnt(4)
L_attn1_kernel_loop:
    s_waitcnt vmcnt(2)
    v_mfma_f32_32x32x16_bf16 v[24:39], v[88:91], v[8:11], 0
    v_mfma_f32_32x32x16_bf16 v[24:39], v[92:95], v[16:19], v[24:39]
    v_mfma_f32_32x32x16_bf16 v[40:55], v[88:91], v[12:15], 0
    v_mfma_f32_32x32x16_bf16 v[40:55], v[92:95], v[20:23], v[40:55]
    s_add_u32 s30, s30, 0x800
    buffer_load_dwordx4 v[88:91], v104, s[12:15], s30 offen
    buffer_load_dwordx4 v[92:95], v104, s[12:15], s30 offen offset:32
    s_nop 6
    v_max3_f32 v111, v24, v25, v26
    v_max3_f32 v111, v111, v27, v28
    v_max3_f32 v111, v111, v29, v30
    v_max3_f32 v111, v111, v31, v32
    v_max3_f32 v111, v111, v33, v34
    v_max3_f32 v111, v111, v35, v36
    v_max3_f32 v111, v111, v37, v38
    v_max_f32 v111, v111, v39
    v_cmp_gt_f32 vcc, v111, v108
    s_cbranch_vccnz L_attn1_kernel_rare0
L_attn1_kernel_back0:
    v_exp_f32 v24, v24
    v_exp_f32 v25, v25
    v_exp_f32 v26, v26
    v_exp_f32 v27, v27
    v_exp_f32 v28, v28
    v_exp_f32 v29, v29
    v_exp_f32 v30, v30
    v_exp_f32 v31, v31
    v_exp_f32 v32, v32
    v_exp_f32 v33, v33
    v_exp_f32 v34, v34
    v_exp_f32 v35, v35
    v_exp_f32 v36, v36
    v_exp_f32 v37, v37
    v_exp_f32 v38, v38
    v_exp_f32 v39, v39
    v_cvt_pk_bf16_f32 v24, v24, v25
    v_cvt_pk_bf16_f32 v25, v26, v27
    v_cvt_pk_bf16_f32 v26, v28, v29
    v_cvt_pk_bf16_f32 v27, v30, v31
    v_cvt_pk_bf16_f32 v28, v32, v33
    v_cvt_pk_bf16_f32 v29, v34, v35
    v_cvt_pk_bf16_f32 v30, v36, v37
    v_cvt_pk_bf16_f32 v31, v38, v39
    s_waitcnt vmcnt(2)
    v_mfma_f32_32x32x16_bf16 v[56:71], v[96:99], v[24:27], v[56:71]
    v_mfma_f32_32x32x16_bf16 v[56:71], v[100:103], v[28:31], v[56:71]
    v_max3_f32 v111, v40, v41, v42
    v_max3_f32 v111, v111, v43, v44
    v_max3_f32 v111, v111, v45, v46
    v_max3_f32 v111, v111, v47, v48
    v_max3_f32 v111, v111, v49, v50
    v_max3_f32 v111, v111, v51, v52
    v_max3_f32 v111, v111, v53, v54
    v_max_f32 v111, v111, v55
    v_cmp_gt_f32 vcc, v111, v109
    s_cbranch_vccnz L_attn1_kernel_rare1
L_attn1_kernel_back1:
    v_exp_f32 v40, v40
    v_exp_f32 v41, v41
    v_exp_f32 v42, v42
    v_exp_f32 v43, v43
    v_exp_f32 v44, v44
    v_exp_f32 v45, v45
    v_exp_f32 v46, v46
    v_exp_f32 v47, v47
    v_exp_f32 v48, v48
    v_exp_f32 v49, v49
    v_exp_f32 v50, v50
    v_exp_f32 v51, v51
    v_exp_f32 v52, v52
    v_exp_f32 v53, v53
    v_exp_f32 v54, v54
    v_exp_f32 v55, v55
    v_cvt_pk_bf16_f32 v40, v40, v41
    v_cvt_pk_bf16_f32 v41, v42, v43
    v_cvt_pk_bf16_f32 v42, v44, v45
    v_cvt_pk_bf16_f32 v43, v46, v47
    v_cvt_pk_bf16_f32 v44, v48, v49
    v_cvt_pk_bf16_f32 v45, v50, v51
    v_cvt_pk_bf16_f32 v46, v52, v53
    v_cvt_pk_bf16_f32 v47, v54, v55
    v_mfma_f32_32x32x16_bf16 v[72:87], v[96:99], v[40:43], v[72:87]
    s_nop 0
    v_mfma_f32_32x32x16_bf16 v[72:87], v[100:103], v[44:47], v[72:87]
    s_add_u32 s31, s31, 0x800
    buffer_load_dwordx4 v[96:99], v105, s[16:19], s31 offen
    buffer_load_dwordx4 v[100:103], v105, s[16:19], s31 offen offset:32
    s_add_u32 s32, s32, 1
    s_cmp_lt_u32 s32, 16
    s_cbranch_scc1 L_attn1_kernel_loop
    s_waitcnt vmcnt(0)
    v_lshlrev_b32 v104, 2, v1
    s_mul_i32 s3, s39, 6656
    v_add_u32 v105, s3, v104
    ds_write_b32 v105, v56 offset:0
    ds_write_b32 v105, v57 offset:256
    ds_write_b32 v105, v58 offset:512
    ds_write_b32 v105, v59 offset:768
    ds_write_b32 v105, v60 offset:1024
    ds_write_b32 v105, v61 offset:1280
    ds_write_b32 v105, v62 offset:1536
    ds_write_b32 v105, v63 offset:1792
    ds_write_b32 v105, v64 offset:2048
    ds_write_b32 v105, v65 offset:2304
    ds_write_b32 v105, v66 offset:2560
    ds_write_b32 v105, v67 offset:2816
    ds_write_b32 v105, v106 offset:3072
    ds_write_b32 v105, v72 offset:3328
    ds_write_b32 v105, v73 offset:3584
    ds_write_b32 v105, v74 offset:3840
    ds_write_b32 v105, v75 offset:4096
    ds_write_b32 v105, v76 offset:4352
    ds_write_b32 v105, v77 offset:4608
    ds_write_b32 v105, v78 offset:4864
    ds_write_b32 v105, v79 offset:5120
    ds_write_b32 v105, v80 offset:5376
    ds_write_b32 v105, v81 offset:5632
    ds_write_b32 v105, v82 offset:5888
    ds_write_b32 v105, v83 offset:6144
    ds_write_b32 v105, v107 offset:6400
    s_waitcnt lgkmcnt(0)
    s_barrier
    s_cmp_ge_u32 s39, 2
    s_cbranch_scc1 L_attn1_kernel_end
    s_mul_i32 s3, s39, 3328
    v_add_u32 v104, s3, v104
    ds_read_b32 v40, v104 offset:3072
    ds_read_b32 v41, v104 offset:9728
    ds_read_b32 v42, v104 offset:16384
    ds_read_b32 v43, v104 offset:23040
    s_waitcnt lgkmcnt(0)
    v_max3_f32 v111, v40, v41, v42
    v_max_f32 v111, v111, v43
    v_sub_f32 v44, v40, v111
    v_exp_f32 v44, v44
    v_sub_f32 v45, v41, v111
    v_exp_f32 v45, v45
    v_sub_f32 v46, v42, v111
    v_exp_f32 v46, v46
    v_sub_f32 v47, v43, v111
    v_exp_f32 v47, v47
    ds_read_b32 v24, v104 offset:0
    ds_read_b32 v25, v104 offset:256
    ds_read_b32 v26, v104 offset:512
    ds_read_b32 v27, v104 offset:768
    ds_read_b32 v28, v104 offset:1024
    ds_read_b32 v29, v104 offset:1280
    ds_read_b32 v30, v104 offset:1536
    ds_read_b32 v31, v104 offset:1792
    ds_read_b32 v32, v104 offset:2048
    ds_read_b32 v33, v104 offset:2304
    ds_read_b32 v34, v104 offset:2560
    ds_read_b32 v35, v104 offset:2816
    s_waitcnt lgkmcnt(0)
    v_mul_f32 v56, v24, v44
    v_mul_f32 v57, v25, v44
    v_mul_f32 v58, v26, v44
    v_mul_f32 v59, v27, v44
    v_mul_f32 v60, v28, v44
    v_mul_f32 v61, v29, v44
    v_mul_f32 v62, v30, v44
    v_mul_f32 v63, v31, v44
    v_mul_f32 v64, v32, v44
    v_mul_f32 v65, v33, v44
    v_mul_f32 v66, v34, v44
    v_mul_f32 v67, v35, v44
    ds_read_b32 v24, v104 offset:6656
    ds_read_b32 v25, v104 offset:6912
    ds_read_b32 v26, v104 offset:7168
    ds_read_b32 v27, v104 offset:7424
    ds_read_b32 v28, v104 offset:7680
    ds_read_b32 v29, v104 offset:7936
    ds_read_b32 v30, v104 offset:8192
    ds_read_b32 v31, v104 offset:8448
    ds_read_b32 v32, v104 offset:8704
    ds_read_b32 v33, v104 offset:8960
    ds_read_b32 v34, v104 offset:9216
    ds_read_b32 v35, v104 offset:9472
    s_waitcnt lgkmcnt(0)
    v_fmac_f32 v56, v24, v45
    v_fmac_f32 v57, v25, v45
    v_fmac_f32 v58, v26, v45
    v_fmac_f32 v59, v27, v45
    v_fmac_f32 v60, v28, v45
    v_fmac_f32 v61, v29, v45
    v_fmac_f32 v62, v30, v45
    v_fmac_f32 v63, v31, v45
    v_fmac_f32 v64, v32, v45
    v_fmac_f32 v65, v33, v45
    v_fmac_f32 v66, v34, v45
    v_fmac_f32 v67, v35, v45
    ds_read_b32 v24, v104 offset:13312
    ds_read_b32 v25, v104 offset:13568
    ds_read_b32 v26, v104 offset:13824
    ds_read_b32 v27, v104 offset:14080
    ds_read_b32 v28, v104 offset:14336
    ds_read_b32 v29, v104 offset:14592
    ds_read_b32 v30, v104 offset:14848
    ds_read_b32 v31, v104 offset:15104
    ds_read_b32 v32, v104 offset:15360
    ds_read_b32 v33, v104 offset:15616
    ds_read_b32 v34, v104 offset:15872
    ds_read_b32 v35, v104 offset:16128
    s_waitcnt lgkmcnt(0)
    v_fmac_f32 v56, v24, v46
    v_fmac_f32 v57, v25, v46
    v_fmac_f32 v58, v26, v46
    v_fmac_f32 v59, v27, v46
    v_fmac_f32 v60, v28, v46
    v_fmac_f32 v61, v29, v46
    v_fmac_f32 v62, v30, v46
    v_fmac_f32 v63, v31, v46
    v_fmac_f32 v64, v32, v46
    v_fmac_f32 v65, v33, v46
    v_fmac_f32 v66, v34, v46
    v_fmac_f32 v67, v35, v46
    ds_read_b32 v24, v104 offset:19968
    ds_read_b32 v25, v104 offset:20224
    ds_read_b32 v26, v104 offset:20480
    ds_read_b32 v27, v104 offset:20736
    ds_read_b32 v28, v104 offset:20992
    ds_read_b32 v29, v104 offset:21248
    ds_read_b32 v30, v104 offset:21504
    ds_read_b32 v31, v104 offset:21760
    ds_read_b32 v32, v104 offset:22016
    ds_read_b32 v33, v104 offset:22272
    ds_read_b32 v34, v104 offset:22528
    ds_read_b32 v35, v104 offset:22784
    s_waitcnt lgkmcnt(0)
    v_fmac_f32 v56, v24, v47
    v_fmac_f32 v57, v25, v47
    v_fmac_f32 v58, v26, v47
    v_fmac_f32 v59, v27, v47
    v_fmac_f32 v60, v28, v47
    v_fmac_f32 v61, v29, v47
    v_fmac_f32 v62, v30, v47
    v_fmac_f32 v63, v31, v47
    v_fmac_f32 v64, v32, v47
    v_fmac_f32 v65, v33, v47
    v_fmac_f32 v66, v34, v47
    v_fmac_f32 v67, v35, v47
    v_mov_b32 v112, v64
    v_mov_b32 v113, v64
    s_nop 1
    v_permlane32_swap_b32 v112, v113
    v_rcp_f32 v113, v113
    s_nop 0
    v_mul_f32 v56, v56, v113
    v_mul_f32 v57, v57, v113
    v_mul_f32 v58, v58, v113
    v_mul_f32 v59, v59, v113
    v_mul_f32 v60, v60, v113
    v_mul_f32 v61, v61, v113
    v_mul_f32 v62, v62, v113
    v_mul_f32 v63, v63, v113
    v_mul_f32 v64, v64, v113
    v_mul_f32 v65, v65, v113
    v_mul_f32 v66, v66, v113
    v_mul_f32 v67, v67, v113
    v_cvt_pk_bf16_f32 v56, v56, v57
    v_cvt_pk_bf16_f32 v57, v58, v59
    v_cvt_pk_bf16_f32 v60, v60, v61
    v_cvt_pk_bf16_f32 v61, v62, v63
    v_cvt_pk_bf16_f32 v64, v64, v65
    v_cvt_pk_bf16_f32 v65, v66, v67
    s_lshl_b32 s3, s2, 6
    s_lshl_b32 s33, s39, 5
    s_add_u32 s3, s3, s33
    v_add_u32 v4, s3, v2
    v_mul_u32_u24 v4, 40, v4
    v_lshl_add_u32 v5, v3, 3, v4
    v_lshl_add_u32 v6, v3, 28, v4
    buffer_store_dwordx2 v[56:57], v5, s[20:23], 0 offen
    buffer_store_dwordx2 v[60:61], v5, s[20:23], 0 offen offset:16
    buffer_store_dwordx2 v[64:65], v6, s[20:23], 0 offen offset:32
L_attn1_kernel_end:
    s_endpgm
L_attn1_kernel_rare0:
    v_mov_b32 v112, v111
    v_mov_b32 v113, v111
    s_nop 1
    v_permlane32_swap_b32 v112, v113
    v_max_f32 v111, v112, v113
    v_cmp_gt_f32 vcc, v111, v108
    s_nop 1
    v_cndmask_b32 v111, 0, v111, vcc
    v_add_f32 v112, v106, v111
    v_and_b32 v112, 0xffff0000, v112
    v_sub_f32 v113, v112, v106
    v_sub_f32 v24, v24, v113
    v_sub_f32 v25, v25, v113
    v_sub_f32 v26, v26, v113
    v_sub_f32 v27, v27, v113
    v_sub_f32 v28, v28, v113
    v_sub_f32 v29, v29, v113
    v_sub_f32 v30, v30, v113
    v_sub_f32 v31, v31, v113
    v_sub_f32 v32, v32, v113
    v_sub_f32 v33, v33, v113
    v_sub_f32 v34, v34, v113
    v_sub_f32 v35, v35, v113
    v_sub_f32 v36, v36, v113
    v_sub_f32 v37, v37, v113
    v_sub_f32 v38, v38, v113
    v_sub_f32 v39, v39, v113
    v_max_f32 v113, 0, v113
    v_sub_f32 v113, 0, v113
    v_exp_f32 v113, v113
    v_mov_b32 v106, v112
    v_xor_b32 v112, 0x80000000, v112
    v_lshrrev_b32 v112, 16, v112
    v_and_b32 v18, v112, v110
    v_mov_b32 v108, 0x41000000
    v_mul_f32 v56, v56, v113
    v_mul_f32 v57, v57, v113
    v_mul_f32 v58, v58, v113
    v_mul_f32 v59, v59, v113
    v_mul_f32 v60, v60, v113
    v_mul_f32 v61, v61, v113
    v_mul_f32 v62, v62, v113
    v_mul_f32 v63, v63, v113
    v_mul_f32 v64, v64, v113
    v_mul_f32 v65, v65, v113
    v_mul_f32 v66, v66, v113
    v_mul_f32 v67, v67, v113
    s_branch L_attn1_kernel_back0
L_attn1_kernel_rare1:
    v_mov_b32 v112, v111
    v_mov_b32 v113, v111
    s_nop 1
    v_permlane32_swap_b32 v112, v113
    v_max_f32 v111, v112, v113
    v_cmp_gt_f32 vcc, v111, v109
    s_nop 1
    v_cndmask_b32 v111, 0, v111, vcc
    v_add_f32 v112, v107, v111
    v_and_b32 v112, 0xffff0000, v112
    v_sub_f32 v113, v112, v107
    v_sub_f32 v40, v40, v113
    v_sub_f32 v41, v41, v113
    v_sub_f32 v42, v42, v113
    v_sub_f32 v43, v43, v113
    v_sub_f32 v44, v44, v113
    v_sub_f32 v45, v45, v113
    v_sub_f32 v46, v46, v113
    v_sub_f32 v47, v47, v113
    v_sub_f32 v48, v48, v113
    v_sub_f32 v49, v49, v113
    v_sub_f32 v50, v50, v113
    v_sub_f32 v51, v51, v113
    v_sub_f32 v52, v52, v113
    v_sub_f32 v53, v53, v113
    v_sub_f32 v54, v54, v113
    v_sub_f32 v55, v55, v113
    v_max_f32 v113, 0, v113
    v_sub_f32 v113, 0, v113
    v_exp_f32 v113, v113
    v_mov_b32 v107, v112
    v_xor_b32 v112, 0x80000000, v112
    v_lshrrev_b32 v112, 16, v112
    v_and_b32 v22, v112, v110
    v_mov_b32 v109, 0x41000000
    v_mul_f32 v72, v72, v113
    v_mul_f32 v73, v73, v113
    v_mul_f32 v74, v74, v113
    v_mul_f32 v75, v75, v113
    v_mul_f32 v76, v76, v113
    v_mul_f32 v77, v77, v113
    v_mul_f32 v78, v78, v113
    v_mul_f32 v79, v79, v113
    v_mul_f32 v80, v80, v113
    v_mul_f32 v81, v81, v113
    v_mul_f32 v82, v82, v113
    v_mul_f32 v83, v83, v113
    s_branch L_attn1_kernel_back1
.globl wo1_kernel
.p2align 8
.type wo1_kernel,@function
wo1_kernel:
    s_cmp_ge_u32 s2, 160
    s_cbranch_scc1 L_wo1_kernel_end
    s_load_dwordx2 s[4:5], s[0:1], 88
    s_load_dwordx2 s[6:7], s[0:1], 88
    s_load_dwordx2 s[40:41], s[0:1], 32
    s_load_dwordx2 s[46:47], s[0:1], 0
    s_and_b32 s28, s2, 7
    s_mul_i32 s28, s28, 20
    s_lshr_b32 s29, s2, 3
    s_add_u32 s28, s28, s29
    s_lshr_b32 s29, s28, 5
    s_and_b32 s28, s28, 31
    v_lshrrev_b32 v1, 6, v0
    v_and_b32 v5, 63, v0
    v_readfirstlane_b32 s39, v1
    v_and_b32 v6, 31, v0
    v_lshrrev_b32 v7, 5, v5
    s_waitcnt lgkmcnt(0)
    s_and_b32 s37, s39, 1
    s_lshr_b32 s38, s39, 1
    s_add_u32 s8, s4, 0x568000
    s_addc_u32 s9, s5, 0
    s_mov_b32 s10, 0x280000
    s_mov_b32 s11, 0x20000
    s_mul_i32 s30, s28, 81920
    s_lshl_b32 s3, s29, 8
    s_add_u32 s12, s40, s3
    s_addc_u32 s13, s41, 0
    s_sub_u32 s14, 0xc8000, s3
    s_mov_b32 s15, 0x20000
    s_add_u32 s16, s12, 128
    s_addc_u32 s17, s13, 0
    s_sub_u32 s18, s14, 128
    s_mov_b32 s19, 0x20000
    s_mov_b32 s33, 1280
    s_lshl_b32 s32, s33, 6
    s_mov_b32 s31, 0
    s_mul_i32 s34, s39, 2048
    s_lshl_b32 s35, s39, 11
    s_add_u32 s35, s35, 8192
    v_lshrrev_b32 v1, 3, v5
    v_lshrrev_b32 v2, 4, v5
    v_and_b32 v3, 7, v5
    s_mul_i32 s3, s39, 16
    v_add_u32 v4, 0, v2
    v_and_b32 v4, 7, v4
    v_xor_b32 v4, v4, v3
    v_add_u32 v64, s3, v1
    v_mul_u32_u24 v64, 0x500, v64
    v_lshl_add_u32 v64, v4, 4, v64
    v_add_u32 v4, 4, v2
    v_and_b32 v4, 7, v4
    v_xor_b32 v4, v4, v3
    v_add_u32 v65, s3, v1
    v_add_u32 v65, 8, v65
    v_mul_u32_u24 v65, 0x500, v65
    v_lshl_add_u32 v65, v4, 4, v65
    v_subrev_u32 v65, 1024, v65
    v_and_b32 v4, 1, v2
    v_lshlrev_b32 v4, 2, v4
    v_xor_b32 v4, v4, v3
    s_lshl_b32 s3, s39, 4
    v_add_u32 v66, s3, v1
    v_mul_lo_u32 v66, v66, s33
    v_lshl_add_u32 v66, v4, 4, v66
    v_add_u32 v67, s3, v1
    v_add_u32 v67, 8, v67
    v_mul_lo_u32 v67, v67, s33
    v_lshl_add_u32 v67, v4, 4, v67
    v_subrev_u32 v67, 1024, v67
    s_mul_i32 s3, s38, 32
    v_add_u32 v1, s3, v6
    v_lshlrev_b32 v1, 7, v1
    v_bfe_u32 v2, v5, 1, 3
    v_add_u32 v3, 0, v7
    v_xor_b32 v3, v3, v2
    v_lshl_add_u32 v68, v3, 4, v1
    v_add_u32 v3, 2, v7
    v_xor_b32 v3, v3, v2
    v_lshl_add_u32 v69, v3, 4, v1
    v_add_u32 v3, 4, v7
    v_xor_b32 v3, v3, v2
    v_lshl_add_u32 v70, v3, 4, v1
    v_add_u32 v3, 6, v7
    v_xor_b32 v3, v3, v2
    v_lshl_add_u32 v71, v3, 4, v1
    v_lshrrev_b32 v1, 5, v5
    v_lshlrev_b32 v1, 3, v1
    v_bfe_u32 v2, v5, 2, 2
    v_add_u32 v1, v1, v2
    v_lshlrev_b32 v72, 7, v1
    v_bfe_u32 v1, v5, 4, 1
    v_lshlrev_b32 v1, 1, v1
    v_bfe_u32 v2, v5, 1, 1
    v_add_u32 v1, v1, v2
    s_lshl_b32 s3, s37, 2
    v_add_u32 v1, s3, v1
    v_bfe_u32 v2, v5, 3, 1
    v_lshlrev_b32 v2, 2, v2
    v_xor_b32 v1, v1, v2
    v_lshl_add_u32 v72, v1, 4, v72
    v_and_b32 v1, 1, v5
    v_lshl_add_u32 v72, v1, 3, v72
    v_add_u32 v72, 8192, v72
    s_mov_b32 s36, 0
    s_mov_b32 s58, 0
    s_add_u32 m0, s36, s34
    s_nop 0
    buffer_load_dwordx4 v64, s[8:11], s30 offen offset:0 lds
    buffer_load_dwordx4 v65, s[8:11], s30 offen offset:1024 lds
    s_add_u32 m0, s36, s35
    s_nop 0
    buffer_load_dwordx4 v66, s[12:15], s31 offen lds
    buffer_load_dwordx4 v67, s[12:15], s31 offen offset:1024 lds
    s_add_u32 m0, m0, 0x2000
    s_nop 0
    buffer_load_dwordx4 v66, s[16:19], s31 offen lds
    buffer_load_dwordx4 v67, s[16:19], s31 offen offset:1024 lds
    s_add_u32 s30, s30, 128
    s_add_u32 s31, s31, s32
    s_add_u32 s36, s36, 24576
    s_add_u32 s58, s58, 1
    s_cmp_eq_u32 s58, 3
    s_cselect_b32 s36, 0, s36
    s_cselect_b32 s58, 0, s58
    s_add_u32 m0, s36, s34
    s_nop 0
    buffer_load_dwordx4 v64, s[8:11], s30 offen offset:0 lds
    buffer_load_dwordx4 v65, s[8:11], s30 offen offset:1024 lds
    s_add_u32 m0, s36, s35
    s_nop 0
    buffer_load_dwordx4 v66, s[12:15], s31 offen lds
    buffer_load_dwordx4 v67, s[12:15], s31 offen offset:1024 lds
    s_add_u32 m0, m0, 0x2000
    s_nop 0
    buffer_load_dwordx4 v66, s[16:19], s31 offen lds
    buffer_load_dwordx4 v67, s[16:19], s31 offen offset:1024 lds
    s_add_u32 s30, s30, 128
    s_add_u32 s31, s31, s32
    s_add_u32 s36, s36, 24576
    s_add_u32 s58, s58, 1
    s_cmp_eq_u32 s58, 3
    s_cselect_b32 s36, 0, s36
    s_cselect_b32 s58, 0, s58
    s_mov_b32 s59, 0
    s_mov_b32 s60, 0xffff4000
    s_mov_b32 s61, 24576
    s_mov_b32 s49, 0
    v_mov_b32 v8, 0
    v_mov_b32 v9, 0
    v_mov_b32 v10, 0
    v_mov_b32 v11, 0
    v_mov_b32 v12, 0
    v_mov_b32 v13, 0
    v_mov_b32 v14, 0
    v_mov_b32 v15, 0
    v_mov_b32 v16, 0
    v_mov_b32 v17, 0
    v_mov_b32 v18, 0
    v_mov_b32 v19, 0
    v_mov_b32 v20, 0
    v_mov_b32 v21, 0
    v_mov_b32 v22, 0
    v_mov_b32 v23, 0
    v_mov_b32 v24, 0
    v_mov_b32 v25, 0
    v_mov_b32 v26, 0
    v_mov_b32 v27, 0
    v_mov_b32 v28, 0
    v_mov_b32 v29, 0
    v_mov_b32 v30, 0
    v_mov_b32 v31, 0
    v_mov_b32 v32, 0
    v_mov_b32 v33, 0
    v_mov_b32 v34, 0
    v_mov_b32 v35, 0
    v_mov_b32 v36, 0
    v_mov_b32 v37, 0
    v_mov_b32 v38, 0
    v_mov_b32 v39, 0
L_wo1_kernel_loop:
    s_waitcnt vmcnt(6)
    s_barrier
    s_add_u32 m0, s36, s34
    s_nop 0
    buffer_load_dwordx4 v64, s[8:11], s30 offen offset:0 lds
    buffer_load_dwordx4 v65, s[8:11], s30 offen offset:1024 lds
    s_add_u32 m0, s36, s35
    s_nop 0
    buffer_load_dwordx4 v66, s[12:15], s31 offen lds
    buffer_load_dwordx4 v67, s[12:15], s31 offen offset:1024 lds
    s_add_u32 m0, m0, 0x2000
    s_nop 0
    buffer_load_dwordx4 v66, s[16:19], s31 offen lds
    buffer_load_dwordx4 v67, s[16:19], s31 offen offset:1024 lds
    s_add_u32 s30, s30, 128
    s_add_u32 s31, s31, s32
    s_add_u32 s36, s36, 24576
    s_add_u32 s58, s58, 1
    s_cmp_eq_u32 s58, 3
    s_cselect_b32 s36, 0, s36
    s_cselect_b32 s58, 0, s58
    ds_read_b128 v[48:51], v68 offset:0
    ds_read_b64_tr_b16 v[40:41], v72 offset:0
    ds_read_b64_tr_b16 v[42:43], v72 offset:512
    ds_read_b64_tr_b16 v[44:45], v72 offset:8192
    ds_read_b64_tr_b16 v[46:47], v72 offset:8704
    ds_read_b128 v[60:63], v69 offset:0
    ds_read_b64_tr_b16 v[52:53], v72 offset:2048
    ds_read_b64_tr_b16 v[54:55], v72 offset:2560
    ds_read_b64_tr_b16 v[56:57], v72 offset:10240
    ds_read_b64_tr_b16 v[58:59], v72 offset:10752
    s_waitcnt lgkmcnt(5)
    v_mfma_f32_32x32x16_bf16 v[8:23], v[40:43], v[48:51], v[8:23]
    v_mfma_f32_32x32x16_bf16 v[24:39], v[44:47], v[48:51], v[24:39]
    ds_read_b128 v[48:51], v70 offset:0
    ds_read_b64_tr_b16 v[40:41], v72 offset:4096
    ds_read_b64_tr_b16 v[42:43], v72 offset:4608
    ds_read_b64_tr_b16 v[44:45], v72 offset:12288
    ds_read_b64_tr_b16 v[46:47], v72 offset:12800
    s_waitcnt lgkmcnt(5)
    v_mfma_f32_32x32x16_bf16 v[8:23], v[52:55], v[60:63], v[8:23]
    v_mfma_f32_32x32x16_bf16 v[24:39], v[56:59], v[60:63], v[24:39]
    ds_read_b128 v[60:63], v71 offset:0
    ds_read_b64_tr_b16 v[52:53], v72 offset:6144
    ds_read_b64_tr_b16 v[54:55], v72 offset:6656
    ds_read_b64_tr_b16 v[56:57], v72 offset:14336
    ds_read_b64_tr_b16 v[58:59], v72 offset:14848
    s_waitcnt lgkmcnt(5)
    v_mfma_f32_32x32x16_bf16 v[8:23], v[40:43], v[48:51], v[8:23]
    v_mfma_f32_32x32x16_bf16 v[24:39], v[44:47], v[48:51], v[24:39]
    s_waitcnt lgkmcnt(0)
    v_mfma_f32_32x32x16_bf16 v[8:23], v[52:55], v[60:63], v[8:23]
    v_mfma_f32_32x32x16_bf16 v[24:39], v[56:59], v[60:63], v[24:39]
    s_add_u32 s59, s59, 1
    s_cmp_eq_u32 s59, 3
    s_cselect_b32 s48, s60, s61
    s_cselect_b32 s59, 0, s59
    v_add_u32 v68, s48, v68
    v_add_u32 v69, s48, v69
    v_add_u32 v70, s48, v70
    v_add_u32 v71, s48, v71
    v_add_u32 v72, s48, v72
    s_add_u32 s49, s49, 1
    s_cmp_lt_u32 s49, 10
    s_cbranch_scc1 L_wo1_kernel_loop
    s_waitcnt vmcnt(0)
    s_mul_i32 s3, s28, 64
    s_mul_i32 s50, s38, 32
    s_add_u32 s3, s3, s50
    v_add_u32 v1, s3, v6
    s_mov_b32 s51, 0xffff0000
    s_add_u32 s20, s6, 0x7e8000
    s_addc_u32 s21, s7, 0
    s_mov_b32 s22, 0x280000
    s_mov_b32 s23, 0x20000
    s_mov_b32 s24, s46
    s_mov_b32 s25, s47
    s_mov_b32 s26, 0x280000
    s_mov_b32 s27, 0x20000
    v_mul_u32_u24 v2, 0x500, v1
    s_lshl_b32 s3, s29, 8
    s_lshl_b32 s50, s37, 6
    s_add_u32 s3, s3, s50
    v_add_u32 v2, s3, v2
    v_lshl_add_u32 v2, v7, 3, v2
    s_mov_b32 s52, 0xa000
    buffer_load_dwordx2 v[40:41], v2, s[24:27], 0 offen offset:0
    buffer_load_dwordx2 v[42:43], v2, s[24:27], 0 offen offset:16
    buffer_load_dwordx2 v[44:45], v2, s[24:27], 0 offen offset:32
    buffer_load_dwordx2 v[46:47], v2, s[24:27], 0 offen offset:48
    buffer_load_dwordx2 v[48:49], v2, s[24:27], 0 offen offset:128
    buffer_load_dwordx2 v[50:51], v2, s[24:27], 0 offen offset:144
    buffer_load_dwordx2 v[52:53], v2, s[24:27], 0 offen offset:160
    buffer_load_dwordx2 v[54:55], v2, s[24:27], 0 offen offset:176
    v_mov_b32 v80, 0x3f803f80
    v_mov_b32 v82, 0
    v_mov_b32 v83, 0
    v_cvt_pk_bf16_f32 v74, v8, v9
    v_cvt_pk_bf16_f32 v75, v10, v11
    v_lshlrev_b32 v8, 16, v74
    v_and_b32 v9, s51, v74
    v_lshlrev_b32 v10, 16, v75
    v_and_b32 v11, s51, v75
    s_waitcnt vmcnt(0)
    v_lshlrev_b32 v76, 16, v40
    v_and_b32 v77, s51, v40
    v_lshlrev_b32 v78, 16, v41
    v_and_b32 v79, s51, v41
    v_pk_add_f32 v[8:9], v[8:9], v[76:77]
    v_pk_add_f32 v[10:11], v[10:11], v[78:79]
    v_cvt_pk_bf16_f32 v40, v8, v9
    v_cvt_pk_bf16_f32 v41, v10, v11
    buffer_store_dwordx2 v[40:41], v2, s[20:23], 0 offen offset:0
    v_dot2c_f32_bf16 v82, v40, v80
    v_dot2c_f32_bf16 v83, v40, v40
    v_dot2c_f32_bf16 v82, v41, v80
    v_dot2c_f32_bf16 v83, v41, v41
    v_cvt_pk_bf16_f32 v74, v12, v13
    v_cvt_pk_bf16_f32 v75, v14, v15
    v_lshlrev_b32 v12, 16, v74
    v_and_b32 v13, s51, v74
    v_lshlrev_b32 v14, 16, v75
    v_and_b32 v15, s51, v75
    v_lshlrev_b32 v76, 16, v42
    v_and_b32 v77, s51, v42
    v_lshlrev_b32 v78, 16, v43
    v_and_b32 v79, s51, v43
    v_pk_add_f32 v[12:13], v[12:13], v[76:77]
    v_pk_add_f32 v[14:15], v[14:15], v[78:79]
    v_cvt_pk_bf16_f32 v42, v12, v13
    v_cvt_pk_bf16_f32 v43, v14, v15
    buffer_store_dwordx2 v[42:43], v2, s[20:23], 0 offen offset:16
    v_dot2c_f32_bf16 v82, v42, v80
    v_dot2c_f32_bf16 v83, v42, v42
    v_dot2c_f32_bf16 v82, v43, v80
    v_dot2c_f32_bf16 v83, v43, v43
    v_cvt_pk_bf16_f32 v74, v16, v17
    v_cvt_pk_bf16_f32 v75, v18, v19
    v_lshlrev_b32 v16, 16, v74
    v_and_b32 v17, s51, v74
    v_lshlrev_b32 v18, 16, v75
    v_and_b32 v19, s51, v75
    v_lshlrev_b32 v76, 16, v44
    v_and_b32 v77, s51, v44
    v_lshlrev_b32 v78, 16, v45
    v_and_b32 v79, s51, v45
    v_pk_add_f32 v[16:17], v[16:17], v[76:77]
    v_pk_add_f32 v[18:19], v[18:19], v[78:79]
    v_cvt_pk_bf16_f32 v44, v16, v17
    v_cvt_pk_bf16_f32 v45, v18, v19
    buffer_store_dwordx2 v[44:45], v2, s[20:23], 0 offen offset:32
    v_dot2c_f32_bf16 v82, v44, v80
    v_dot2c_f32_bf16 v83, v44, v44
    v_dot2c_f32_bf16 v82, v45, v80
    v_dot2c_f32_bf16 v83, v45, v45
    v_cvt_pk_bf16_f32 v74, v20, v21
    v_cvt_pk_bf16_f32 v75, v22, v23
    v_lshlrev_b32 v20, 16, v74
    v_and_b32 v21, s51, v74
    v_lshlrev_b32 v22, 16, v75
    v_and_b32 v23, s51, v75
    v_lshlrev_b32 v76, 16, v46
    v_and_b32 v77, s51, v46
    v_lshlrev_b32 v78, 16, v47
    v_and_b32 v79, s51, v47
    v_pk_add_f32 v[20:21], v[20:21], v[76:77]
    v_pk_add_f32 v[22:23], v[22:23], v[78:79]
    v_cvt_pk_bf16_f32 v46, v20, v21
    v_cvt_pk_bf16_f32 v47, v22, v23
    buffer_store_dwordx2 v[46:47], v2, s[20:23], 0 offen offset:48
    v_dot2c_f32_bf16 v82, v46, v80
    v_dot2c_f32_bf16 v83, v46, v46
    v_dot2c_f32_bf16 v82, v47, v80
    v_dot2c_f32_bf16 v83, v47, v47
    v_cvt_pk_bf16_f32 v74, v24, v25
    v_cvt_pk_bf16_f32 v75, v26, v27
    v_lshlrev_b32 v24, 16, v74
    v_and_b32 v25, s51, v74
    v_lshlrev_b32 v26, 16, v75
    v_and_b32 v27, s51, v75
    v_lshlrev_b32 v76, 16, v48
    v_and_b32 v77, s51, v48
    v_lshlrev_b32 v78, 16, v49
    v_and_b32 v79, s51, v49
    v_pk_add_f32 v[24:25], v[24:25], v[76:77]
    v_pk_add_f32 v[26:27], v[26:27], v[78:79]
    v_cvt_pk_bf16_f32 v48, v24, v25
    v_cvt_pk_bf16_f32 v49, v26, v27
    buffer_store_dwordx2 v[48:49], v2, s[20:23], 0 offen offset:128
    v_dot2c_f32_bf16 v82, v48, v80
    v_dot2c_f32_bf16 v83, v48, v48
    v_dot2c_f32_bf16 v82, v49, v80
    v_dot2c_f32_bf16 v83, v49, v49
    v_cvt_pk_bf16_f32 v74, v28, v29
    v_cvt_pk_bf16_f32 v75, v30, v31
    v_lshlrev_b32 v28, 16, v74
    v_and_b32 v29, s51, v74
    v_lshlrev_b32 v30, 16, v75
    v_and_b32 v31, s51, v75
    v_lshlrev_b32 v76, 16, v50
    v_and_b32 v77, s51, v50
    v_lshlrev_b32 v78, 16, v51
    v_and_b32 v79, s51, v51
    v_pk_add_f32 v[28:29], v[28:29], v[76:77]
    v_pk_add_f32 v[30:31], v[30:31], v[78:79]
    v_cvt_pk_bf16_f32 v50, v28, v29
    v_cvt_pk_bf16_f32 v51, v30, v31
    buffer_store_dwordx2 v[50:51], v2, s[20:23], 0 offen offset:144
    v_dot2c_f32_bf16 v82, v50, v80
    v_dot2c_f32_bf16 v83, v50, v50
    v_dot2c_f32_bf16 v82, v51, v80
    v_dot2c_f32_bf16 v83, v51, v51
    v_cvt_pk_bf16_f32 v74, v32, v33
    v_cvt_pk_bf16_f32 v75, v34, v35
    v_lshlrev_b32 v32, 16, v74
    v_and_b32 v33, s51, v74
    v_lshlrev_b32 v34, 16, v75
    v_and_b32 v35, s51, v75
    v_lshlrev_b32 v76, 16, v52
    v_and_b32 v77, s51, v52
    v_lshlrev_b32 v78, 16, v53
    v_and_b32 v79, s51, v53
    v_pk_add_f32 v[32:33], v[32:33], v[76:77]
    v_pk_add_f32 v[34:35], v[34:35], v[78:79]
    v_cvt_pk_bf16_f32 v52, v32, v33
    v_cvt_pk_bf16_f32 v53, v34, v35
    buffer_store_dwordx2 v[52:53], v2, s[20:23], 0 offen offset:160
    v_dot2c_f32_bf16 v82, v52, v80
    v_dot2c_f32_bf16 v83, v52, v52
    v_dot2c_f32_bf16 v82, v53, v80
    v_dot2c_f32_bf16 v83, v53, v53
    v_cvt_pk_bf16_f32 v74, v36, v37
    v_cvt_pk_bf16_f32 v75, v38, v39
    v_lshlrev_b32 v36, 16, v74
    v_and_b32 v37, s51, v74
    v_lshlrev_b32 v38, 16, v75
    v_and_b32 v39, s51, v75
    v_lshlrev_b32 v76, 16, v54
    v_and_b32 v77, s51, v54
    v_lshlrev_b32 v78, 16, v55
    v_and_b32 v79, s51, v55
    v_pk_add_f32 v[36:37], v[36:37], v[76:77]
    v_pk_add_f32 v[38:39], v[38:39], v[78:79]
    v_cvt_pk_bf16_f32 v54, v36, v37
    v_cvt_pk_bf16_f32 v55, v38, v39
    buffer_store_dwordx2 v[54:55], v2, s[20:23], 0 offen offset:176
    v_dot2c_f32_bf16 v82, v54, v80
    v_dot2c_f32_bf16 v83, v54, v54
    v_dot2c_f32_bf16 v82, v55, v80
    v_dot2c_f32_bf16 v83, v55, v55
    s_add_u32 s24, s6, 0x1628000
    s_addc_u32 s25, s7, 0
    s_mov_b32 s26, 0x50000
    s_mov_b32 s27, 0x20000
    v_mul_u32_u24 v2, 160, v1
    s_lshl_b32 s3, s29, 5
    s_lshl_b32 s50, s37, 4
    s_add_u32 s3, s3, s50
    v_add_u32 v2, s3, v2
    v_lshl_add_u32 v2, v7, 3, v2
    s_mov_b32 s52, 5120
    buffer_store_dwordx2 v[82:83], v2, s[24:27], 0 offen
L_wo1_kernel_end:
    s_endpgm
.globl gu1_kernel
.p2align 8
.type gu1_kernel,@function
gu1_kernel:
    s_cmp_ge_u32 s2, 432
    s_cbranch_scc1 L_gu1_kernel_end
    s_load_dwordx2 s[4:5], s[0:1], 88
    s_load_dwordx2 s[6:7], s[0:1], 88
    s_load_dwordx2 s[40:41], s[0:1], 48
    s_load_dwordx2 s[42:43], s[0:1], 56
    s_and_b32 s28, s2, 7
    s_mul_i32 s28, s28, 54
    s_lshr_b32 s29, s2, 3
    s_add_u32 s28, s28, s29
    s_lshr_b32 s29, s28, 4
    s_and_b32 s28, s28, 15
    v_lshrrev_b32 v1, 6, v0
    v_and_b32 v5, 63, v0
    v_readfirstlane_b32 s39, v1
    v_and_b32 v6, 31, v0
    v_lshrrev_b32 v7, 5, v5
    s_waitcnt lgkmcnt(0)
    s_and_b32 s37, s39, 1
    s_lshr_b32 s38, s39, 1
    s_add_u32 s24, s6, 0x1628000
    s_addc_u32 s25, s7, 0
    s_mov_b32 s26, 0x50000
    s_mov_b32 s27, 0x20000
    s_mul_i32 s3, s28, 128
    s_mul_i32 s50, s38, 64
    s_add_u32 s3, s3, s50
    v_add_u32 v2, s3, v6
    v_mul_u32_u24 v2, 160, v2
    s_mov_b32 s50, 5120
    buffer_load_dwordx4 v[8:11], v2, s[24:27], 0 offen offset:0
    buffer_load_dwordx4 v[12:15], v2, s[24:27], 0 offen offset:16
    buffer_load_dwordx4 v[16:19], v2, s[24:27], 0 offen offset:32
    buffer_load_dwordx4 v[20:23], v2, s[24:27], 0 offen offset:48
    buffer_load_dwordx4 v[24:27], v2, s[24:27], 0 offen offset:64
    buffer_load_dwordx4 v[28:31], v2, s[24:27], 0 offen offset:80
    buffer_load_dwordx4 v[32:35], v2, s[24:27], 0 offen offset:96
    buffer_load_dwordx4 v[36:39], v2, s[24:27], 0 offen offset:112
    buffer_load_dwordx4 v[40:43], v2, s[24:27], 0 offen offset:128
    buffer_load_dwordx4 v[44:47], v2, s[24:27], 0 offen offset:144
    buffer_load_dwordx4 v[48:51], v2, s[24:27], s50 offen offset:0
    buffer_load_dwordx4 v[52:55], v2, s[24:27], s50 offen offset:16
    buffer_load_dwordx4 v[56:59], v2, s[24:27], s50 offen offset:32
    buffer_load_dwordx4 v[60:63], v2, s[24:27], s50 offen offset:48
    buffer_load_dwordx4 v[64:67], v2, s[24:27], s50 offen offset:64
    buffer_load_dwordx4 v[68:71], v2, s[24:27], s50 offen offset:80
    buffer_load_dwordx4 v[72:75], v2, s[24:27], s50 offen offset:96
    buffer_load_dwordx4 v[76:79], v2, s[24:27], s50 offen offset:112
    buffer_load_dwordx4 v[80:83], v2, s[24:27], s50 offen offset:128
    buffer_load_dwordx4 v[84:87], v2, s[24:27], s50 offen offset:144
    s_add_u32 s8, s4, 0x7e8000
    s_addc_u32 s9, s5, 0
    s_mov_b32 s10, 0x280000
    s_mov_b32 s11, 0x20000
    s_mul_i32 s30, s28, 163840
    s_lshl_b32 s3, s29, 7
    s_add_u32 s12, s40, s3
    s_addc_u32 s13, s41, 0
    s_sub_u32 s14, 0x21c000, s3
    s_mov_b32 s15, 0x20000
    s_add_u32 s16, s42, s3
    s_addc_u32 s17, s43, 0
    s_sub_u32 s18, 0x21c000, s3
    s_mov_b32 s19, 0x20000
    s_mov_b32 s33, 3456
    s_lshl_b32 s32, s33, 6
    s_mov_b32 s31, 0
    s_mul_i32 s34, s39, 4096
    s_lshl_b32 s35, s39, 11
    s_add_u32 s35, s35, 16384
    v_lshrrev_b32 v1, 3, v5
    v_lshrrev_b32 v2, 4, v5
    v_and_b32 v3, 7, v5
    s_mul_i32 s3, s39, 32
    v_add_u32 v4, 0, v2
    v_and_b32 v4, 7, v4
    v_xor_b32 v4, v4, v3
    v_add_u32 v104, s3, v1
    v_mul_u32_u24 v104, 0x500, v104
    v_lshl_add_u32 v104, v4, 4, v104
    v_add_u32 v4, 4, v2
    v_and_b32 v4, 7, v4
    v_xor_b32 v4, v4, v3
    v_add_u32 v105, s3, v1
    v_add_u32 v105, 8, v105
    v_mul_u32_u24 v105, 0x500, v105
    v_lshl_add_u32 v105, v4, 4, v105
    v_subrev_u32 v105, 1024, v105
    v_add_u32 v4, 8, v2
    v_and_b32 v4, 7, v4
    v_xor_b32 v4, v4, v3
    v_add_u32 v106, s3, v1
    v_add_u32 v106, 16, v106
    v_mul_u32_u24 v106, 0x500, v106
    v_lshl_add_u32 v106, v4, 4, v106
    v_subrev_u32 v106, 2048, v106
    v_add_u32 v4, 12, v2
    v_and_b32 v4, 7, v4
    v_xor_b32 v4, v4, v3
    v_add_u32 v107, s3, v1
    v_add_u32 v107, 24, v107
    v_mul_u32_u24 v107, 0x500, v107
    v_lshl_add_u32 v107, v4, 4, v107
    v_subrev_u32 v107, 3072, v107
    v_and_b32 v4, 1, v2
    v_lshlrev_b32 v4, 2, v4
    v_xor_b32 v4, v4, v3
    s_lshl_b32 s3, s39, 4
    v_add_u32 v108, s3, v1
    v_mul_lo_u32 v108, v108, s33
    v_lshl_add_u32 v108, v4, 4, v108
    v_add_u32 v109, s3, v1
    v_add_u32 v109, 8, v109
    v_mul_lo_u32 v109, v109, s33
    v_lshl_add_u32 v109, v4, 4, v109
    v_subrev_u32 v109, 1024, v109
    s_mul_i32 s3, s38, 64
    v_add_u32 v1, s3, v6
    v_lshlrev_b32 v1, 7, v1
    v_bfe_u32 v2, v5, 1, 3
    v_add_u32 v3, 0, v7
    v_xor_b32 v3, v3, v2
    v_lshl_add_u32 v110, v3, 4, v1
    v_add_u32 v3, 2, v7
    v_xor_b32 v3, v3, v2
    v_lshl_add_u32 v111, v3, 4, v1
    v_add_u32 v3, 4, v7
    v_xor_b32 v3, v3, v2
    v_lshl_add_u32 v112, v3, 4, v1
    v_add_u32 v3, 6, v7
    v_xor_b32 v3, v3, v2
    v_lshl_add_u32 v113, v3, 4, v1
    v_lshrrev_b32 v1, 5, v5
    v_lshlrev_b32 v1, 3, v1
    v_bfe_u32 v2, v5, 2, 2
    v_add_u32 v1, v1, v2
    v_lshlrev_b32 v114, 7, v1
    v_bfe_u32 v1, v5, 4, 1
    v_lshlrev_b32 v1, 1, v1
    v_bfe_u32 v2, v5, 1, 1
    v_add_u32 v1, v1, v2
    s_lshl_b32 s3, s37, 2
    v_add_u32 v1, s3, v1
    v_bfe_u32 v2, v5, 3, 1
    v_lshlrev_b32 v2, 2, v2
    v_xor_b32 v1, v1, v2
    v_lshl_add_u32 v114, v1, 4, v114
    v_and_b32 v1, 1, v5
    v_lshl_add_u32 v114, v1, 3, v114
    v_add_u32 v114, 16384, v114
    s_mov_b32 s36, 0
    s_mov_b32 s58, 0
    s_add_u32 m0, s36, s34
    s_nop 0
    buffer_load_dwordx4 v104, s[8:11], s30 offen offset:0 lds
    buffer_load_dwordx4 v105, s[8:11], s30 offen offset:1024 lds
    buffer_load_dwordx4 v106, s[8:11], s30 offen offset:2048 lds
    buffer_load_dwordx4 v107, s[8:11], s30 offen offset:3072 lds
    s_add_u32 m0, s36, s35
    s_nop 0
    buffer_load_dwordx4 v108, s[12:15], s31 offen lds
    buffer_load_dwordx4 v109, s[12:15], s31 offen offset:1024 lds
    s_add_u32 m0, m0, 0x2000
    s_nop 0
    buffer_load_dwordx4 v108, s[16:19], s31 offen lds
    buffer_load_dwordx4 v109, s[16:19], s31 offen offset:1024 lds
    s_add_u32 s30, s30, 128
    s_add_u32 s31, s31, s32
    s_add_u32 s36, s36, 32768
    s_add_u32 s58, s58, 1
    s_cmp_eq_u32 s58, 2
    s_cselect_b32 s36, 0, s36
    s_cselect_b32 s58, 0, s58
    s_mov_b32 s59, 0
    s_mov_b32 s60, 0xffff8000
    s_mov_b32 s61, 32768
    s_mov_b32 s49, 0
    s_waitcnt vmcnt(8)
    s_mov_b32 s51, 0xffff0000
    s_mov_b32 s52, 0x3acccccd
    s_mov_b32 s53, 0x3727c5ac
    v_pk_add_f32 v[8:9], v[8:9], v[10:11]
    v_pk_add_f32 v[8:9], v[8:9], v[12:13]
    v_pk_add_f32 v[8:9], v[8:9], v[14:15]
    v_pk_add_f32 v[8:9], v[8:9], v[16:17]
    v_pk_add_f32 v[8:9], v[8:9], v[18:19]
    v_pk_add_f32 v[8:9], v[8:9], v[20:21]
    v_pk_add_f32 v[8:9], v[8:9], v[22:23]
    v_pk_add_f32 v[8:9], v[8:9], v[24:25]
    v_pk_add_f32 v[8:9], v[8:9], v[26:27]
    v_pk_add_f32 v[8:9], v[8:9], v[28:29]
    v_pk_add_f32 v[8:9], v[8:9], v[30:31]
    v_pk_add_f32 v[8:9], v[8:9], v[32:33]
    v_pk_add_f32 v[8:9], v[8:9], v[34:35]
    v_pk_add_f32 v[8:9], v[8:9], v[36:37]
    v_pk_add_f32 v[8:9], v[8:9], v[38:39]
    v_pk_add_f32 v[8:9], v[8:9], v[40:41]
    v_pk_add_f32 v[8:9], v[8:9], v[42:43]
    v_pk_add_f32 v[8:9], v[8:9], v[44:45]
    v_pk_add_f32 v[8:9], v[8:9], v[46:47]
    v_mul_f32 v8, s52, v8
    v_mul_f32 v9, s52, v9
    v_fma_f32 v9, -v8, v8, v9
    v_max_f32 v9, 0, v9
    v_cvt_pk_bf16_f32 v10, v8, v9
    v_lshlrev_b32 v8, 16, v10
    v_and_b32 v9, s51, v10
    v_add_f32 v9, s53, v9
    v_cvt_pk_bf16_f32 v9, v9, v9
    v_lshlrev_b32 v9, 16, v9
    v_sqrt_f32 v9, v9
    s_nop 0
    v_cvt_pk_bf16_f32 v9, v9, v9
    v_lshlrev_b32 v9, 16, v9
    v_rcp_f32 v10, v9
    s_nop 0
    v_fma_f32 v11, -v9, v10, 2.0
    v_mul_f32 v10, v10, v11
    v_sub_f32 v116, 0, v8
    v_sub_f32 v117, 0, v8
    v_mov_b32 v120, v10
    v_mov_b32 v121, v10
    v_pk_add_f32 v[48:49], v[48:49], v[50:51]
    v_pk_add_f32 v[48:49], v[48:49], v[52:53]
    v_pk_add_f32 v[48:49], v[48:49], v[54:55]
    v_pk_add_f32 v[48:49], v[48:49], v[56:57]
    v_pk_add_f32 v[48:49], v[48:49], v[58:59]
    v_pk_add_f32 v[48:49], v[48:49], v[60:61]
    v_pk_add_f32 v[48:49], v[48:49], v[62:63]
    v_pk_add_f32 v[48:49], v[48:49], v[64:65]
    v_pk_add_f32 v[48:49], v[48:49], v[66:67]
    v_pk_add_f32 v[48:49], v[48:49], v[68:69]
    v_pk_add_f32 v[48:49], v[48:49], v[70:71]
    v_pk_add_f32 v[48:49], v[48:49], v[72:73]
    v_pk_add_f32 v[48:49], v[48:49], v[74:75]
    v_pk_add_f32 v[48:49], v[48:49], v[76:77]
    v_pk_add_f32 v[48:49], v[48:49], v[78:79]
    v_pk_add_f32 v[48:49], v[48:49], v[80:81]
    v_pk_add_f32 v[48:49], v[48:49], v[82:83]
    v_pk_add_f32 v[48:49], v[48:49], v[84:85]
    v_pk_add_f32 v[48:49], v[48:49], v[86:87]
    v_mul_f32 v48, s52, v48
    v_mul_f32 v49, s52, v49
    v_fma_f32 v49, -v48, v48, v49
    v_max_f32 v49, 0, v49
    v_cvt_pk_bf16_f32 v50, v48, v49
    v_lshlrev_b32 v48, 16, v50
    v_and_b32 v49, s51, v50
    v_add_f32 v49, s53, v49
    v_cvt_pk_bf16_f32 v49, v49, v49
    v_lshlrev_b32 v49, 16, v49
    v_sqrt_f32 v49, v49
    s_nop 0
    v_cvt_pk_bf16_f32 v49, v49, v49
    v_lshlrev_b32 v49, 16, v49
    v_rcp_f32 v50, v49
    s_nop 0
    v_fma_f32 v51, -v49, v50, 2.0
    v_mul_f32 v50, v50, v51
    v_sub_f32 v118, 0, v48
    v_sub_f32 v119, 0, v48
    v_mov_b32 v122, v50
    v_mov_b32 v123, v50
    v_mov_b32 v8, 0
    v_mov_b32 v9, 0
    v_mov_b32 v10, 0
    v_mov_b32 v11, 0
    v_mov_b32 v12, 0
    v_mov_b32 v13, 0
    v_mov_b32 v14, 0
    v_mov_b32 v15, 0
    v_mov_b32 v16, 0
    v_mov_b32 v17, 0
    v_mov_b32 v18, 0
    v_mov_b32 v19, 0
    v_mov_b32 v20, 0
    v_mov_b32 v21, 0
    v_mov_b32 v22, 0
    v_mov_b32 v23, 0
    v_mov_b32 v24, 0
    v_mov_b32 v25, 0
    v_mov_b32 v26, 0
    v_mov_b32 v27, 0
    v_mov_b32 v28, 0
    v_mov_b32 v29, 0
    v_mov_b32 v30, 0
    v_mov_b32 v31, 0
    v_mov_b32 v32, 0
    v_mov_b32 v33, 0
    v_mov_b32 v34, 0
    v_mov_b32 v35, 0
    v_mov_b32 v36, 0
    v_mov_b32 v37, 0
    v_mov_b32 v38, 0
    v_mov_b32 v39, 0
    v_mov_b32 v40, 0
    v_mov_b32 v41, 0
    v_mov_b32 v42, 0
    v_mov_b32 v43, 0
    v_mov_b32 v44, 0
    v_mov_b32 v45, 0
    v_mov_b32 v46, 0
    v_mov_b32 v47, 0
    v_mov_b32 v48, 0
    v_mov_b32 v49, 0
    v_mov_b32 v50, 0
    v_mov_b32 v51, 0
    v_mov_b32 v52, 0
    v_mov_b32 v53, 0
    v_mov_b32 v54, 0
    v_mov_b32 v55, 0
    v_mov_b32 v56, 0
    v_mov_b32 v57, 0
    v_mov_b32 v58, 0
    v_mov_b32 v59, 0
    v_mov_b32 v60, 0
    v_mov_b32 v61, 0
    v_mov_b32 v62, 0
    v_mov_b32 v63, 0
    v_mov_b32 v64, 0
    v_mov_b32 v65, 0
    v_mov_b32 v66, 0
    v_mov_b32 v67, 0
    v_mov_b32 v68, 0
    v_mov_b32 v69, 0
    v_mov_b32 v70, 0
    v_mov_b32 v71, 0
L_gu1_kernel_loop:
    s_waitcnt vmcnt(0)
    s_barrier
    s_add_u32 m0, s36, s34
    s_nop 0
    buffer_load_dwordx4 v104, s[8:11], s30 offen offset:0 lds
    buffer_load_dwordx4 v105, s[8:11], s30 offen offset:1024 lds
    buffer_load_dwordx4 v106, s[8:11], s30 offen offset:2048 lds
    buffer_load_dwordx4 v107, s[8:11], s30 offen offset:3072 lds
    s_add_u32 m0, s36, s35
    s_nop 0
    buffer_load_dwordx4 v108, s[12:15], s31 offen lds
    buffer_load_dwordx4 v109, s[12:15], s31 offen offset:1024 lds
    s_add_u32 m0, m0, 0x2000
    s_nop 0
    buffer_load_dwordx4 v108, s[16:19], s31 offen lds
    buffer_load_dwordx4 v109, s[16:19], s31 offen offset:1024 lds
    s_add_u32 s30, s30, 128
    s_add_u32 s31, s31, s32
    s_add_u32 s36, s36, 32768
    s_add_u32 s58, s58, 1
    s_cmp_eq_u32 s58, 2
    s_cselect_b32 s36, 0, s36
    s_cselect_b32 s58, 0, s58
    ds_read_b128 v[80:83], v110 offset:0
    ds_read_b128 v[84:87], v110 offset:4096
    ds_read_b64_tr_b16 v[72:73], v114 offset:0
    ds_read_b64_tr_b16 v[74:75], v114 offset:512
    ds_read_b64_tr_b16 v[76:77], v114 offset:8192
    ds_read_b64_tr_b16 v[78:79], v114 offset:8704
    ds_read_b128 v[96:99], v111 offset:0
    ds_read_b128 v[100:103], v111 offset:4096
    ds_read_b64_tr_b16 v[88:89], v114 offset:2048
    ds_read_b64_tr_b16 v[90:91], v114 offset:2560
    ds_read_b64_tr_b16 v[92:93], v114 offset:10240
    ds_read_b64_tr_b16 v[94:95], v114 offset:10752
    s_waitcnt lgkmcnt(6)
    v_mfma_f32_32x32x16_bf16 v[8:23], v[72:75], v[80:83], v[8:23]
    v_mfma_f32_32x32x16_bf16 v[24:39], v[72:75], v[84:87], v[24:39]
    v_mfma_f32_32x32x16_bf16 v[40:55], v[76:79], v[80:83], v[40:55]
    v_mfma_f32_32x32x16_bf16 v[56:71], v[76:79], v[84:87], v[56:71]
    ds_read_b128 v[80:83], v112 offset:0
    ds_read_b128 v[84:87], v112 offset:4096
    ds_read_b64_tr_b16 v[72:73], v114 offset:4096
    ds_read_b64_tr_b16 v[74:75], v114 offset:4608
    ds_read_b64_tr_b16 v[76:77], v114 offset:12288
    ds_read_b64_tr_b16 v[78:79], v114 offset:12800
    s_waitcnt lgkmcnt(6)
    v_mfma_f32_32x32x16_bf16 v[8:23], v[88:91], v[96:99], v[8:23]
    v_mfma_f32_32x32x16_bf16 v[24:39], v[88:91], v[100:103], v[24:39]
    v_mfma_f32_32x32x16_bf16 v[40:55], v[92:95], v[96:99], v[40:55]
    v_mfma_f32_32x32x16_bf16 v[56:71], v[92:95], v[100:103], v[56:71]
    ds_read_b128 v[96:99], v113 offset:0
    ds_read_b128 v[100:103], v113 offset:4096
    ds_read_b64_tr_b16 v[88:89], v114 offset:6144
    ds_read_b64_tr_b16 v[90:91], v114 offset:6656
    ds_read_b64_tr_b16 v[92:93], v114 offset:14336
    ds_read_b64_tr_b16 v[94:95], v114 offset:14848
    s_waitcnt lgkmcnt(6)
    v_mfma_f32_32x32x16_bf16 v[8:23], v[72:75], v[80:83], v[8:23]
    v_mfma_f32_32x32x16_bf16 v[24:39], v[72:75], v[84:87], v[24:39]
    v_mfma_f32_32x32x16_bf16 v[40:55], v[76:79], v[80:83], v[40:55]
    v_mfma_f32_32x32x16_bf16 v[56:71], v[76:79], v[84:87], v[56:71]
    s_waitcnt lgkmcnt(0)
    v_mfma_f32_32x32x16_bf16 v[8:23], v[88:91], v[96:99], v[8:23]
    v_mfma_f32_32x32x16_bf16 v[24:39], v[88:91], v[100:103], v[24:39]
    v_mfma_f32_32x32x16_bf16 v[40:55], v[92:95], v[96:99], v[40:55]
    v_mfma_f32_32x32x16_bf16 v[56:71], v[92:95], v[100:103], v[56:71]
    s_add_u32 s59, s59, 1
    s_cmp_eq_u32 s59, 2
    s_cselect_b32 s48, s60, s61
    s_cselect_b32 s59, 0, s59
    v_add_u32 v110, s48, v110
    v_add_u32 v111, s48, v111
    v_add_u32 v112, s48, v112
    v_add_u32 v113, s48, v113
    v_add_u32 v114, s48, v114
    s_add_u32 s49, s49, 1
    s_cmp_lt_u32 s49, 10
    s_cbranch_scc1 L_gu1_kernel_loop
    s_waitcnt vmcnt(0)
    s_mul_i32 s3, s28, 128
    s_mul_i32 s50, s38, 64
    s_add_u32 s3, s3, s50
    v_add_u32 v1, s3, v6
    s_mov_b32 s51, 0xffff0000
    s_add_u32 s24, s6, 0x1679000
    s_addc_u32 s25, s7, 0
    s_mov_b32 s26, 0x1b00
    s_mov_b32 s27, 0x20000
    s_lshl_b32 s3, s29, 8
    s_lshl_b32 s50, s37, 7
    s_add_u32 s3, s3, s50
    v_lshlrev_b32 v3, 4, v7
    v_add_u32 v3, s3, v3
    buffer_load_dwordx4 v[72:75], v3, s[24:27], 0 offen offset:0
    buffer_load_dwordx4 v[76:79], v3, s[24:27], 0 offen offset:32
    buffer_load_dwordx4 v[80:83], v3, s[24:27], 0 offen offset:64
    buffer_load_dwordx4 v[84:87], v3, s[24:27], 0 offen offset:96
    s_add_u32 s24, s6, 0x167b000
    s_addc_u32 s25, s7, 0
    s_mov_b32 s26, 0x1b00
    s_mov_b32 s27, 0x20000
    s_lshl_b32 s3, s29, 8
    s_lshl_b32 s50, s37, 7
    s_add_u32 s3, s3, s50
    v_lshlrev_b32 v3, 4, v7
    v_add_u32 v3, s3, v3
    buffer_load_dwordx4 v[88:91], v3, s[24:27], 0 offen offset:0
    buffer_load_dwordx4 v[92:95], v3, s[24:27], 0 offen offset:32
    buffer_load_dwordx4 v[96:99], v3, s[24:27], 0 offen offset:64
    buffer_load_dwordx4 v[100:103], v3, s[24:27], 0 offen offset:96
    s_waitcnt vmcnt(0)
    v_pk_fma_f32 v[8:9], v[72:73], v[116:117], v[8:9]
    v_pk_fma_f32 v[10:11], v[74:75], v[116:117], v[10:11]
    v_pk_mul_f32 v[8:9], v[8:9], v[120:121]
    v_pk_mul_f32 v[10:11], v[10:11], v[120:121]
    v_pk_fma_f32 v[12:13], v[76:77], v[116:117], v[12:13]
    v_pk_fma_f32 v[14:15], v[78:79], v[116:117], v[14:15]
    v_pk_mul_f32 v[12:13], v[12:13], v[120:121]
    v_pk_mul_f32 v[14:15], v[14:15], v[120:121]
    v_pk_fma_f32 v[16:17], v[80:81], v[116:117], v[16:17]
    v_pk_fma_f32 v[18:19], v[82:83], v[116:117], v[18:19]
    v_pk_mul_f32 v[16:17], v[16:17], v[120:121]
    v_pk_mul_f32 v[18:19], v[18:19], v[120:121]
    v_pk_fma_f32 v[20:21], v[84:85], v[116:117], v[20:21]
    v_pk_fma_f32 v[22:23], v[86:87], v[116:117], v[22:23]
    v_pk_mul_f32 v[20:21], v[20:21], v[120:121]
    v_pk_mul_f32 v[22:23], v[22:23], v[120:121]
    v_pk_fma_f32 v[24:25], v[72:73], v[118:119], v[24:25]
    v_pk_fma_f32 v[26:27], v[74:75], v[118:119], v[26:27]
    v_pk_mul_f32 v[24:25], v[24:25], v[122:123]
    v_pk_mul_f32 v[26:27], v[26:27], v[122:123]
    v_pk_fma_f32 v[28:29], v[76:77], v[118:119], v[28:29]
    v_pk_fma_f32 v[30:31], v[78:79], v[118:119], v[30:31]
    v_pk_mul_f32 v[28:29], v[28:29], v[122:123]
    v_pk_mul_f32 v[30:31], v[30:31], v[122:123]
    v_pk_fma_f32 v[32:33], v[80:81], v[118:119], v[32:33]
    v_pk_fma_f32 v[34:35], v[82:83], v[118:119], v[34:35]
    v_pk_mul_f32 v[32:33], v[32:33], v[122:123]
    v_pk_mul_f32 v[34:35], v[34:35], v[122:123]
    v_pk_fma_f32 v[36:37], v[84:85], v[118:119], v[36:37]
    v_pk_fma_f32 v[38:39], v[86:87], v[118:119], v[38:39]
    v_pk_mul_f32 v[36:37], v[36:37], v[122:123]
    v_pk_mul_f32 v[38:39], v[38:39], v[122:123]
    v_pk_fma_f32 v[40:41], v[88:89], v[116:117], v[40:41]
    v_pk_fma_f32 v[42:43], v[90:91], v[116:117], v[42:43]
    v_pk_mul_f32 v[40:41], v[40:41], v[120:121]
    v_pk_mul_f32 v[42:43], v[42:43], v[120:121]
    v_pk_fma_f32 v[44:45], v[92:93], v[116:117], v[44:45]
    v_pk_fma_f32 v[46:47], v[94:95], v[116:117], v[46:47]
    v_pk_mul_f32 v[44:45], v[44:45], v[120:121]
    v_pk_mul_f32 v[46:47], v[46:47], v[120:121]
    v_pk_fma_f32 v[48:49], v[96:97], v[116:117], v[48:49]
    v_pk_fma_f32 v[50:51], v[98:99], v[116:117], v[50:51]
    v_pk_mul_f32 v[48:49], v[48:49], v[120:121]
    v_pk_mul_f32 v[50:51], v[50:51], v[120:121]
    v_pk_fma_f32 v[52:53], v[100:101], v[116:117], v[52:53]
    v_pk_fma_f32 v[54:55], v[102:103], v[116:117], v[54:55]
    v_pk_mul_f32 v[52:53], v[52:53], v[120:121]
    v_pk_mul_f32 v[54:55], v[54:55], v[120:121]
    v_pk_fma_f32 v[56:57], v[88:89], v[118:119], v[56:57]
    v_pk_fma_f32 v[58:59], v[90:91], v[118:119], v[58:59]
    v_pk_mul_f32 v[56:57], v[56:57], v[122:123]
    v_pk_mul_f32 v[58:59], v[58:59], v[122:123]
    v_pk_fma_f32 v[60:61], v[92:93], v[118:119], v[60:61]
    v_pk_fma_f32 v[62:63], v[94:95], v[118:119], v[62:63]
    v_pk_mul_f32 v[60:61], v[60:61], v[122:123]
    v_pk_mul_f32 v[62:63], v[62:63], v[122:123]
    v_pk_fma_f32 v[64:65], v[96:97], v[118:119], v[64:65]
    v_pk_fma_f32 v[66:67], v[98:99], v[118:119], v[66:67]
    v_pk_mul_f32 v[64:65], v[64:65], v[122:123]
    v_pk_mul_f32 v[66:67], v[66:67], v[122:123]
    v_pk_fma_f32 v[68:69], v[100:101], v[118:119], v[68:69]
    v_pk_fma_f32 v[70:71], v[102:103], v[118:119], v[70:71]
    v_pk_mul_f32 v[68:69], v[68:69], v[122:123]
    v_pk_mul_f32 v[70:71], v[70:71], v[122:123]
    s_add_u32 s20, s6, 0xf68000
    s_addc_u32 s21, s7, 0
    s_mov_b32 s22, 0x6c0000
    s_mov_b32 s23, 0x20000
    v_mul_u32_u24 v2, 3456, v1
    s_lshl_b32 s3, s29, 7
    s_lshl_b32 s50, s37, 6
    s_add_u32 s3, s3, s50
    v_add_u32 v2, s3, v2
    v_lshl_add_u32 v2, v7, 3, v2
    s_mov_b32 s52, 0x1b000
    s_mov_b32 s54, 0xbdd2d3e8
    s_mov_b32 s55, 0xbdd2d3e8
    v_mov_b32 v130, 0xc0135761
    v_mov_b32 v131, 0xc0135761
    v_cvt_pk_bf16_f32 v124, v8, v9
    v_cvt_pk_bf16_f32 v125, v10, v11
    v_cvt_pk_bf16_f32 v126, v40, v41
    v_cvt_pk_bf16_f32 v127, v42, v43
    v_lshlrev_b32 v8, 16, v124
    v_and_b32 v9, s51, v124
    v_lshlrev_b32 v10, 16, v125
    v_and_b32 v11, s51, v125
    v_lshlrev_b32 v40, 16, v126
    v_and_b32 v41, s51, v126
    v_lshlrev_b32 v42, 16, v127
    v_and_b32 v43, s51, v127
    v_pk_mul_f32 v[128:129], v[8:9], v[8:9]
    v_pk_fma_f32 v[128:129], v[128:129], s[54:55], v[130:131]
    v_pk_mul_f32 v[128:129], v[128:129], v[8:9]
    v_exp_f32 v128, v128
    v_exp_f32 v129, v129
    v_add_f32 v128, 1.0, v128
    v_add_f32 v129, 1.0, v129
    v_rcp_f32 v128, v128
    v_rcp_f32 v129, v129
    s_nop 0
    v_pk_mul_f32 v[8:9], v[8:9], v[128:129]
    v_pk_mul_f32 v[128:129], v[10:11], v[10:11]
    v_pk_fma_f32 v[128:129], v[128:129], s[54:55], v[130:131]
    v_pk_mul_f32 v[128:129], v[128:129], v[10:11]
    v_exp_f32 v128, v128
    v_exp_f32 v129, v129
    v_add_f32 v128, 1.0, v128
    v_add_f32 v129, 1.0, v129
    v_rcp_f32 v128, v128
    v_rcp_f32 v129, v129
    s_nop 0
    v_pk_mul_f32 v[10:11], v[10:11], v[128:129]
    v_cvt_pk_bf16_f32 v124, v8, v9
    v_cvt_pk_bf16_f32 v125, v10, v11
    v_lshlrev_b32 v8, 16, v124
    v_and_b32 v9, s51, v124
    v_lshlrev_b32 v10, 16, v125
    v_and_b32 v11, s51, v125
    v_pk_mul_f32 v[8:9], v[8:9], v[40:41]
    v_pk_mul_f32 v[10:11], v[10:11], v[42:43]
    v_cvt_pk_bf16_f32 v40, v8, v9
    v_cvt_pk_bf16_f32 v41, v10, v11
    buffer_store_dwordx2 v[40:41], v2, s[20:23], 0 offen offset:0
    v_cvt_pk_bf16_f32 v124, v12, v13
    v_cvt_pk_bf16_f32 v125, v14, v15
    v_cvt_pk_bf16_f32 v126, v44, v45
    v_cvt_pk_bf16_f32 v127, v46, v47
    v_lshlrev_b32 v12, 16, v124
    v_and_b32 v13, s51, v124
    v_lshlrev_b32 v14, 16, v125
    v_and_b32 v15, s51, v125
    v_lshlrev_b32 v44, 16, v126
    v_and_b32 v45, s51, v126
    v_lshlrev_b32 v46, 16, v127
    v_and_b32 v47, s51, v127
    v_pk_mul_f32 v[128:129], v[12:13], v[12:13]
    v_pk_fma_f32 v[128:129], v[128:129], s[54:55], v[130:131]
    v_pk_mul_f32 v[128:129], v[128:129], v[12:13]
    v_exp_f32 v128, v128
    v_exp_f32 v129, v129
    v_add_f32 v128, 1.0, v128
    v_add_f32 v129, 1.0, v129
    v_rcp_f32 v128, v128
    v_rcp_f32 v129, v129
    s_nop 0
    v_pk_mul_f32 v[12:13], v[12:13], v[128:129]
    v_pk_mul_f32 v[128:129], v[14:15], v[14:15]
    v_pk_fma_f32 v[128:129], v[128:129], s[54:55], v[130:131]
    v_pk_mul_f32 v[128:129], v[128:129], v[14:15]
    v_exp_f32 v128, v128
    v_exp_f32 v129, v129
    v_add_f32 v128, 1.0, v128
    v_add_f32 v129, 1.0, v129
    v_rcp_f32 v128, v128
    v_rcp_f32 v129, v129
    s_nop 0
    v_pk_mul_f32 v[14:15], v[14:15], v[128:129]
    v_cvt_pk_bf16_f32 v124, v12, v13
    v_cvt_pk_bf16_f32 v125, v14, v15
    v_lshlrev_b32 v12, 16, v124
    v_and_b32 v13, s51, v124
    v_lshlrev_b32 v14, 16, v125
    v_and_b32 v15, s51, v125
    v_pk_mul_f32 v[12:13], v[12:13], v[44:45]
    v_pk_mul_f32 v[14:15], v[14:15], v[46:47]
    v_cvt_pk_bf16_f32 v44, v12, v13
    v_cvt_pk_bf16_f32 v45, v14, v15
    buffer_store_dwordx2 v[44:45], v2, s[20:23], 0 offen offset:16
    v_cvt_pk_bf16_f32 v124, v16, v17
    v_cvt_pk_bf16_f32 v125, v18, v19
    v_cvt_pk_bf16_f32 v126, v48, v49
    v_cvt_pk_bf16_f32 v127, v50, v51
    v_lshlrev_b32 v16, 16, v124
    v_and_b32 v17, s51, v124
    v_lshlrev_b32 v18, 16, v125
    v_and_b32 v19, s51, v125
    v_lshlrev_b32 v48, 16, v126
    v_and_b32 v49, s51, v126
    v_lshlrev_b32 v50, 16, v127
    v_and_b32 v51, s51, v127
    v_pk_mul_f32 v[128:129], v[16:17], v[16:17]
    v_pk_fma_f32 v[128:129], v[128:129], s[54:55], v[130:131]
    v_pk_mul_f32 v[128:129], v[128:129], v[16:17]
    v_exp_f32 v128, v128
    v_exp_f32 v129, v129
    v_add_f32 v128, 1.0, v128
    v_add_f32 v129, 1.0, v129
    v_rcp_f32 v128, v128
    v_rcp_f32 v129, v129
    s_nop 0
    v_pk_mul_f32 v[16:17], v[16:17], v[128:129]
    v_pk_mul_f32 v[128:129], v[18:19], v[18:19]
    v_pk_fma_f32 v[128:129], v[128:129], s[54:55], v[130:131]
    v_pk_mul_f32 v[128:129], v[128:129], v[18:19]
    v_exp_f32 v128, v128
    v_exp_f32 v129, v129
    v_add_f32 v128, 1.0, v128
    v_add_f32 v129, 1.0, v129
    v_rcp_f32 v128, v128
    v_rcp_f32 v129, v129
    s_nop 0
    v_pk_mul_f32 v[18:19], v[18:19], v[128:129]
    v_cvt_pk_bf16_f32 v124, v16, v17
    v_cvt_pk_bf16_f32 v125, v18, v19
    v_lshlrev_b32 v16, 16, v124
    v_and_b32 v17, s51, v124
    v_lshlrev_b32 v18, 16, v125
    v_and_b32 v19, s51, v125
    v_pk_mul_f32 v[16:17], v[16:17], v[48:49]
    v_pk_mul_f32 v[18:19], v[18:19], v[50:51]
    v_cvt_pk_bf16_f32 v48, v16, v17
    v_cvt_pk_bf16_f32 v49, v18, v19
    buffer_store_dwordx2 v[48:49], v2, s[20:23], 0 offen offset:32
    v_cvt_pk_bf16_f32 v124, v20, v21
    v_cvt_pk_bf16_f32 v125, v22, v23
    v_cvt_pk_bf16_f32 v126, v52, v53
    v_cvt_pk_bf16_f32 v127, v54, v55
    v_lshlrev_b32 v20, 16, v124
    v_and_b32 v21, s51, v124
    v_lshlrev_b32 v22, 16, v125
    v_and_b32 v23, s51, v125
    v_lshlrev_b32 v52, 16, v126
    v_and_b32 v53, s51, v126
    v_lshlrev_b32 v54, 16, v127
    v_and_b32 v55, s51, v127
    v_pk_mul_f32 v[128:129], v[20:21], v[20:21]
    v_pk_fma_f32 v[128:129], v[128:129], s[54:55], v[130:131]
    v_pk_mul_f32 v[128:129], v[128:129], v[20:21]
    v_exp_f32 v128, v128
    v_exp_f32 v129, v129
    v_add_f32 v128, 1.0, v128
    v_add_f32 v129, 1.0, v129
    v_rcp_f32 v128, v128
    v_rcp_f32 v129, v129
    s_nop 0
    v_pk_mul_f32 v[20:21], v[20:21], v[128:129]
    v_pk_mul_f32 v[128:129], v[22:23], v[22:23]
    v_pk_fma_f32 v[128:129], v[128:129], s[54:55], v[130:131]
    v_pk_mul_f32 v[128:129], v[128:129], v[22:23]
    v_exp_f32 v128, v128
    v_exp_f32 v129, v129
    v_add_f32 v128, 1.0, v128
    v_add_f32 v129, 1.0, v129
    v_rcp_f32 v128, v128
    v_rcp_f32 v129, v129
    s_nop 0
    v_pk_mul_f32 v[22:23], v[22:23], v[128:129]
    v_cvt_pk_bf16_f32 v124, v20, v21
    v_cvt_pk_bf16_f32 v125, v22, v23
    v_lshlrev_b32 v20, 16, v124
    v_and_b32 v21, s51, v124
    v_lshlrev_b32 v22, 16, v125
    v_and_b32 v23, s51, v125
    v_pk_mul_f32 v[20:21], v[20:21], v[52:53]
    v_pk_mul_f32 v[22:23], v[22:23], v[54:55]
    v_cvt_pk_bf16_f32 v52, v20, v21
    v_cvt_pk_bf16_f32 v53, v22, v23
    buffer_store_dwordx2 v[52:53], v2, s[20:23], 0 offen offset:48
    v_cvt_pk_bf16_f32 v124, v24, v25
    v_cvt_pk_bf16_f32 v125, v26, v27
    v_cvt_pk_bf16_f32 v126, v56, v57
    v_cvt_pk_bf16_f32 v127, v58, v59
    v_lshlrev_b32 v24, 16, v124
    v_and_b32 v25, s51, v124
    v_lshlrev_b32 v26, 16, v125
    v_and_b32 v27, s51, v125
    v_lshlrev_b32 v56, 16, v126
    v_and_b32 v57, s51, v126
    v_lshlrev_b32 v58, 16, v127
    v_and_b32 v59, s51, v127
    v_pk_mul_f32 v[128:129], v[24:25], v[24:25]
    v_pk_fma_f32 v[128:129], v[128:129], s[54:55], v[130:131]
    v_pk_mul_f32 v[128:129], v[128:129], v[24:25]
    v_exp_f32 v128, v128
    v_exp_f32 v129, v129
    v_add_f32 v128, 1.0, v128
    v_add_f32 v129, 1.0, v129
    v_rcp_f32 v128, v128
    v_rcp_f32 v129, v129
    s_nop 0
    v_pk_mul_f32 v[24:25], v[24:25], v[128:129]
    v_pk_mul_f32 v[128:129], v[26:27], v[26:27]
    v_pk_fma_f32 v[128:129], v[128:129], s[54:55], v[130:131]
    v_pk_mul_f32 v[128:129], v[128:129], v[26:27]
    v_exp_f32 v128, v128
    v_exp_f32 v129, v129
    v_add_f32 v128, 1.0, v128
    v_add_f32 v129, 1.0, v129
    v_rcp_f32 v128, v128
    v_rcp_f32 v129, v129
    s_nop 0
    v_pk_mul_f32 v[26:27], v[26:27], v[128:129]
    v_cvt_pk_bf16_f32 v124, v24, v25
    v_cvt_pk_bf16_f32 v125, v26, v27
    v_lshlrev_b32 v24, 16, v124
    v_and_b32 v25, s51, v124
    v_lshlrev_b32 v26, 16, v125
    v_and_b32 v27, s51, v125
    v_pk_mul_f32 v[24:25], v[24:25], v[56:57]
    v_pk_mul_f32 v[26:27], v[26:27], v[58:59]
    v_cvt_pk_bf16_f32 v56, v24, v25
    v_cvt_pk_bf16_f32 v57, v26, v27
    buffer_store_dwordx2 v[56:57], v2, s[20:23], s52 offen offset:0
    v_cvt_pk_bf16_f32 v124, v28, v29
    v_cvt_pk_bf16_f32 v125, v30, v31
    v_cvt_pk_bf16_f32 v126, v60, v61
    v_cvt_pk_bf16_f32 v127, v62, v63
    v_lshlrev_b32 v28, 16, v124
    v_and_b32 v29, s51, v124
    v_lshlrev_b32 v30, 16, v125
    v_and_b32 v31, s51, v125
    v_lshlrev_b32 v60, 16, v126
    v_and_b32 v61, s51, v126
    v_lshlrev_b32 v62, 16, v127
    v_and_b32 v63, s51, v127
    v_pk_mul_f32 v[128:129], v[28:29], v[28:29]
    v_pk_fma_f32 v[128:129], v[128:129], s[54:55], v[130:131]
    v_pk_mul_f32 v[128:129], v[128:129], v[28:29]
    v_exp_f32 v128, v128
    v_exp_f32 v129, v129
    v_add_f32 v128, 1.0, v128
    v_add_f32 v129, 1.0, v129
    v_rcp_f32 v128, v128
    v_rcp_f32 v129, v129
    s_nop 0
    v_pk_mul_f32 v[28:29], v[28:29], v[128:129]
    v_pk_mul_f32 v[128:129], v[30:31], v[30:31]
    v_pk_fma_f32 v[128:129], v[128:129], s[54:55], v[130:131]
    v_pk_mul_f32 v[128:129], v[128:129], v[30:31]
    v_exp_f32 v128, v128
    v_exp_f32 v129, v129
    v_add_f32 v128, 1.0, v128
    v_add_f32 v129, 1.0, v129
    v_rcp_f32 v128, v128
    v_rcp_f32 v129, v129
    s_nop 0
    v_pk_mul_f32 v[30:31], v[30:31], v[128:129]
    v_cvt_pk_bf16_f32 v124, v28, v29
    v_cvt_pk_bf16_f32 v125, v30, v31
    v_lshlrev_b32 v28, 16, v124
    v_and_b32 v29, s51, v124
    v_lshlrev_b32 v30, 16, v125
    v_and_b32 v31, s51, v125
    v_pk_mul_f32 v[28:29], v[28:29], v[60:61]
    v_pk_mul_f32 v[30:31], v[30:31], v[62:63]
    v_cvt_pk_bf16_f32 v60, v28, v29
    v_cvt_pk_bf16_f32 v61, v30, v31
    buffer_store_dwordx2 v[60:61], v2, s[20:23], s52 offen offset:16
    v_cvt_pk_bf16_f32 v124, v32, v33
    v_cvt_pk_bf16_f32 v125, v34, v35
    v_cvt_pk_bf16_f32 v126, v64, v65
    v_cvt_pk_bf16_f32 v127, v66, v67
    v_lshlrev_b32 v32, 16, v124
    v_and_b32 v33, s51, v124
    v_lshlrev_b32 v34, 16, v125
    v_and_b32 v35, s51, v125
    v_lshlrev_b32 v64, 16, v126
    v_and_b32 v65, s51, v126
    v_lshlrev_b32 v66, 16, v127
    v_and_b32 v67, s51, v127
    v_pk_mul_f32 v[128:129], v[32:33], v[32:33]
    v_pk_fma_f32 v[128:129], v[128:129], s[54:55], v[130:131]
    v_pk_mul_f32 v[128:129], v[128:129], v[32:33]
    v_exp_f32 v128, v128
    v_exp_f32 v129, v129
    v_add_f32 v128, 1.0, v128
    v_add_f32 v129, 1.0, v129
    v_rcp_f32 v128, v128
    v_rcp_f32 v129, v129
    s_nop 0
    v_pk_mul_f32 v[32:33], v[32:33], v[128:129]
    v_pk_mul_f32 v[128:129], v[34:35], v[34:35]
    v_pk_fma_f32 v[128:129], v[128:129], s[54:55], v[130:131]
    v_pk_mul_f32 v[128:129], v[128:129], v[34:35]
    v_exp_f32 v128, v128
    v_exp_f32 v129, v129
    v_add_f32 v128, 1.0, v128
    v_add_f32 v129, 1.0, v129
    v_rcp_f32 v128, v128
    v_rcp_f32 v129, v129
    s_nop 0
    v_pk_mul_f32 v[34:35], v[34:35], v[128:129]
    v_cvt_pk_bf16_f32 v124, v32, v33
    v_cvt_pk_bf16_f32 v125, v34, v35
    v_lshlrev_b32 v32, 16, v124
    v_and_b32 v33, s51, v124
    v_lshlrev_b32 v34, 16, v125
    v_and_b32 v35, s51, v125
    v_pk_mul_f32 v[32:33], v[32:33], v[64:65]
    v_pk_mul_f32 v[34:35], v[34:35], v[66:67]
    v_cvt_pk_bf16_f32 v64, v32, v33
    v_cvt_pk_bf16_f32 v65, v34, v35
    buffer_store_dwordx2 v[64:65], v2, s[20:23], s52 offen offset:32
    v_cvt_pk_bf16_f32 v124, v36, v37
    v_cvt_pk_bf16_f32 v125, v38, v39
    v_cvt_pk_bf16_f32 v126, v68, v69
    v_cvt_pk_bf16_f32 v127, v70, v71
    v_lshlrev_b32 v36, 16, v124
    v_and_b32 v37, s51, v124
    v_lshlrev_b32 v38, 16, v125
    v_and_b32 v39, s51, v125
    v_lshlrev_b32 v68, 16, v126
    v_and_b32 v69, s51, v126
    v_lshlrev_b32 v70, 16, v127
    v_and_b32 v71, s51, v127
    v_pk_mul_f32 v[128:129], v[36:37], v[36:37]
    v_pk_fma_f32 v[128:129], v[128:129], s[54:55], v[130:131]
    v_pk_mul_f32 v[128:129], v[128:129], v[36:37]
    v_exp_f32 v128, v128
    v_exp_f32 v129, v129
    v_add_f32 v128, 1.0, v128
    v_add_f32 v129, 1.0, v129
    v_rcp_f32 v128, v128
    v_rcp_f32 v129, v129
    s_nop 0
    v_pk_mul_f32 v[36:37], v[36:37], v[128:129]
    v_pk_mul_f32 v[128:129], v[38:39], v[38:39]
    v_pk_fma_f32 v[128:129], v[128:129], s[54:55], v[130:131]
    v_pk_mul_f32 v[128:129], v[128:129], v[38:39]
    v_exp_f32 v128, v128
    v_exp_f32 v129, v129
    v_add_f32 v128, 1.0, v128
    v_add_f32 v129, 1.0, v129
    v_rcp_f32 v128, v128
    v_rcp_f32 v129, v129
    s_nop 0
    v_pk_mul_f32 v[38:39], v[38:39], v[128:129]
    v_cvt_pk_bf16_f32 v124, v36, v37
    v_cvt_pk_bf16_f32 v125, v38, v39
    v_lshlrev_b32 v36, 16, v124
    v_and_b32 v37, s51, v124
    v_lshlrev_b32 v38, 16, v125
    v_and_b32 v39, s51, v125
    v_pk_mul_f32 v[36:37], v[36:37], v[68:69]
    v_pk_mul_f32 v[38:39], v[38:39], v[70:71]
    v_cvt_pk_bf16_f32 v68, v36, v37
    v_cvt_pk_bf16_f32 v69, v38, v39
    buffer_store_dwordx2 v[68:69], v2, s[20:23], s52 offen offset:48
L_gu1_kernel_end:
    s_endpgm
.globl dn1_kernel
.p2align 8
.type dn1_kernel,@function
dn1_kernel:
    s_cmp_ge_u32 s2, 160
    s_cbranch_scc1 L_dn1_kernel_end
    s_load_dwordx2 s[4:5], s[0:1], 88
    s_load_dwordx2 s[6:7], s[0:1], 88
    s_load_dwordx2 s[40:41], s[0:1], 64
    s_and_b32 s28, s2, 7
    s_mul_i32 s28, s28, 20
    s_lshr_b32 s29, s2, 3
    s_add_u32 s28, s28, s29
    s_lshr_b32 s29, s28, 5
    s_and_b32 s28, s28, 31
    v_lshrrev_b32 v1, 6, v0
    v_and_b32 v5, 63, v0
    v_readfirstlane_b32 s39, v1
    v_and_b32 v6, 31, v0
    v_lshrrev_b32 v7, 5, v5
    s_waitcnt lgkmcnt(0)
    s_and_b32 s37, s39, 1
    s_lshr_b32 s38, s39, 1
    s_add_u32 s8, s4, 0xf68000
    s_addc_u32 s9, s5, 0
    s_mov_b32 s10, 0x6c0000
    s_mov_b32 s11, 0x20000
    s_mul_i32 s30, s28, 221184
    s_lshl_b32 s3, s29, 8
    s_add_u32 s12, s40, s3
    s_addc_u32 s13, s41, 0
    s_sub_u32 s14, 0x21c000, s3
    s_mov_b32 s15, 0x20000
    s_add_u32 s16, s12, 128
    s_addc_u32 s17, s13, 0
    s_sub_u32 s18, s14, 128
    s_mov_b32 s19, 0x20000
    s_mov_b32 s33, 1280
    s_lshl_b32 s32, s33, 6
    s_mov_b32 s31, 0
    s_mul_i32 s34, s39, 2048
    s_lshl_b32 s35, s39, 11
    s_add_u32 s35, s35, 8192
    v_lshrrev_b32 v1, 3, v5
    v_lshrrev_b32 v2, 4, v5
    v_and_b32 v3, 7, v5
    s_mul_i32 s3, s39, 16
    v_add_u32 v4, 0, v2
    v_and_b32 v4, 7, v4
    v_xor_b32 v4, v4, v3
    v_add_u32 v64, s3, v1
    v_mul_u32_u24 v64, 0xd80, v64
    v_lshl_add_u32 v64, v4, 4, v64
    v_add_u32 v4, 4, v2
    v_and_b32 v4, 7, v4
    v_xor_b32 v4, v4, v3
    v_add_u32 v65, s3, v1
    v_add_u32 v65, 8, v65
    v_mul_u32_u24 v65, 0xd80, v65
    v_lshl_add_u32 v65, v4, 4, v65
    v_subrev_u32 v65, 1024, v65
    v_and_b32 v4, 1, v2
    v_lshlrev_b32 v4, 2, v4
    v_xor_b32 v4, v4, v3
    s_lshl_b32 s3, s39, 4
    v_add_u32 v66, s3, v1
    v_mul_lo_u32 v66, v66, s33
    v_lshl_add_u32 v66, v4, 4, v66
    v_add_u32 v67, s3, v1
    v_add_u32 v67, 8, v67
    v_mul_lo_u32 v67, v67, s33
    v_lshl_add_u32 v67, v4, 4, v67
    v_subrev_u32 v67, 1024, v67
    s_mul_i32 s3, s38, 32
    v_add_u32 v1, s3, v6
    v_lshlrev_b32 v1, 7, v1
    v_bfe_u32 v2, v5, 1, 3
    v_add_u32 v3, 0, v7
    v_xor_b32 v3, v3, v2
    v_lshl_add_u32 v68, v3, 4, v1
    v_add_u32 v3, 2, v7
    v_xor_b32 v3, v3, v2
    v_lshl_add_u32 v69, v3, 4, v1
    v_add_u32 v3, 4, v7
    v_xor_b32 v3, v3, v2
    v_lshl_add_u32 v70, v3, 4, v1
    v_add_u32 v3, 6, v7
    v_xor_b32 v3, v3, v2
    v_lshl_add_u32 v71, v3, 4, v1
    v_lshrrev_b32 v1, 5, v5
    v_lshlrev_b32 v1, 3, v1
    v_bfe_u32 v2, v5, 2, 2
    v_add_u32 v1, v1, v2
    v_lshlrev_b32 v72, 7, v1
    v_bfe_u32 v1, v5, 4, 1
    v_lshlrev_b32 v1, 1, v1
    v_bfe_u32 v2, v5, 1, 1
    v_add_u32 v1, v1, v2
    s_lshl_b32 s3, s37, 2
    v_add_u32 v1, s3, v1
    v_bfe_u32 v2, v5, 3, 1
    v_lshlrev_b32 v2, 2, v2
    v_xor_b32 v1, v1, v2
    v_lshl_add_u32 v72, v1, 4, v72
    v_and_b32 v1, 1, v5
    v_lshl_add_u32 v72, v1, 3, v72
    v_add_u32 v72, 8192, v72
    s_mov_b32 s36, 0
    s_mov_b32 s58, 0
    s_add_u32 m0, s36, s34
    s_nop 0
    buffer_load_dwordx4 v64, s[8:11], s30 offen offset:0 lds
    buffer_load_dwordx4 v65, s[8:11], s30 offen offset:1024 lds
    s_add_u32 m0, s36, s35
    s_nop 0
    buffer_load_dwordx4 v66, s[12:15], s31 offen lds
    buffer_load_dwordx4 v67, s[12:15], s31 offen offset:1024 lds
    s_add_u32 m0, m0, 0x2000
    s_nop 0
    buffer_load_dwordx4 v66, s[16:19], s31 offen lds
    buffer_load_dwordx4 v67, s[16:19], s31 offen offset:1024 lds
    s_add_u32 s30, s30, 128
    s_add_u32 s31, s31, s32
    s_add_u32 s36, s36, 24576
    s_add_u32 s58, s58, 1
    s_cmp_eq_u32 s58, 5
    s_cselect_b32 s36, 0, s36
    s_cselect_b32 s58, 0, s58
    s_add_u32 m0, s36, s34
    s_nop 0
    buffer_load_dwordx4 v64, s[8:11], s30 offen offset:0 lds
    buffer_load_dwordx4 v65, s[8:11], s30 offen offset:1024 lds
    s_add_u32 m0, s36, s35
    s_nop 0
    buffer_load_dwordx4 v66, s[12:15], s31 offen lds
    buffer_load_dwordx4 v67, s[12:15], s31 offen offset:1024 lds
    s_add_u32 m0, m0, 0x2000
    s_nop 0
    buffer_load_dwordx4 v66, s[16:19], s31 offen lds
    buffer_load_dwordx4 v67, s[16:19], s31 offen offset:1024 lds
    s_add_u32 s30, s30, 128
    s_add_u32 s31, s31, s32
    s_add_u32 s36, s36, 24576
    s_add_u32 s58, s58, 1
    s_cmp_eq_u32 s58, 5
    s_cselect_b32 s36, 0, s36
    s_cselect_b32 s58, 0, s58
    s_add_u32 m0, s36, s34
    s_nop 0
    buffer_load_dwordx4 v64, s[8:11], s30 offen offset:0 lds
    buffer_load_dwordx4 v65, s[8:11], s30 offen offset:1024 lds
    s_add_u32 m0, s36, s35
    s_nop 0
    buffer_load_dwordx4 v66, s[12:15], s31 offen lds
    buffer_load_dwordx4 v67, s[12:15], s31 offen offset:1024 lds
    s_add_u32 m0, m0, 0x2000
    s_nop 0
    buffer_load_dwordx4 v66, s[16:19], s31 offen lds
    buffer_load_dwordx4 v67, s[16:19], s31 offen offset:1024 lds
    s_add_u32 s30, s30, 128
    s_add_u32 s31, s31, s32
    s_add_u32 s36, s36, 24576
    s_add_u32 s58, s58, 1
    s_cmp_eq_u32 s58, 5
    s_cselect_b32 s36, 0, s36
    s_cselect_b32 s58, 0, s58
    s_add_u32 m0, s36, s34
    s_nop 0
    buffer_load_dwordx4 v64, s[8:11], s30 offen offset:0 lds
    buffer_load_dwordx4 v65, s[8:11], s30 offen offset:1024 lds
    s_add_u32 m0, s36, s35
    s_nop 0
    buffer_load_dwordx4 v66, s[12:15], s31 offen lds
    buffer_load_dwordx4 v67, s[12:15], s31 offen offset:1024 lds
    s_add_u32 m0, m0, 0x2000
    s_nop 0
    buffer_load_dwordx4 v66, s[16:19], s31 offen lds
    buffer_load_dwordx4 v67, s[16:19], s31 offen offset:1024 lds
    s_add_u32 s30, s30, 128
    s_add_u32 s31, s31, s32
    s_add_u32 s36, s36, 24576
    s_add_u32 s58, s58, 1
    s_cmp_eq_u32 s58, 5
    s_cselect_b32 s36, 0, s36
    s_cselect_b32 s58, 0, s58
    s_mov_b32 s59, 0
    s_mov_b32 s60, 0xfffe8000
    s_mov_b32 s61, 24576
    s_mov_b32 s49, 0
    v_mov_b32 v8, 0
    v_mov_b32 v9, 0
    v_mov_b32 v10, 0
    v_mov_b32 v11, 0
    v_mov_b32 v12, 0
    v_mov_b32 v13, 0
    v_mov_b32 v14, 0
    v_mov_b32 v15, 0
    v_mov_b32 v16, 0
    v_mov_b32 v17, 0
    v_mov_b32 v18, 0
    v_mov_b32 v19, 0
    v_mov_b32 v20, 0
    v_mov_b32 v21, 0
    v_mov_b32 v22, 0
    v_mov_b32 v23, 0
    v_mov_b32 v24, 0
    v_mov_b32 v25, 0
    v_mov_b32 v26, 0
    v_mov_b32 v27, 0
    v_mov_b32 v28, 0
    v_mov_b32 v29, 0
    v_mov_b32 v30, 0
    v_mov_b32 v31, 0
    v_mov_b32 v32, 0
    v_mov_b32 v33, 0
    v_mov_b32 v34, 0
    v_mov_b32 v35, 0
    v_mov_b32 v36, 0
    v_mov_b32 v37, 0
    v_mov_b32 v38, 0
    v_mov_b32 v39, 0
L_dn1_kernel_loop:
    s_waitcnt vmcnt(18)
    s_barrier
    s_add_u32 m0, s36, s34
    s_nop 0
    buffer_load_dwordx4 v64, s[8:11], s30 offen offset:0 lds
    buffer_load_dwordx4 v65, s[8:11], s30 offen offset:1024 lds
    s_add_u32 m0, s36, s35
    s_nop 0
    buffer_load_dwordx4 v66, s[12:15], s31 offen lds
    buffer_load_dwordx4 v67, s[12:15], s31 offen offset:1024 lds
    s_add_u32 m0, m0, 0x2000
    s_nop 0
    buffer_load_dwordx4 v66, s[16:19], s31 offen lds
    buffer_load_dwordx4 v67, s[16:19], s31 offen offset:1024 lds
    s_add_u32 s30, s30, 128
    s_add_u32 s31, s31, s32
    s_add_u32 s36, s36, 24576
    s_add_u32 s58, s58, 1
    s_cmp_eq_u32 s58, 5
    s_cselect_b32 s36, 0, s36
    s_cselect_b32 s58, 0, s58
    ds_read_b128 v[48:51], v68 offset:0
    ds_read_b64_tr_b16 v[40:41], v72 offset:0
    ds_read_b64_tr_b16 v[42:43], v72 offset:512
    ds_read_b64_tr_b16 v[44:45], v72 offset:8192
    ds_read_b64_tr_b16 v[46:47], v72 offset:8704
    ds_read_b128 v[60:63], v69 offset:0
    ds_read_b64_tr_b16 v[52:53], v72 offset:2048
    ds_read_b64_tr_b16 v[54:55], v72 offset:2560
    ds_read_b64_tr_b16 v[56:57], v72 offset:10240
    ds_read_b64_tr_b16 v[58:59], v72 offset:10752
    s_waitcnt lgkmcnt(5)
    v_mfma_f32_32x32x16_bf16 v[8:23], v[40:43], v[48:51], v[8:23]
    v_mfma_f32_32x32x16_bf16 v[24:39], v[44:47], v[48:51], v[24:39]
    ds_read_b128 v[48:51], v70 offset:0
    ds_read_b64_tr_b16 v[40:41], v72 offset:4096
    ds_read_b64_tr_b16 v[42:43], v72 offset:4608
    ds_read_b64_tr_b16 v[44:45], v72 offset:12288
    ds_read_b64_tr_b16 v[46:47], v72 offset:12800
    s_waitcnt lgkmcnt(5)
    v_mfma_f32_32x32x16_bf16 v[8:23], v[52:55], v[60:63], v[8:23]
    v_mfma_f32_32x32x16_bf16 v[24:39], v[56:59], v[60:63], v[24:39]
    ds_read_b128 v[60:63], v71 offset:0
    ds_read_b64_tr_b16 v[52:53], v72 offset:6144
    ds_read_b64_tr_b16 v[54:55], v72 offset:6656
    ds_read_b64_tr_b16 v[56:57], v72 offset:14336
    ds_read_b64_tr_b16 v[58:59], v72 offset:14848
    s_waitcnt lgkmcnt(5)
    v_mfma_f32_32x32x16_bf16 v[8:23], v[40:43], v[48:51], v[8:23]
    v_mfma_f32_32x32x16_bf16 v[24:39], v[44:47], v[48:51], v[24:39]
    s_waitcnt lgkmcnt(0)
    v_mfma_f32_32x32x16_bf16 v[8:23], v[52:55], v[60:63], v[8:23]
    v_mfma_f32_32x32x16_bf16 v[24:39], v[56:59], v[60:63], v[24:39]
    s_add_u32 s59, s59, 1
    s_cmp_eq_u32 s59, 5
    s_cselect_b32 s48, s60, s61
    s_cselect_b32 s59, 0, s59
    v_add_u32 v68, s48, v68
    v_add_u32 v69, s48, v69
    v_add_u32 v70, s48, v70
    v_add_u32 v71, s48, v71
    v_add_u32 v72, s48, v72
    s_add_u32 s49, s49, 1
    s_cmp_lt_u32 s49, 27
    s_cbranch_scc1 L_dn1_kernel_loop
    s_waitcnt vmcnt(0)
    s_mul_i32 s3, s28, 64
    s_mul_i32 s50, s38, 32
    s_add_u32 s3, s3, s50
    v_add_u32 v1, s3, v6
    s_mov_b32 s51, 0xffff0000
    s_add_u32 s20, s6, 0xa68000
    s_addc_u32 s21, s7, 0
    s_mov_b32 s22, 0x280000
    s_mov_b32 s23, 0x20000
    s_add_u32 s24, s6, 0x7e8000
    s_addc_u32 s25, s7, 0
    s_mov_b32 s26, 0x280000
    s_mov_b32 s27, 0x20000
    v_mul_u32_u24 v2, 0x500, v1
    s_lshl_b32 s3, s29, 8
    s_lshl_b32 s50, s37, 6
    s_add_u32 s3, s3, s50
    v_add_u32 v2, s3, v2
    v_lshl_add_u32 v2, v7, 3, v2
    s_mov_b32 s52, 0xa000
    buffer_load_dwordx2 v[40:41], v2, s[24:27], 0 offen offset:0
    buffer_load_dwordx2 v[42:43], v2, s[24:27], 0 offen offset:16
    buffer_load_dwordx2 v[44:45], v2, s[24:27], 0 offen offset:32
    buffer_load_dwordx2 v[46:47], v2, s[24:27], 0 offen offset:48
    buffer_load_dwordx2 v[48:49], v2, s[24:27], 0 offen offset:128
    buffer_load_dwordx2 v[50:51], v2, s[24:27], 0 offen offset:144
    buffer_load_dwordx2 v[52:53], v2, s[24:27], 0 offen offset:160
    buffer_load_dwordx2 v[54:55], v2, s[24:27], 0 offen offset:176
    v_mov_b32 v80, 0x3f803f80
    v_mov_b32 v82, 0
    v_mov_b32 v83, 0
    v_cvt_pk_bf16_f32 v74, v8, v9
    v_cvt_pk_bf16_f32 v75, v10, v11
    v_lshlrev_b32 v8, 16, v74
    v_and_b32 v9, s51, v74
    v_lshlrev_b32 v10, 16, v75
    v_and_b32 v11, s51, v75
    s_waitcnt vmcnt(0)
    v_lshlrev_b32 v76, 16, v40
    v_and_b32 v77, s51, v40
    v_lshlrev_b32 v78, 16, v41
    v_and_b32 v79, s51, v41
    v_pk_add_f32 v[8:9], v[8:9], v[76:77]
    v_pk_add_f32 v[10:11], v[10:11], v[78:79]
    v_cvt_pk_bf16_f32 v40, v8, v9
    v_cvt_pk_bf16_f32 v41, v10, v11
    buffer_store_dwordx2 v[40:41], v2, s[20:23], 0 offen offset:0
    v_dot2c_f32_bf16 v82, v40, v80
    v_dot2c_f32_bf16 v83, v40, v40
    v_dot2c_f32_bf16 v82, v41, v80
    v_dot2c_f32_bf16 v83, v41, v41
    v_cvt_pk_bf16_f32 v74, v12, v13
    v_cvt_pk_bf16_f32 v75, v14, v15
    v_lshlrev_b32 v12, 16, v74
    v_and_b32 v13, s51, v74
    v_lshlrev_b32 v14, 16, v75
    v_and_b32 v15, s51, v75
    v_lshlrev_b32 v76, 16, v42
    v_and_b32 v77, s51, v42
    v_lshlrev_b32 v78, 16, v43
    v_and_b32 v79, s51, v43
    v_pk_add_f32 v[12:13], v[12:13], v[76:77]
    v_pk_add_f32 v[14:15], v[14:15], v[78:79]
    v_cvt_pk_bf16_f32 v42, v12, v13
    v_cvt_pk_bf16_f32 v43, v14, v15
    buffer_store_dwordx2 v[42:43], v2, s[20:23], 0 offen offset:16
    v_dot2c_f32_bf16 v82, v42, v80
    v_dot2c_f32_bf16 v83, v42, v42
    v_dot2c_f32_bf16 v82, v43, v80
    v_dot2c_f32_bf16 v83, v43, v43
    v_cvt_pk_bf16_f32 v74, v16, v17
    v_cvt_pk_bf16_f32 v75, v18, v19
    v_lshlrev_b32 v16, 16, v74
    v_and_b32 v17, s51, v74
    v_lshlrev_b32 v18, 16, v75
    v_and_b32 v19, s51, v75
    v_lshlrev_b32 v76, 16, v44
    v_and_b32 v77, s51, v44
    v_lshlrev_b32 v78, 16, v45
    v_and_b32 v79, s51, v45
    v_pk_add_f32 v[16:17], v[16:17], v[76:77]
    v_pk_add_f32 v[18:19], v[18:19], v[78:79]
    v_cvt_pk_bf16_f32 v44, v16, v17
    v_cvt_pk_bf16_f32 v45, v18, v19
    buffer_store_dwordx2 v[44:45], v2, s[20:23], 0 offen offset:32
    v_dot2c_f32_bf16 v82, v44, v80
    v_dot2c_f32_bf16 v83, v44, v44
    v_dot2c_f32_bf16 v82, v45, v80
    v_dot2c_f32_bf16 v83, v45, v45
    v_cvt_pk_bf16_f32 v74, v20, v21
    v_cvt_pk_bf16_f32 v75, v22, v23
    v_lshlrev_b32 v20, 16, v74
    v_and_b32 v21, s51, v74
    v_lshlrev_b32 v22, 16, v75
    v_and_b32 v23, s51, v75
    v_lshlrev_b32 v76, 16, v46
    v_and_b32 v77, s51, v46
    v_lshlrev_b32 v78, 16, v47
    v_and_b32 v79, s51, v47
    v_pk_add_f32 v[20:21], v[20:21], v[76:77]
    v_pk_add_f32 v[22:23], v[22:23], v[78:79]
    v_cvt_pk_bf16_f32 v46, v20, v21
    v_cvt_pk_bf16_f32 v47, v22, v23
    buffer_store_dwordx2 v[46:47], v2, s[20:23], 0 offen offset:48
    v_dot2c_f32_bf16 v82, v46, v80
    v_dot2c_f32_bf16 v83, v46, v46
    v_dot2c_f32_bf16 v82, v47, v80
    v_dot2c_f32_bf16 v83, v47, v47
    v_cvt_pk_bf16_f32 v74, v24, v25
    v_cvt_pk_bf16_f32 v75, v26, v27
    v_lshlrev_b32 v24, 16, v74
    v_and_b32 v25, s51, v74
    v_lshlrev_b32 v26, 16, v75
    v_and_b32 v27, s51, v75
    v_lshlrev_b32 v76, 16, v48
    v_and_b32 v77, s51, v48
    v_lshlrev_b32 v78, 16, v49
    v_and_b32 v79, s51, v49
    v_pk_add_f32 v[24:25], v[24:25], v[76:77]
    v_pk_add_f32 v[26:27], v[26:27], v[78:79]
    v_cvt_pk_bf16_f32 v48, v24, v25
    v_cvt_pk_bf16_f32 v49, v26, v27
    buffer_store_dwordx2 v[48:49], v2, s[20:23], 0 offen offset:128
    v_dot2c_f32_bf16 v82, v48, v80
    v_dot2c_f32_bf16 v83, v48, v48
    v_dot2c_f32_bf16 v82, v49, v80
    v_dot2c_f32_bf16 v83, v49, v49
    v_cvt_pk_bf16_f32 v74, v28, v29
    v_cvt_pk_bf16_f32 v75, v30, v31
    v_lshlrev_b32 v28, 16, v74
    v_and_b32 v29, s51, v74
    v_lshlrev_b32 v30, 16, v75
    v_and_b32 v31, s51, v75
    v_lshlrev_b32 v76, 16, v50
    v_and_b32 v77, s51, v50
    v_lshlrev_b32 v78, 16, v51
    v_and_b32 v79, s51, v51
    v_pk_add_f32 v[28:29], v[28:29], v[76:77]
    v_pk_add_f32 v[30:31], v[30:31], v[78:79]
    v_cvt_pk_bf16_f32 v50, v28, v29
    v_cvt_pk_bf16_f32 v51, v30, v31
    buffer_store_dwordx2 v[50:51], v2, s[20:23], 0 offen offset:144
    v_dot2c_f32_bf16 v82, v50, v80
    v_dot2c_f32_bf16 v83, v50, v50
    v_dot2c_f32_bf16 v82, v51, v80
    v_dot2c_f32_bf16 v83, v51, v51
    v_cvt_pk_bf16_f32 v74, v32, v33
    v_cvt_pk_bf16_f32 v75, v34, v35
    v_lshlrev_b32 v32, 16, v74
    v_and_b32 v33, s51, v74
    v_lshlrev_b32 v34, 16, v75
    v_and_b32 v35, s51, v75
    v_lshlrev_b32 v76, 16, v52
    v_and_b32 v77, s51, v52
    v_lshlrev_b32 v78, 16, v53
    v_and_b32 v79, s51, v53
    v_pk_add_f32 v[32:33], v[32:33], v[76:77]
    v_pk_add_f32 v[34:35], v[34:35], v[78:79]
    v_cvt_pk_bf16_f32 v52, v32, v33
    v_cvt_pk_bf16_f32 v53, v34, v35
    buffer_store_dwordx2 v[52:53], v2, s[20:23], 0 offen offset:160
    v_dot2c_f32_bf16 v82, v52, v80
    v_dot2c_f32_bf16 v83, v52, v52
    v_dot2c_f32_bf16 v82, v53, v80
    v_dot2c_f32_bf16 v83, v53, v53
    v_cvt_pk_bf16_f32 v74, v36, v37
    v_cvt_pk_bf16_f32 v75, v38, v39
    v_lshlrev_b32 v36, 16, v74
    v_and_b32 v37, s51, v74
    v_lshlrev_b32 v38, 16, v75
    v_and_b32 v39, s51, v75
    v_lshlrev_b32 v76, 16, v54
    v_and_b32 v77, s51, v54
    v_lshlrev_b32 v78, 16, v55
    v_and_b32 v79, s51, v55
    v_pk_add_f32 v[36:37], v[36:37], v[76:77]
    v_pk_add_f32 v[38:39], v[38:39], v[78:79]
    v_cvt_pk_bf16_f32 v54, v36, v37
    v_cvt_pk_bf16_f32 v55, v38, v39
    buffer_store_dwordx2 v[54:55], v2, s[20:23], 0 offen offset:176
    v_dot2c_f32_bf16 v82, v54, v80
    v_dot2c_f32_bf16 v83, v54, v54
    v_dot2c_f32_bf16 v82, v55, v80
    v_dot2c_f32_bf16 v83, v55, v55
    s_add_u32 s24, s6, 0x1628000
    s_addc_u32 s25, s7, 0
    s_mov_b32 s26, 0x50000
    s_mov_b32 s27, 0x20000
    v_mul_u32_u24 v2, 160, v1
    s_lshl_b32 s3, s29, 5
    s_lshl_b32 s50, s37, 4
    s_add_u32 s3, s3, s50
    v_add_u32 v2, s3, v2
    v_lshl_add_u32 v2, v7, 3, v2
    s_mov_b32 s52, 5120
    buffer_store_dwordx2 v[82:83], v2, s[24:27], 0 offen
L_dn1_kernel_end:
    s_endpgm
.globl qkv2_kernel
.p2align 8
.type qkv2_kernel,@function
qkv2_kernel:
    s_cmp_ge_u32 s2, 192
    s_cbranch_scc1 L_qkv2_kernel_end
    s_load_dwordx2 s[4:5], s[0:1], 88
    s_load_dwordx2 s[6:7], s[0:1], 88
    s_load_dwordx2 s[40:41], s[0:1], 8
    s_and_b32 s28, s2, 7
    s_mul_i32 s28, s28, 24
    s_lshr_b32 s29, s2, 3
    s_add_u32 s28, s28, s29
    s_lshr_b32 s29, s28, 5
    s_and_b32 s28, s28, 31
    v_lshrrev_b32 v1, 6, v0
    v_and_b32 v5, 63, v0
    v_readfirstlane_b32 s39, v1
    v_and_b32 v6, 31, v0
    v_lshrrev_b32 v7, 5, v5
    s_waitcnt lgkmcnt(0)
    s_and_b32 s37, s39, 1
    s_lshr_b32 s38, s39, 1
    s_add_u32 s24, s6, 0x1628000
    s_addc_u32 s25, s7, 0
    s_mov_b32 s26, 0x50000
    s_mov_b32 s27, 0x20000
    s_mul_i32 s3, s28, 64
    s_mul_i32 s50, s38, 32
    s_add_u32 s3, s3, s50
    v_add_u32 v2, s3, v6
    v_mul_u32_u24 v2, 160, v2
    s_mov_b32 s50, 5120
    buffer_load_dwordx4 v[8:11], v2, s[24:27], 0 offen offset:0
    buffer_load_dwordx4 v[12:15], v2, s[24:27], 0 offen offset:16
    buffer_load_dwordx4 v[16:19], v2, s[24:27], 0 offen offset:32
    buffer_load_dwordx4 v[20:23], v2, s[24:27], 0 offen offset:48
    buffer_load_dwordx4 v[24:27], v2, s[24:27], 0 offen offset:64
    buffer_load_dwordx4 v[28:31], v2, s[24:27], 0 offen offset:80
    buffer_load_dwordx4 v[32:35], v2, s[24:27], 0 offen offset:96
    buffer_load_dwordx4 v[36:39], v2, s[24:27], 0 offen offset:112
    buffer_load_dwordx4 v[40:43], v2, s[24:27], 0 offen offset:128
    buffer_load_dwordx4 v[44:47], v2, s[24:27], 0 offen offset:144
    s_add_u32 s8, s4, 0xa68000
    s_addc_u32 s9, s5, 0
    s_mov_b32 s10, 0x280000
    s_mov_b32 s11, 0x20000
    s_mul_i32 s30, s28, 81920
    s_lshl_b32 s3, s29, 8
    s_add_u32 s12, s40, s3
    s_addc_u32 s13, s41, 0
    s_sub_u32 s14, 0xc8000, s3
    s_mov_b32 s33, 0x500
    s_cmp_lt_u32 s29, 5
    s_cbranch_scc1 L_qkv2_kernel_wq
    s_add_u32 s12, s6, 0x540000
    s_addc_u32 s13, s7, 0
    s_mov_b32 s14, 0x28000
    s_mov_b32 s33, 256
L_qkv2_kernel_wq:
    s_mov_b32 s15, 0x20000
    s_add_u32 s16, s12, 128
    s_addc_u32 s17, s13, 0
    s_sub_u32 s18, s14, 128
    s_mov_b32 s19, 0x20000
    s_lshl_b32 s32, s33, 6
    s_mov_b32 s31, 0
    s_mul_i32 s34, s39, 2048
    s_lshl_b32 s35, s39, 11
    s_add_u32 s35, s35, 8192
    v_lshrrev_b32 v1, 3, v5
    v_lshrrev_b32 v2, 4, v5
    v_and_b32 v3, 7, v5
    s_mul_i32 s3, s39, 16
    v_add_u32 v4, 0, v2
    v_and_b32 v4, 7, v4
    v_xor_b32 v4, v4, v3
    v_add_u32 v64, s3, v1
    v_mul_u32_u24 v64, 0x500, v64
    v_lshl_add_u32 v64, v4, 4, v64
    v_add_u32 v4, 4, v2
    v_and_b32 v4, 7, v4
    v_xor_b32 v4, v4, v3
    v_add_u32 v65, s3, v1
    v_add_u32 v65, 8, v65
    v_mul_u32_u24 v65, 0x500, v65
    v_lshl_add_u32 v65, v4, 4, v65
    v_subrev_u32 v65, 1024, v65
    v_and_b32 v4, 1, v2
    v_lshlrev_b32 v4, 2, v4
    v_xor_b32 v4, v4, v3
    s_lshl_b32 s3, s39, 4
    v_add_u32 v66, s3, v1
    v_mul_lo_u32 v66, v66, s33
    v_lshl_add_u32 v66, v4, 4, v66
    v_add_u32 v67, s3, v1
    v_add_u32 v67, 8, v67
    v_mul_lo_u32 v67, v67, s33
    v_lshl_add_u32 v67, v4, 4, v67
    v_subrev_u32 v67, 1024, v67
    s_mul_i32 s3, s38, 32
    v_add_u32 v1, s3, v6
    v_lshlrev_b32 v1, 7, v1
    v_bfe_u32 v2, v5, 1, 3
    v_add_u32 v3, 0, v7
    v_xor_b32 v3, v3, v2
    v_lshl_add_u32 v68, v3, 4, v1
    v_add_u32 v3, 2, v7
    v_xor_b32 v3, v3, v2
    v_lshl_add_u32 v69, v3, 4, v1
    v_add_u32 v3, 4, v7
    v_xor_b32 v3, v3, v2
    v_lshl_add_u32 v70, v3, 4, v1
    v_add_u32 v3, 6, v7
    v_xor_b32 v3, v3, v2
    v_lshl_add_u32 v71, v3, 4, v1
    v_lshrrev_b32 v1, 5, v5
    v_lshlrev_b32 v1, 3, v1
    v_bfe_u32 v2, v5, 2, 2
    v_add_u32 v1, v1, v2
    v_lshlrev_b32 v72, 7, v1
    v_bfe_u32 v1, v5, 4, 1
    v_lshlrev_b32 v1, 1, v1
    v_bfe_u32 v2, v5, 1, 1
    v_add_u32 v1, v1, v2
    s_lshl_b32 s3, s37, 2
    v_add_u32 v1, s3, v1
    v_bfe_u32 v2, v5, 3, 1
    v_lshlrev_b32 v2, 2, v2
    v_xor_b32 v1, v1, v2
    v_lshl_add_u32 v72, v1, 4, v72
    v_and_b32 v1, 1, v5
    v_lshl_add_u32 v72, v1, 3, v72
    v_add_u32 v72, 8192, v72
    s_mov_b32 s36, 0
    s_mov_b32 s58, 0
    s_add_u32 m0, s36, s34
    s_nop 0
    buffer_load_dwordx4 v64, s[8:11], s30 offen offset:0 lds
    buffer_load_dwordx4 v65, s[8:11], s30 offen offset:1024 lds
    s_add_u32 m0, s36, s35
    s_nop 0
    buffer_load_dwordx4 v66, s[12:15], s31 offen lds
    buffer_load_dwordx4 v67, s[12:15], s31 offen offset:1024 lds
    s_add_u32 m0, m0, 0x2000
    s_nop 0
    buffer_load_dwordx4 v66, s[16:19], s31 offen lds
    buffer_load_dwordx4 v67, s[16:19], s31 offen offset:1024 lds
    s_add_u32 s30, s30, 128
    s_add_u32 s31, s31, s32
    s_add_u32 s36, s36, 24576
    s_add_u32 s58, s58, 1
    s_cmp_eq_u32 s58, 3
    s_cselect_b32 s36, 0, s36
    s_cselect_b32 s58, 0, s58
    s_add_u32 m0, s36, s34
    s_nop 0
    buffer_load_dwordx4 v64, s[8:11], s30 offen offset:0 lds
    buffer_load_dwordx4 v65, s[8:11], s30 offen offset:1024 lds
    s_add_u32 m0, s36, s35
    s_nop 0
    buffer_load_dwordx4 v66, s[12:15], s31 offen lds
    buffer_load_dwordx4 v67, s[12:15], s31 offen offset:1024 lds
    s_add_u32 m0, m0, 0x2000
    s_nop 0
    buffer_load_dwordx4 v66, s[16:19], s31 offen lds
    buffer_load_dwordx4 v67, s[16:19], s31 offen offset:1024 lds
    s_add_u32 s30, s30, 128
    s_add_u32 s31, s31, s32
    s_add_u32 s36, s36, 24576
    s_add_u32 s58, s58, 1
    s_cmp_eq_u32 s58, 3
    s_cselect_b32 s36, 0, s36
    s_cselect_b32 s58, 0, s58
    s_mov_b32 s59, 0
    s_mov_b32 s60, 0xffff4000
    s_mov_b32 s61, 24576
    s_mov_b32 s49, 0
    s_waitcnt vmcnt(12)
    s_mov_b32 s51, 0xffff0000
    s_mov_b32 s52, 0x3acccccd
    s_mov_b32 s53, 0x3727c5ac
    v_pk_add_f32 v[8:9], v[8:9], v[10:11]
    v_pk_add_f32 v[8:9], v[8:9], v[12:13]
    v_pk_add_f32 v[8:9], v[8:9], v[14:15]
    v_pk_add_f32 v[8:9], v[8:9], v[16:17]
    v_pk_add_f32 v[8:9], v[8:9], v[18:19]
    v_pk_add_f32 v[8:9], v[8:9], v[20:21]
    v_pk_add_f32 v[8:9], v[8:9], v[22:23]
    v_pk_add_f32 v[8:9], v[8:9], v[24:25]
    v_pk_add_f32 v[8:9], v[8:9], v[26:27]
    v_pk_add_f32 v[8:9], v[8:9], v[28:29]
    v_pk_add_f32 v[8:9], v[8:9], v[30:31]
    v_pk_add_f32 v[8:9], v[8:9], v[32:33]
    v_pk_add_f32 v[8:9], v[8:9], v[34:35]
    v_pk_add_f32 v[8:9], v[8:9], v[36:37]
    v_pk_add_f32 v[8:9], v[8:9], v[38:39]
    v_pk_add_f32 v[8:9], v[8:9], v[40:41]
    v_pk_add_f32 v[8:9], v[8:9], v[42:43]
    v_pk_add_f32 v[8:9], v[8:9], v[44:45]
    v_pk_add_f32 v[8:9], v[8:9], v[46:47]
    v_mul_f32 v8, s52, v8
    v_mul_f32 v9, s52, v9
    v_fma_f32 v9, -v8, v8, v9
    v_max_f32 v9, 0, v9
    v_cvt_pk_bf16_f32 v10, v8, v9
    v_lshlrev_b32 v8, 16, v10
    v_and_b32 v9, s51, v10
    v_add_f32 v9, s53, v9
    v_cvt_pk_bf16_f32 v9, v9, v9
    v_lshlrev_b32 v9, 16, v9
    v_sqrt_f32 v9, v9
    s_nop 0
    v_cvt_pk_bf16_f32 v9, v9, v9
    v_lshlrev_b32 v9, 16, v9
    v_rcp_f32 v10, v9
    s_nop 0
    v_fma_f32 v11, -v9, v10, 2.0
    v_mul_f32 v10, v10, v11
    v_sub_f32 v74, 0, v8
    v_sub_f32 v75, 0, v8
    v_mov_b32 v76, v10
    v_mov_b32 v77, v10
    v_mov_b32 v8, 0
    v_mov_b32 v9, 0
    v_mov_b32 v10, 0
    v_mov_b32 v11, 0
    v_mov_b32 v12, 0
    v_mov_b32 v13, 0
    v_mov_b32 v14, 0
    v_mov_b32 v15, 0
    v_mov_b32 v16, 0
    v_mov_b32 v17, 0
    v_mov_b32 v18, 0
    v_mov_b32 v19, 0
    v_mov_b32 v20, 0
    v_mov_b32 v21, 0
    v_mov_b32 v22, 0
    v_mov_b32 v23, 0
    v_mov_b32 v24, 0
    v_mov_b32 v25, 0
    v_mov_b32 v26, 0
    v_mov_b32 v27, 0
    v_mov_b32 v28, 0
    v_mov_b32 v29, 0
    v_mov_b32 v30, 0
    v_mov_b32 v31, 0
    v_mov_b32 v32, 0
    v_mov_b32 v33, 0
    v_mov_b32 v34, 0
    v_mov_b32 v35, 0
    v_mov_b32 v36, 0
    v_mov_b32 v37, 0
    v_mov_b32 v38, 0
    v_mov_b32 v39, 0
L_qkv2_kernel_loop:
    s_waitcnt vmcnt(6)
    s_barrier
    s_add_u32 m0, s36, s34
    s_nop 0
    buffer_load_dwordx4 v64, s[8:11], s30 offen offset:0 lds
    buffer_load_dwordx4 v65, s[8:11], s30 offen offset:1024 lds
    s_add_u32 m0, s36, s35
    s_nop 0
    buffer_load_dwordx4 v66, s[12:15], s31 offen lds
    buffer_load_dwordx4 v67, s[12:15], s31 offen offset:1024 lds
    s_add_u32 m0, m0, 0x2000
    s_nop 0
    buffer_load_dwordx4 v66, s[16:19], s31 offen lds
    buffer_load_dwordx4 v67, s[16:19], s31 offen offset:1024 lds
    s_add_u32 s30, s30, 128
    s_add_u32 s31, s31, s32
    s_add_u32 s36, s36, 24576
    s_add_u32 s58, s58, 1
    s_cmp_eq_u32 s58, 3
    s_cselect_b32 s36, 0, s36
    s_cselect_b32 s58, 0, s58
    ds_read_b128 v[48:51], v68 offset:0
    ds_read_b64_tr_b16 v[40:41], v72 offset:0
    ds_read_b64_tr_b16 v[42:43], v72 offset:512
    ds_read_b64_tr_b16 v[44:45], v72 offset:8192
    ds_read_b64_tr_b16 v[46:47], v72 offset:8704
    ds_read_b128 v[60:63], v69 offset:0
    ds_read_b64_tr_b16 v[52:53], v72 offset:2048
    ds_read_b64_tr_b16 v[54:55], v72 offset:2560
    ds_read_b64_tr_b16 v[56:57], v72 offset:10240
    ds_read_b64_tr_b16 v[58:59], v72 offset:10752
    s_waitcnt lgkmcnt(5)
    v_mfma_f32_32x32x16_bf16 v[8:23], v[40:43], v[48:51], v[8:23]
    v_mfma_f32_32x32x16_bf16 v[24:39], v[44:47], v[48:51], v[24:39]
    ds_read_b128 v[48:51], v70 offset:0
    ds_read_b64_tr_b16 v[40:41], v72 offset:4096
    ds_read_b64_tr_b16 v[42:43], v72 offset:4608
    ds_read_b64_tr_b16 v[44:45], v72 offset:12288
    ds_read_b64_tr_b16 v[46:47], v72 offset:12800
    s_waitcnt lgkmcnt(5)
    v_mfma_f32_32x32x16_bf16 v[8:23], v[52:55], v[60:63], v[8:23]
    v_mfma_f32_32x32x16_bf16 v[24:39], v[56:59], v[60:63], v[24:39]
    ds_read_b128 v[60:63], v71 offset:0
    ds_read_b64_tr_b16 v[52:53], v72 offset:6144
    ds_read_b64_tr_b16 v[54:55], v72 offset:6656
    ds_read_b64_tr_b16 v[56:57], v72 offset:14336
    ds_read_b64_tr_b16 v[58:59], v72 offset:14848
    s_waitcnt lgkmcnt(5)
    v_mfma_f32_32x32x16_bf16 v[8:23], v[40:43], v[48:51], v[8:23]
    v_mfma_f32_32x32x16_bf16 v[24:39], v[44:47], v[48:51], v[24:39]
    s_waitcnt lgkmcnt(0)
    v_mfma_f32_32x32x16_bf16 v[8:23], v[52:55], v[60:63], v[8:23]
    v_mfma_f32_32x32x16_bf16 v[24:39], v[56:59], v[60:63], v[24:39]
    s_add_u32 s59, s59, 1
    s_cmp_eq_u32 s59, 3
    s_cselect_b32 s48, s60, s61
    s_cselect_b32 s59, 0, s59
    v_add_u32 v68, s48, v68
    v_add_u32 v69, s48, v69
    v_add_u32 v70, s48, v70
    v_add_u32 v71, s48, v71
    v_add_u32 v72, s48, v72
    s_add_u32 s49, s49, 1
    s_cmp_lt_u32 s49, 10
    s_cbranch_scc1 L_qkv2_kernel_loop
    s_waitcnt vmcnt(0)
    s_mul_i32 s3, s28, 64
    s_mul_i32 s50, s38, 32
    s_add_u32 s3, s3, s50
    v_add_u32 v1, s3, v6
    s_mov_b32 s51, 0xffff0000
    s_add_u32 s24, s6, 0x1678000
    s_addc_u32 s25, s7, 0
    s_mov_b32 s26, 0xc00
    s_mov_b32 s27, 0x20000
    s_lshl_b32 s3, s29, 9
    s_lshl_b32 s50, s37, 7
    s_add_u32 s3, s3, s50
    v_lshlrev_b32 v3, 4, v7
    v_add_u32 v3, s3, v3
    buffer_load_dwordx4 v[80:83], v3, s[24:27], 0 offen offset:0
    buffer_load_dwordx4 v[84:87], v3, s[24:27], 0 offen offset:32
    buffer_load_dwordx4 v[88:91], v3, s[24:27], 0 offen offset:64
    buffer_load_dwordx4 v[92:95], v3, s[24:27], 0 offen offset:96
    s_add_u32 s24, s6, 0x1678000
    s_addc_u32 s25, s7, 0
    s_mov_b32 s26, 0xc00
    s_mov_b32 s27, 0x20000
    s_lshl_b32 s3, s29, 9
    s_lshl_b32 s50, s37, 7
    s_add_u32 s3, s3, s50
    s_add_u32 s3, s3, 256
    v_lshlrev_b32 v3, 4, v7
    v_add_u32 v3, s3, v3
    buffer_load_dwordx4 v[96:99], v3, s[24:27], 0 offen offset:0
    buffer_load_dwordx4 v[100:103], v3, s[24:27], 0 offen offset:32
    buffer_load_dwordx4 v[104:107], v3, s[24:27], 0 offen offset:64
    buffer_load_dwordx4 v[108:111], v3, s[24:27], 0 offen offset:96
    s_waitcnt vmcnt(0)
    v_pk_fma_f32 v[8:9], v[80:81], v[74:75], v[8:9]
    v_pk_fma_f32 v[10:11], v[82:83], v[74:75], v[10:11]
    v_pk_mul_f32 v[8:9], v[8:9], v[76:77]
    v_pk_mul_f32 v[10:11], v[10:11], v[76:77]
    v_pk_fma_f32 v[12:13], v[84:85], v[74:75], v[12:13]
    v_pk_fma_f32 v[14:15], v[86:87], v[74:75], v[14:15]
    v_pk_mul_f32 v[12:13], v[12:13], v[76:77]
    v_pk_mul_f32 v[14:15], v[14:15], v[76:77]
    v_pk_fma_f32 v[16:17], v[88:89], v[74:75], v[16:17]
    v_pk_fma_f32 v[18:19], v[90:91], v[74:75], v[18:19]
    v_pk_mul_f32 v[16:17], v[16:17], v[76:77]
    v_pk_mul_f32 v[18:19], v[18:19], v[76:77]
    v_pk_fma_f32 v[20:21], v[92:93], v[74:75], v[20:21]
    v_pk_fma_f32 v[22:23], v[94:95], v[74:75], v[22:23]
    v_pk_mul_f32 v[20:21], v[20:21], v[76:77]
    v_pk_mul_f32 v[22:23], v[22:23], v[76:77]
    v_pk_fma_f32 v[24:25], v[96:97], v[74:75], v[24:25]
    v_pk_fma_f32 v[26:27], v[98:99], v[74:75], v[26:27]
    v_pk_mul_f32 v[24:25], v[24:25], v[76:77]
    v_pk_mul_f32 v[26:27], v[26:27], v[76:77]
    v_pk_fma_f32 v[28:29], v[100:101], v[74:75], v[28:29]
    v_pk_fma_f32 v[30:31], v[102:103], v[74:75], v[30:31]
    v_pk_mul_f32 v[28:29], v[28:29], v[76:77]
    v_pk_mul_f32 v[30:31], v[30:31], v[76:77]
    v_pk_fma_f32 v[32:33], v[104:105], v[74:75], v[32:33]
    v_pk_fma_f32 v[34:35], v[106:107], v[74:75], v[34:35]
    v_pk_mul_f32 v[32:33], v[32:33], v[76:77]
    v_pk_mul_f32 v[34:35], v[34:35], v[76:77]
    v_pk_fma_f32 v[36:37], v[108:109], v[74:75], v[36:37]
    v_pk_fma_f32 v[38:39], v[110:111], v[74:75], v[38:39]
    v_pk_mul_f32 v[36:37], v[36:37], v[76:77]
    v_pk_mul_f32 v[38:39], v[38:39], v[76:77]
    s_cmp_ge_u32 s29, 5
    s_cbranch_scc1 L_qkv2_kernel_kv
    s_add_u32 s20, s6, 0x280000
    s_addc_u32 s21, s7, 0
    s_mov_b32 s22, 0x280000
    s_mov_b32 s23, 0x20000
    v_mul_u32_u24 v2, 0x500, v1
    s_lshl_b32 s3, s29, 8
    s_lshl_b32 s50, s37, 6
    s_add_u32 s3, s3, s50
    v_add_u32 v2, s3, v2
    v_lshl_add_u32 v2, v7, 3, v2
    s_mov_b32 s52, 0xa000
    s_mov_b32 s54, 0x3ea52b5c
    s_mov_b32 s55, 0x3ea52b5c
    v_pk_mul_f32 v[8:9], v[8:9], s[54:55]
    v_pk_mul_f32 v[10:11], v[10:11], s[54:55]
    v_cvt_pk_bf16_f32 v8, v8, v9
    v_cvt_pk_bf16_f32 v9, v10, v11
    buffer_store_dwordx2 v[8:9], v2, s[20:23], 0 offen offset:0
    v_pk_mul_f32 v[12:13], v[12:13], s[54:55]
    v_pk_mul_f32 v[14:15], v[14:15], s[54:55]
    v_cvt_pk_bf16_f32 v12, v12, v13
    v_cvt_pk_bf16_f32 v13, v14, v15
    buffer_store_dwordx2 v[12:13], v2, s[20:23], 0 offen offset:16
    v_pk_mul_f32 v[16:17], v[16:17], s[54:55]
    v_pk_mul_f32 v[18:19], v[18:19], s[54:55]
    v_cvt_pk_bf16_f32 v16, v16, v17
    v_cvt_pk_bf16_f32 v17, v18, v19
    buffer_store_dwordx2 v[16:17], v2, s[20:23], 0 offen offset:32
    v_pk_mul_f32 v[20:21], v[20:21], s[54:55]
    v_pk_mul_f32 v[22:23], v[22:23], s[54:55]
    v_cvt_pk_bf16_f32 v20, v20, v21
    v_cvt_pk_bf16_f32 v21, v22, v23
    buffer_store_dwordx2 v[20:21], v2, s[20:23], 0 offen offset:48
    v_pk_mul_f32 v[24:25], v[24:25], s[54:55]
    v_pk_mul_f32 v[26:27], v[26:27], s[54:55]
    v_cvt_pk_bf16_f32 v24, v24, v25
    v_cvt_pk_bf16_f32 v25, v26, v27
    buffer_store_dwordx2 v[24:25], v2, s[20:23], 0 offen offset:128
    v_pk_mul_f32 v[28:29], v[28:29], s[54:55]
    v_pk_mul_f32 v[30:31], v[30:31], s[54:55]
    v_cvt_pk_bf16_f32 v28, v28, v29
    v_cvt_pk_bf16_f32 v29, v30, v31
    buffer_store_dwordx2 v[28:29], v2, s[20:23], 0 offen offset:144
    v_pk_mul_f32 v[32:33], v[32:33], s[54:55]
    v_pk_mul_f32 v[34:35], v[34:35], s[54:55]
    v_cvt_pk_bf16_f32 v32, v32, v33
    v_cvt_pk_bf16_f32 v33, v34, v35
    buffer_store_dwordx2 v[32:33], v2, s[20:23], 0 offen offset:160
    v_pk_mul_f32 v[36:37], v[36:37], s[54:55]
    v_pk_mul_f32 v[38:39], v[38:39], s[54:55]
    v_cvt_pk_bf16_f32 v36, v36, v37
    v_cvt_pk_bf16_f32 v37, v38, v39
    buffer_store_dwordx2 v[36:37], v2, s[20:23], 0 offen offset:176
    s_endpgm
L_qkv2_kernel_kv:
    s_cmp_lg_u32 s37, 0
    s_cbranch_scc1 L_qkv2_kernel_end
    s_add_u32 s20, s6, 0x500000
    s_addc_u32 s21, s7, 0
    s_mov_b32 s22, 0x20000
    s_mov_b32 s23, 0x20000
    s_add_u32 s24, s6, 0x520000
    s_addc_u32 s25, s7, 0
    s_mov_b32 s26, 0x20000
    s_mov_b32 s27, 0x20000
    s_mov_b32 s56, 0
    s_mov_b32 s57, -1
    v_mov_b32 v4, 0
    v_mov_b32 v112, 0x3f80
    v_add_u32 v2, 0, v1
    v_lshlrev_b32 v2, 6, v2
    v_lshl_add_u32 v2, v7, 3, v2
    v_cvt_pk_bf16_f32 v8, v8, v9
    v_cvt_pk_bf16_f32 v9, v10, v11
    v_cvt_pk_bf16_f32 v12, v12, v13
    v_cvt_pk_bf16_f32 v13, v14, v15
    v_cvt_pk_bf16_f32 v16, v16, v17
    v_cvt_pk_bf16_f32 v17, v18, v19
    v_cndmask_b32 v16, v16, v112, s[56:57]
    v_cndmask_b32 v17, v17, v4, s[56:57]
    v_mov_b32 v20, 0
    v_mov_b32 v21, 0
    buffer_store_dwordx2 v[8:9], v2, s[20:23], 0 offen offset:0
    buffer_store_dwordx2 v[12:13], v2, s[20:23], 0 offen offset:16
    buffer_store_dwordx2 v[16:17], v2, s[20:23], 0 offen offset:32
    buffer_store_dwordx2 v[20:21], v2, s[20:23], 0 offen offset:48
    v_add_u32 v2, 0, v1
    v_lshrrev_b32 v3, 5, v2
    v_lshlrev_b32 v3, 11, v3
    v_and_b32 v114, 0x13, v2
    v_bfe_u32 v115, v2, 2, 1
    v_lshl_add_u32 v114, v115, 3, v114
    v_bfe_u32 v115, v2, 3, 1
    v_lshl_add_u32 v114, v115, 2, v114
    v_lshl_add_u32 v3, v114, 1, v3
    v_lshl_add_u32 v3, v7, 8, v3
    v_cvt_pk_bf16_f32 v24, v24, v25
    v_cvt_pk_bf16_f32 v25, v26, v27
    v_cvt_pk_bf16_f32 v28, v28, v29
    v_cvt_pk_bf16_f32 v29, v30, v31
    v_cvt_pk_bf16_f32 v32, v32, v33
    v_cvt_pk_bf16_f32 v33, v34, v35
    v_cndmask_b32 v32, v32, v112, s[56:57]
    v_cndmask_b32 v33, v33, v4, s[56:57]
    v_mov_b32 v36, 0
    v_mov_b32 v37, 0
    buffer_store_short v24, v3, s[24:27], 0 offen offset:0
    buffer_store_short_d16_hi v24, v3, s[24:27], 0 offen offset:64
    buffer_store_short v25, v3, s[24:27], 0 offen offset:128
    buffer_store_short_d16_hi v25, v3, s[24:27], 0 offen offset:192
    buffer_store_short v28, v3, s[24:27], 0 offen offset:512
    buffer_store_short_d16_hi v28, v3, s[24:27], 0 offen offset:576
    buffer_store_short v29, v3, s[24:27], 0 offen offset:640
    buffer_store_short_d16_hi v29, v3, s[24:27], 0 offen offset:704
    buffer_store_short v32, v3, s[24:27], 0 offen offset:1024
    buffer_store_short_d16_hi v32, v3, s[24:27], 0 offen offset:1088
    buffer_store_short v33, v3, s[24:27], 0 offen offset:1152
    buffer_store_short_d16_hi v33, v3, s[24:27], 0 offen offset:1216
    buffer_store_short v36, v3, s[24:27], 0 offen offset:1536
    buffer_store_short_d16_hi v36, v3, s[24:27], 0 offen offset:1600
    buffer_store_short v37, v3, s[24:27], 0 offen offset:1664
    buffer_store_short_d16_hi v37, v3, s[24:27], 0 offen offset:1728
L_qkv2_kernel_end:
    s_endpgm
.globl attn2_kernel
.p2align 8
.type attn2_kernel,@function
attn2_kernel:
    s_cmp_ge_u32 s2, 1024
    s_cbranch_scc1 L_attn2_kernel_end
    s_load_dwordx2 s[6:7], s[0:1], 88
    v_and_b32 v1, 63, v0
    v_lshrrev_b32 v4, 6, v0
    v_and_b32 v2, 31, v0
    v_readfirstlane_b32 s39, v4
    v_lshrrev_b32 v3, 5, v1
    s_waitcnt lgkmcnt(0)
    s_add_u32 s8, s6, 0x280000
    s_addc_u32 s9, s7, 0
    s_mov_b32 s10, 0x280000
    s_mov_b32 s11, 0x20000
    s_add_u32 s12, s6, 0x500000
    s_addc_u32 s13, s7, 0
    s_mov_b32 s14, 0x20000
    s_mov_b32 s15, 0x20000
    s_add_u32 s16, s6, 0x520000
    s_addc_u32 s17, s7, 0
    s_mov_b32 s18, 0x20000
    s_mov_b32 s19, 0x20000
    s_add_u32 s20, s6, 0x568000
    s_addc_u32 s21, s7, 0
    s_mov_b32 s22, 0x280000
    s_mov_b32 s23, 0x20000
    s_lshl_b32 s3, s2, 6
    v_add_u32 v4, s3, v2
    v_add_u32 v5, 0, v4
    v_mul_u32_u24 v5, 40, v5
    v_lshl_add_u32 v6, v3, 4, v5
    buffer_load_dwordx4 v[8:11], v6, s[8:11], 0 offen
    v_lshl_add_u32 v6, v3, 28, v5
    buffer_load_dwordx2 v[16:17], v6, s[8:11], 0 offen offset:32
    v_mov_b32 v18, 0
    v_mov_b32 v19, 0
    v_add_u32 v5, 32, v4
    v_mul_u32_u24 v5, 40, v5
    v_lshl_add_u32 v6, v3, 4, v5
    buffer_load_dwordx4 v[12:15], v6, s[8:11], 0 offen
    v_lshl_add_u32 v6, v3, 28, v5
    buffer_load_dwordx2 v[20:21], v6, s[8:11], 0 offen offset:32
    v_mov_b32 v22, 0
    v_mov_b32 v23, 0
    v_lshlrev_b32 v104, 6, v2
    v_lshl_add_u32 v104, v3, 4, v104
    v_mov_b32 v105, v104
    s_lshl_b32 s30, s39, 15
    s_mov_b32 s31, s30
    buffer_load_dwordx4 v[88:91], v104, s[12:15], s30 offen
    buffer_load_dwordx4 v[92:95], v104, s[12:15], s30 offen offset:32
    buffer_load_dwordx4 v[96:99], v105, s[16:19], s31 offen
    buffer_load_dwordx4 v[100:103], v105, s[16:19], s31 offen offset:32
    v_mov_b32 v56, 0
    v_mov_b32 v57, 0
    v_mov_b32 v58, 0
    v_mov_b32 v59, 0
    v_mov_b32 v60, 0
    v_mov_b32 v61, 0
    v_mov_b32 v62, 0
    v_mov_b32 v63, 0
    v_mov_b32 v64, 0
    v_mov_b32 v65, 0
    v_mov_b32 v66, 0
    v_mov_b32 v67, 0
    v_mov_b32 v68, 0
    v_mov_b32 v69, 0
    v_mov_b32 v70, 0
    v_mov_b32 v71, 0
    v_mov_b32 v106, 0
    v_mov_b32 v108, 0xff7fffff
    v_mov_b32 v72, 0
    v_mov_b32 v73, 0
    v_mov_b32 v74, 0
    v_mov_b32 v75, 0
    v_mov_b32 v76, 0
    v_mov_b32 v77, 0
    v_mov_b32 v78, 0
    v_mov_b32 v79, 0
    v_mov_b32 v80, 0
    v_mov_b32 v81, 0
    v_mov_b32 v82, 0
    v_mov_b32 v83, 0
    v_mov_b32 v84, 0
    v_mov_b32 v85, 0
    v_mov_b32 v86, 0
    v_mov_b32 v87, 0
    v_mov_b32 v107, 0
    v_mov_b32 v109, 0xff7fffff
    v_subrev_u32 v110, 1, v3
    v_and_b32 v110, 0xffff, v110
    s_mov_b32 s32, 0
    s_waitcnt vmcnt(4)
L_attn2_kernel_loop:
    s_waitcnt vmcnt(2)
    v_mfma_f32_32x32x16_bf16 v[24:39], v[88:91], v[8:11], 0
    v_mfma_f32_32x32x16_bf16 v[24:39], v[92:95], v[16:19], v[24:39]
    v_mfma_f32_32x32x16_bf16 v[40:55], v[88:91], v[12:15], 0
    v_mfma_f32_32x32x16_bf16 v[40:55], v[92:95], v[20:23], v[40:55]
    s_add_u32 s30, s30, 0x800
    buffer_load_dwordx4 v[88:91], v104, s[12:15], s30 offen
    buffer_load_dwordx4 v[92:95], v104, s[12:15], s30 offen offset:32
    s_nop 6
    v_max3_f32 v111, v24, v25, v26
    v_max3_f32 v111, v111, v27, v28
    v_max3_f32 v111, v111, v29, v30
    v_max3_f32 v111, v111, v31, v32
    v_max3_f32 v111, v111, v33, v34
    v_max3_f32 v111, v111, v35, v36
    v_max3_f32 v111, v111, v37, v38
    v_max_f32 v111, v111, v39
    v_cmp_gt_f32 vcc, v111, v108
    s_cbranch_vccnz L_attn2_kernel_rare0
L_attn2_kernel_back0:
    v_exp_f32 v24, v24
    v_exp_f32 v25, v25
    v_exp_f32 v26, v26
    v_exp_f32 v27, v27
    v_exp_f32 v28, v28
    v_exp_f32 v29, v29
    v_exp_f32 v30, v30
    v_exp_f32 v31, v31
    v_exp_f32 v32, v32
    v_exp_f32 v33, v33
    v_exp_f32 v34, v34
    v_exp_f32 v35, v35
    v_exp_f32 v36, v36
    v_exp_f32 v37, v37
    v_exp_f32 v38, v38
    v_exp_f32 v39, v39
    v_cvt_pk_bf16_f32 v24, v24, v25
    v_cvt_pk_bf16_f32 v25, v26, v27
    v_cvt_pk_bf16_f32 v26, v28, v29
    v_cvt_pk_bf16_f32 v27, v30, v31
    v_cvt_pk_bf16_f32 v28, v32, v33
    v_cvt_pk_bf16_f32 v29, v34, v35
    v_cvt_pk_bf16_f32 v30, v36, v37
    v_cvt_pk_bf16_f32 v31, v38, v39
    s_waitcnt vmcnt(2)
    v_mfma_f32_32x32x16_bf16 v[56:71], v[96:99], v[24:27], v[56:71]
    v_mfma_f32_32x32x16_bf16 v[56:71], v[100:103], v[28:31], v[56:71]
    v_max3_f32 v111, v40, v41, v42
    v_max3_f32 v111, v111, v43, v44
    v_max3_f32 v111, v111, v45, v46
    v_max3_f32 v111, v111, v47, v48
    v_max3_f32 v111, v111, v49, v50
    v_max3_f32 v111, v111, v51, v52
    v_max3_f32 v111, v111, v53, v54
    v_max_f32 v111, v111, v55
    v_cmp_gt_f32 vcc, v111, v109
    s_cbranch_vccnz L_attn2_kernel_rare1
L_attn2_kernel_back1:
    v_exp_f32 v40, v40
    v_exp_f32 v41, v41
    v_exp_f32 v42, v42
    v_exp_f32 v43, v43
    v_exp_f32 v44, v44
    v_exp_f32 v45, v45
    v_exp_f32 v46, v46
    v_exp_f32 v47, v47
    v_exp_f32 v48, v48
    v_exp_f32 v49, v49
    v_exp_f32 v50, v50
    v_exp_f32 v51, v51
    v_exp_f32 v52, v52
    v_exp_f32 v53, v53
    v_exp_f32 v54, v54
    v_exp_f32 v55, v55
    v_cvt_pk_bf16_f32 v40, v40, v41
    v_cvt_pk_bf16_f32 v41, v42, v43
    v_cvt_pk_bf16_f32 v42, v44, v45
    v_cvt_pk_bf16_f32 v43, v46, v47
    v_cvt_pk_bf16_f32 v44, v48, v49
    v_cvt_pk_bf16_f32 v45, v50, v51
    v_cvt_pk_bf16_f32 v46, v52, v53
    v_cvt_pk_bf16_f32 v47, v54, v55
    v_mfma_f32_32x32x16_bf16 v[72:87], v[96:99], v[40:43], v[72:87]
    s_nop 0
    v_mfma_f32_32x32x16_bf16 v[72:87], v[100:103], v[44:47], v[72:87]
    s_add_u32 s31, s31, 0x800
    buffer_load_dwordx4 v[96:99], v105, s[16:19], s31 offen
    buffer_load_dwordx4 v[100:103], v105, s[16:19], s31 offen offset:32
    s_add_u32 s32, s32, 1
    s_cmp_lt_u32 s32, 16
    s_cbranch_scc1 L_attn2_kernel_loop
    s_waitcnt vmcnt(0)
    v_lshlrev_b32 v104, 2, v1
    s_mul_i32 s3, s39, 6656
    v_add_u32 v105, s3, v104
    ds_write_b32 v105, v56 offset:0
    ds_write_b32 v105, v57 offset:256
    ds_write_b32 v105, v58 offset:512
    ds_write_b32 v105, v59 offset:768
    ds_write_b32 v105, v60 offset:1024
    ds_write_b32 v105, v61 offset:1280
    ds_write_b32 v105, v62 offset:1536
    ds_write_b32 v105, v63 offset:1792
    ds_write_b32 v105, v64 offset:2048
    ds_write_b32 v105, v65 offset:2304
    ds_write_b32 v105, v66 offset:2560
    ds_write_b32 v105, v67 offset:2816
    ds_write_b32 v105, v106 offset:3072
    ds_write_b32 v105, v72 offset:3328
    ds_write_b32 v105, v73 offset:3584
    ds_write_b32 v105, v74 offset:3840
    ds_write_b32 v105, v75 offset:4096
    ds_write_b32 v105, v76 offset:4352
    ds_write_b32 v105, v77 offset:4608
    ds_write_b32 v105, v78 offset:4864
    ds_write_b32 v105, v79 offset:5120
    ds_write_b32 v105, v80 offset:5376
    ds_write_b32 v105, v81 offset:5632
    ds_write_b32 v105, v82 offset:5888
    ds_write_b32 v105, v83 offset:6144
    ds_write_b32 v105, v107 offset:6400
    s_waitcnt lgkmcnt(0)
    s_barrier
    s_cmp_ge_u32 s39, 2
    s_cbranch_scc1 L_attn2_kernel_end
    s_mul_i32 s3, s39, 3328
    v_add_u32 v104, s3, v104
    ds_read_b32 v40, v104 offset:3072
    ds_read_b32 v41, v104 offset:9728
    ds_read_b32 v42, v104 offset:16384
    ds_read_b32 v43, v104 offset:23040
    s_waitcnt lgkmcnt(0)
    v_max3_f32 v111, v40, v41, v42
    v_max_f32 v111, v111, v43
    v_sub_f32 v44, v40, v111
    v_exp_f32 v44, v44
    v_sub_f32 v45, v41, v111
    v_exp_f32 v45, v45
    v_sub_f32 v46, v42, v111
    v_exp_f32 v46, v46
    v_sub_f32 v47, v43, v111
    v_exp_f32 v47, v47
    ds_read_b32 v24, v104 offset:0
    ds_read_b32 v25, v104 offset:256
    ds_read_b32 v26, v104 offset:512
    ds_read_b32 v27, v104 offset:768
    ds_read_b32 v28, v104 offset:1024
    ds_read_b32 v29, v104 offset:1280
    ds_read_b32 v30, v104 offset:1536
    ds_read_b32 v31, v104 offset:1792
    ds_read_b32 v32, v104 offset:2048
    ds_read_b32 v33, v104 offset:2304
    ds_read_b32 v34, v104 offset:2560
    ds_read_b32 v35, v104 offset:2816
    s_waitcnt lgkmcnt(0)
    v_mul_f32 v56, v24, v44
    v_mul_f32 v57, v25, v44
    v_mul_f32 v58, v26, v44
    v_mul_f32 v59, v27, v44
    v_mul_f32 v60, v28, v44
    v_mul_f32 v61, v29, v44
    v_mul_f32 v62, v30, v44
    v_mul_f32 v63, v31, v44
    v_mul_f32 v64, v32, v44
    v_mul_f32 v65, v33, v44
    v_mul_f32 v66, v34, v44
    v_mul_f32 v67, v35, v44
    ds_read_b32 v24, v104 offset:6656
    ds_read_b32 v25, v104 offset:6912
    ds_read_b32 v26, v104 offset:7168
    ds_read_b32 v27, v104 offset:7424
    ds_read_b32 v28, v104 offset:7680
    ds_read_b32 v29, v104 offset:7936
    ds_read_b32 v30, v104 offset:8192
    ds_read_b32 v31, v104 offset:8448
    ds_read_b32 v32, v104 offset:8704
    ds_read_b32 v33, v104 offset:8960
    ds_read_b32 v34, v104 offset:9216
    ds_read_b32 v35, v104 offset:9472
    s_waitcnt lgkmcnt(0)
    v_fmac_f32 v56, v24, v45
    v_fmac_f32 v57, v25, v45
    v_fmac_f32 v58, v26, v45
    v_fmac_f32 v59, v27, v45
    v_fmac_f32 v60, v28, v45
    v_fmac_f32 v61, v29, v45
    v_fmac_f32 v62, v30, v45
    v_fmac_f32 v63, v31, v45
    v_fmac_f32 v64, v32, v45
    v_fmac_f32 v65, v33, v45
    v_fmac_f32 v66, v34, v45
    v_fmac_f32 v67, v35, v45
    ds_read_b32 v24, v104 offset:13312
    ds_read_b32 v25, v104 offset:13568
    ds_read_b32 v26, v104 offset:13824
    ds_read_b32 v27, v104 offset:14080
    ds_read_b32 v28, v104 offset:14336
    ds_read_b32 v29, v104 offset:14592
    ds_read_b32 v30, v104 offset:14848
    ds_read_b32 v31, v104 offset:15104
    ds_read_b32 v32, v104 offset:15360
    ds_read_b32 v33, v104 offset:15616
    ds_read_b32 v34, v104 offset:15872
    ds_read_b32 v35, v104 offset:16128
    s_waitcnt lgkmcnt(0)
    v_fmac_f32 v56, v24, v46
    v_fmac_f32 v57, v25, v46
    v_fmac_f32 v58, v26, v46
    v_fmac_f32 v59, v27, v46
    v_fmac_f32 v60, v28, v46
    v_fmac_f32 v61, v29, v46
    v_fmac_f32 v62, v30, v46
    v_fmac_f32 v63, v31, v46
    v_fmac_f32 v64, v32, v46
    v_fmac_f32 v65, v33, v46
    v_fmac_f32 v66, v34, v46
    v_fmac_f32 v67, v35, v46
    ds_read_b32 v24, v104 offset:19968
    ds_read_b32 v25, v104 offset:20224
    ds_read_b32 v26, v104 offset:20480
    ds_read_b32 v27, v104 offset:20736
    ds_read_b32 v28, v104 offset:20992
    ds_read_b32 v29, v104 offset:21248
    ds_read_b32 v30, v104 offset:21504
    ds_read_b32 v31, v104 offset:21760
    ds_read_b32 v32, v104 offset:22016
    ds_read_b32 v33, v104 offset:22272
    ds_read_b32 v34, v104 offset:22528
    ds_read_b32 v35, v104 offset:22784
    s_waitcnt lgkmcnt(0)
    v_fmac_f32 v56, v24, v47
    v_fmac_f32 v57, v25, v47
    v_fmac_f32 v58, v26, v47
    v_fmac_f32 v59, v27, v47
    v_fmac_f32 v60, v28, v47
    v_fmac_f32 v61, v29, v47
    v_fmac_f32 v62, v30, v47
    v_fmac_f32 v63, v31, v47
    v_fmac_f32 v64, v32, v47
    v_fmac_f32 v65, v33, v47
    v_fmac_f32 v66, v34, v47
    v_fmac_f32 v67, v35, v47
    v_mov_b32 v112, v64
    v_mov_b32 v113, v64
    s_nop 1
    v_permlane32_swap_b32 v112, v113
    v_rcp_f32 v113, v113
    s_nop 0
    v_mul_f32 v56, v56, v113
    v_mul_f32 v57, v57, v113
    v_mul_f32 v58, v58, v113
    v_mul_f32 v59, v59, v113
    v_mul_f32 v60, v60, v113
    v_mul_f32 v61, v61, v113
    v_mul_f32 v62, v62, v113
    v_mul_f32 v63, v63, v113
    v_mul_f32 v64, v64, v113
    v_mul_f32 v65, v65, v113
    v_mul_f32 v66, v66, v113
    v_mul_f32 v67, v67, v113
    v_cvt_pk_bf16_f32 v56, v56, v57
    v_cvt_pk_bf16_f32 v57, v58, v59
    v_cvt_pk_bf16_f32 v60, v60, v61
    v_cvt_pk_bf16_f32 v61, v62, v63
    v_cvt_pk_bf16_f32 v64, v64, v65
    v_cvt_pk_bf16_f32 v65, v66, v67
    s_lshl_b32 s3, s2, 6
    s_lshl_b32 s33, s39, 5
    s_add_u32 s3, s3, s33
    v_add_u32 v4, s3, v2
    v_mul_u32_u24 v4, 40, v4
    v_lshl_add_u32 v5, v3, 3, v4
    v_lshl_add_u32 v6, v3, 28, v4
    buffer_store_dwordx2 v[56:57], v5, s[20:23], 0 offen
    buffer_store_dwordx2 v[60:61], v5, s[20:23], 0 offen offset:16
    buffer_store_dwordx2 v[64:65], v6, s[20:23], 0 offen offset:32
L_attn2_kernel_end:
    s_endpgm
L_attn2_kernel_rare0:
    v_mov_b32 v112, v111
    v_mov_b32 v113, v111
    s_nop 1
    v_permlane32_swap_b32 v112, v113
    v_max_f32 v111, v112, v113
    v_cmp_gt_f32 vcc, v111, v108
    s_nop 1
    v_cndmask_b32 v111, 0, v111, vcc
    v_add_f32 v112, v106, v111
    v_and_b32 v112, 0xffff0000, v112
    v_sub_f32 v113, v112, v106
    v_sub_f32 v24, v24, v113
    v_sub_f32 v25, v25, v113
    v_sub_f32 v26, v26, v113
    v_sub_f32 v27, v27, v113
    v_sub_f32 v28, v28, v113
    v_sub_f32 v29, v29, v113
    v_sub_f32 v30, v30, v113
    v_sub_f32 v31, v31, v113
    v_sub_f32 v32, v32, v113
    v_sub_f32 v33, v33, v113
    v_sub_f32 v34, v34, v113
    v_sub_f32 v35, v35, v113
    v_sub_f32 v36, v36, v113
    v_sub_f32 v37, v37, v113
    v_sub_f32 v38, v38, v113
    v_sub_f32 v39, v39, v113
    v_max_f32 v113, 0, v113
    v_sub_f32 v113, 0, v113
    v_exp_f32 v113, v113
    v_mov_b32 v106, v112
    v_xor_b32 v112, 0x80000000, v112
    v_lshrrev_b32 v112, 16, v112
    v_and_b32 v18, v112, v110
    v_mov_b32 v108, 0x41000000
    v_mul_f32 v56, v56, v113
    v_mul_f32 v57, v57, v113
    v_mul_f32 v58, v58, v113
    v_mul_f32 v59, v59, v113
    v_mul_f32 v60, v60, v113
    v_mul_f32 v61, v61, v113
    v_mul_f32 v62, v62, v113
    v_mul_f32 v63, v63, v113
    v_mul_f32 v64, v64, v113
    v_mul_f32 v65, v65, v113
    v_mul_f32 v66, v66, v113
    v_mul_f32 v67, v67, v113
    s_branch L_attn2_kernel_back0
L_attn2_kernel_rare1:
    v_mov_b32 v112, v111
    v_mov_b32 v113, v111
    s_nop 1
    v_permlane32_swap_b32 v112, v113
    v_max_f32 v111, v112, v113
    v_cmp_gt_f32 vcc, v111, v109
    s_nop 1
    v_cndmask_b32 v111, 0, v111, vcc
    v_add_f32 v112, v107, v111
    v_and_b32 v112, 0xffff0000, v112
    v_sub_f32 v113, v112, v107
    v_sub_f32 v40, v40, v113
    v_sub_f32 v41, v41, v113
    v_sub_f32 v42, v42, v113
    v_sub_f32 v43, v43, v113
    v_sub_f32 v44, v44, v113
    v_sub_f32 v45, v45, v113
    v_sub_f32 v46, v46, v113
    v_sub_f32 v47, v47, v113
    v_sub_f32 v48, v48, v113
    v_sub_f32 v49, v49, v113
    v_sub_f32 v50, v50, v113
    v_sub_f32 v51, v51, v113
    v_sub_f32 v52, v52, v113
    v_sub_f32 v53, v53, v113
    v_sub_f32 v54, v54, v113
    v_sub_f32 v55, v55, v113
    v_max_f32 v113, 0, v113
    v_sub_f32 v113, 0, v113
    v_exp_f32 v113, v113
    v_mov_b32 v107, v112
    v_xor_b32 v112, 0x80000000, v112
    v_lshrrev_b32 v112, 16, v112
    v_and_b32 v22, v112, v110
    v_mov_b32 v109, 0x41000000
    v_mul_f32 v72, v72, v113
    v_mul_f32 v73, v73, v113
    v_mul_f32 v74, v74, v113
    v_mul_f32 v75, v75, v113
    v_mul_f32 v76, v76, v113
    v_mul_f32 v77, v77, v113
    v_mul_f32 v78, v78, v113
    v_mul_f32 v79, v79, v113
    v_mul_f32 v80, v80, v113
    v_mul_f32 v81, v81, v113
    v_mul_f32 v82, v82, v113
    v_mul_f32 v83, v83, v113
    s_branch L_attn2_kernel_back1
.globl wo2_kernel
.p2align 8
.type wo2_kernel,@function
wo2_kernel:
    s_cmp_ge_u32 s2, 160
    s_cbranch_scc1 L_wo2_kernel_end
    s_load_dwordx2 s[4:5], s[0:1], 88
    s_load_dwordx2 s[6:7], s[0:1], 88
    s_load_dwordx2 s[40:41], s[0:1], 32
    s_and_b32 s28, s2, 7
    s_mul_i32 s28, s28, 20
    s_lshr_b32 s29, s2, 3
    s_add_u32 s28, s28, s29
    s_lshr_b32 s29, s28, 5
    s_and_b32 s28, s28, 31
    v_lshrrev_b32 v1, 6, v0
    v_and_b32 v5, 63, v0
    v_readfirstlane_b32 s39, v1
    v_and_b32 v6, 31, v0
    v_lshrrev_b32 v7, 5, v5
    s_waitcnt lgkmcnt(0)
    s_and_b32 s37, s39, 1
    s_lshr_b32 s38, s39, 1
    s_add_u32 s8, s4, 0x568000
    s_addc_u32 s9, s5, 0
    s_mov_b32 s10, 0x280000
    s_mov_b32 s11, 0x20000
    s_mul_i32 s30, s28, 81920
    s_lshl_b32 s3, s29, 8
    s_add_u32 s12, s40, s3
    s_addc_u32 s13, s41, 0
    s_sub_u32 s14, 0xc8000, s3
    s_mov_b32 s15, 0x20000
    s_add_u32 s16, s12, 128
    s_addc_u32 s17, s13, 0
    s_sub_u32 s18, s14, 128
    s_mov_b32 s19, 0x20000
    s_mov_b32 s33, 1280
    s_lshl_b32 s32, s33, 6
    s_mov_b32 s31, 0
    s_mul_i32 s34, s39, 2048
    s_lshl_b32 s35, s39, 11
    s_add_u32 s35, s35, 8192
    v_lshrrev_b32 v1, 3, v5
    v_lshrrev_b32 v2, 4, v5
    v_and_b32 v3, 7, v5
    s_mul_i32 s3, s39, 16
    v_add_u32 v4, 0, v2
    v_and_b32 v4, 7, v4
    v_xor_b32 v4, v4, v3
    v_add_u32 v64, s3, v1
    v_mul_u32_u24 v64, 0x500, v64
    v_lshl_add_u32 v64, v4, 4, v64
    v_add_u32 v4, 4, v2
    v_and_b32 v4, 7, v4
    v_xor_b32 v4, v4, v3
    v_add_u32 v65, s3, v1
    v_add_u32 v65, 8, v65
    v_mul_u32_u24 v65, 0x500, v65
    v_lshl_add_u32 v65, v4, 4, v65
    v_subrev_u32 v65, 1024, v65
    v_and_b32 v4, 1, v2
    v_lshlrev_b32 v4, 2, v4
    v_xor_b32 v4, v4, v3
    s_lshl_b32 s3, s39, 4
    v_add_u32 v66, s3, v1
    v_mul_lo_u32 v66, v66, s33
    v_lshl_add_u32 v66, v4, 4, v66
    v_add_u32 v67, s3, v1
    v_add_u32 v67, 8, v67
    v_mul_lo_u32 v67, v67, s33
    v_lshl_add_u32 v67, v4, 4, v67
    v_subrev_u32 v67, 1024, v67
    s_mul_i32 s3, s38, 32
    v_add_u32 v1, s3, v6
    v_lshlrev_b32 v1, 7, v1
    v_bfe_u32 v2, v5, 1, 3
    v_add_u32 v3, 0, v7
    v_xor_b32 v3, v3, v2
    v_lshl_add_u32 v68, v3, 4, v1
    v_add_u32 v3, 2, v7
    v_xor_b32 v3, v3, v2
    v_lshl_add_u32 v69, v3, 4, v1
    v_add_u32 v3, 4, v7
    v_xor_b32 v3, v3, v2
    v_lshl_add_u32 v70, v3, 4, v1
    v_add_u32 v3, 6, v7
    v_xor_b32 v3, v3, v2
    v_lshl_add_u32 v71, v3, 4, v1
    v_lshrrev_b32 v1, 5, v5
    v_lshlrev_b32 v1, 3, v1
    v_bfe_u32 v2, v5, 2, 2
    v_add_u32 v1, v1, v2
    v_lshlrev_b32 v72, 7, v1
    v_bfe_u32 v1, v5, 4, 1
    v_lshlrev_b32 v1, 1, v1
    v_bfe_u32 v2, v5, 1, 1
    v_add_u32 v1, v1, v2
    s_lshl_b32 s3, s37, 2
    v_add_u32 v1, s3, v1
    v_bfe_u32 v2, v5, 3, 1
    v_lshlrev_b32 v2, 2, v2
    v_xor_b32 v1, v1, v2
    v_lshl_add_u32 v72, v1, 4, v72
    v_and_b32 v1, 1, v5
    v_lshl_add_u32 v72, v1, 3, v72
    v_add_u32 v72, 8192, v72
    s_mov_b32 s36, 0
    s_mov_b32 s58, 0
    s_add_u32 m0, s36, s34
    s_nop 0
    buffer_load_dwordx4 v64, s[8:11], s30 offen offset:0 lds
    buffer_load_dwordx4 v65, s[8:11], s30 offen offset:1024 lds
    s_add_u32 m0, s36, s35
    s_nop 0
    buffer_load_dwordx4 v66, s[12:15], s31 offen lds
    buffer_load_dwordx4 v67, s[12:15], s31 offen offset:1024 lds
    s_add_u32 m0, m0, 0x2000
    s_nop 0
    buffer_load_dwordx4 v66, s[16:19], s31 offen lds
    buffer_load_dwordx4 v67, s[16:19], s31 offen offset:1024 lds
    s_add_u32 s30, s30, 128
    s_add_u32 s31, s31, s32
    s_add_u32 s36, s36, 24576
    s_add_u32 s58, s58, 1
    s_cmp_eq_u32 s58, 3
    s_cselect_b32 s36, 0, s36
    s_cselect_b32 s58, 0, s58
    s_add_u32 m0, s36, s34
    s_nop 0
    buffer_load_dwordx4 v64, s[8:11], s30 offen offset:0 lds
    buffer_load_dwordx4 v65, s[8:11], s30 offen offset:1024 lds
    s_add_u32 m0, s36, s35
    s_nop 0
    buffer_load_dwordx4 v66, s[12:15], s31 offen lds
    buffer_load_dwordx4 v67, s[12:15], s31 offen offset:1024 lds
    s_add_u32 m0, m0, 0x2000
    s_nop 0
    buffer_load_dwordx4 v66, s[16:19], s31 offen lds
    buffer_load_dwordx4 v67, s[16:19], s31 offen offset:1024 lds
    s_add_u32 s30, s30, 128
    s_add_u32 s31, s31, s32
    s_add_u32 s36, s36, 24576
    s_add_u32 s58, s58, 1
    s_cmp_eq_u32 s58, 3
    s_cselect_b32 s36, 0, s36
    s_cselect_b32 s58, 0, s58
    s_mov_b32 s59, 0
    s_mov_b32 s60, 0xffff4000
    s_mov_b32 s61, 24576
    s_mov_b32 s49, 0
    v_mov_b32 v8, 0
    v_mov_b32 v9, 0
    v_mov_b32 v10, 0
    v_mov_b32 v11, 0
    v_mov_b32 v12, 0
    v_mov_b32 v13, 0
    v_mov_b32 v14, 0
    v_mov_b32 v15, 0
    v_mov_b32 v16, 0
    v_mov_b32 v17, 0
    v_mov_b32 v18, 0
    v_mov_b32 v19, 0
    v_mov_b32 v20, 0
    v_mov_b32 v21, 0
    v_mov_b32 v22, 0
    v_mov_b32 v23, 0
    v_mov_b32 v24, 0
    v_mov_b32 v25, 0
    v_mov_b32 v26, 0
    v_mov_b32 v27, 0
    v_mov_b32 v28, 0
    v_mov_b32 v29, 0
    v_mov_b32 v30, 0
    v_mov_b32 v31, 0
    v_mov_b32 v32, 0
    v_mov_b32 v33, 0
    v_mov_b32 v34, 0
    v_mov_b32 v35, 0
    v_mov_b32 v36, 0
    v_mov_b32 v37, 0
    v_mov_b32 v38, 0
    v_mov_b32 v39, 0
L_wo2_kernel_loop:
    s_waitcnt vmcnt(6)
    s_barrier
    s_add_u32 m0, s36, s34
    s_nop 0
    buffer_load_dwordx4 v64, s[8:11], s30 offen offset:0 lds
    buffer_load_dwordx4 v65, s[8:11], s30 offen offset:1024 lds
    s_add_u32 m0, s36, s35
    s_nop 0
    buffer_load_dwordx4 v66, s[12:15], s31 offen lds
    buffer_load_dwordx4 v67, s[12:15], s31 offen offset:1024 lds
    s_add_u32 m0, m0, 0x2000
    s_nop 0
    buffer_load_dwordx4 v66, s[16:19], s31 offen lds
    buffer_load_dwordx4 v67, s[16:19], s31 offen offset:1024 lds
    s_add_u32 s30, s30, 128
    s_add_u32 s31, s31, s32
    s_add_u32 s36, s36, 24576
    s_add_u32 s58, s58, 1
    s_cmp_eq_u32 s58, 3
    s_cselect_b32 s36, 0, s36
    s_cselect_b32 s58, 0, s58
    ds_read_b128 v[48:51], v68 offset:0
    ds_read_b64_tr_b16 v[40:41], v72 offset:0
    ds_read_b64_tr_b16 v[42:43], v72 offset:512
    ds_read_b64_tr_b16 v[44:45], v72 offset:8192
    ds_read_b64_tr_b16 v[46:47], v72 offset:8704
    ds_read_b128 v[60:63], v69 offset:0
    ds_read_b64_tr_b16 v[52:53], v72 offset:2048
    ds_read_b64_tr_b16 v[54:55], v72 offset:2560
    ds_read_b64_tr_b16 v[56:57], v72 offset:10240
    ds_read_b64_tr_b16 v[58:59], v72 offset:10752
    s_waitcnt lgkmcnt(5)
    v_mfma_f32_32x32x16_bf16 v[8:23], v[40:43], v[48:51], v[8:23]
    v_mfma_f32_32x32x16_bf16 v[24:39], v[44:47], v[48:51], v[24:39]
    ds_read_b128 v[48:51], v70 offset:0
    ds_read_b64_tr_b16 v[40:41], v72 offset:4096
    ds_read_b64_tr_b16 v[42:43], v72 offset:4608
    ds_read_b64_tr_b16 v[44:45], v72 offset:12288
    ds_read_b64_tr_b16 v[46:47], v72 offset:12800
    s_waitcnt lgkmcnt(5)
    v_mfma_f32_32x32x16_bf16 v[8:23], v[52:55], v[60:63], v[8:23]
    v_mfma_f32_32x32x16_bf16 v[24:39], v[56:59], v[60:63], v[24:39]
    ds_read_b128 v[60:63], v71 offset:0
    ds_read_b64_tr_b16 v[52:53], v72 offset:6144
    ds_read_b64_tr_b16 v[54:55], v72 offset:6656
    ds_read_b64_tr_b16 v[56:57], v72 offset:14336
    ds_read_b64_tr_b16 v[58:59], v72 offset:14848
    s_waitcnt lgkmcnt(5)
    v_mfma_f32_32x32x16_bf16 v[8:23], v[40:43], v[48:51], v[8:23]
    v_mfma_f32_32x32x16_bf16 v[24:39], v[44:47], v[48:51], v[24:39]
    s_waitcnt lgkmcnt(0)
    v_mfma_f32_32x32x16_bf16 v[8:23], v[52:55], v[60:63], v[8:23]
    v_mfma_f32_32x32x16_bf16 v[24:39], v[56:59], v[60:63], v[24:39]
    s_add_u32 s59, s59, 1
    s_cmp_eq_u32 s59, 3
    s_cselect_b32 s48, s60, s61
    s_cselect_b32 s59, 0, s59
    v_add_u32 v68, s48, v68
    v_add_u32 v69, s48, v69
    v_add_u32 v70, s48, v70
    v_add_u32 v71, s48, v71
    v_add_u32 v72, s48, v72
    s_add_u32 s49, s49, 1
    s_cmp_lt_u32 s49, 10
    s_cbranch_scc1 L_wo2_kernel_loop
    s_waitcnt vmcnt(0)
    s_mul_i32 s3, s28, 64
    s_mul_i32 s50, s38, 32
    s_add_u32 s3, s3, s50
    v_add_u32 v1, s3, v6
    s_mov_b32 s51, 0xffff0000
    s_add_u32 s20, s6, 0xce8000
    s_addc_u32 s21, s7, 0
    s_mov_b32 s22, 0x280000
    s_mov_b32 s23, 0x20000
    s_add_u32 s24, s6, 0xa68000
    s_addc_u32 s25, s7, 0
    s_mov_b32 s26, 0x280000
    s_mov_b32 s27, 0x20000
    v_mul_u32_u24 v2, 0x500, v1
    s_lshl_b32 s3, s29, 8
    s_lshl_b32 s50, s37, 6
    s_add_u32 s3, s3, s50
    v_add_u32 v2, s3, v2
    v_lshl_add_u32 v2, v7, 3, v2
    s_mov_b32 s52, 0xa000
    buffer_load_dwordx2 v[40:41], v2, s[24:27], 0 offen offset:0
    buffer_load_dwordx2 v[42:43], v2, s[24:27], 0 offen offset:16
    buffer_load_dwordx2 v[44:45], v2, s[24:27], 0 offen offset:32
    buffer_load_dwordx2 v[46:47], v2, s[24:27], 0 offen offset:48
    buffer_load_dwordx2 v[48:49], v2, s[24:27], 0 offen offset:128
    buffer_load_dwordx2 v[50:51], v2, s[24:27], 0 offen offset:144
    buffer_load_dwordx2 v[52:53], v2, s[24:27], 0 offen offset:160
    buffer_load_dwordx2 v[54:55], v2, s[24:27], 0 offen offset:176
    v_mov_b32 v80, 0x3f803f80
    v_mov_b32 v82, 0
    v_mov_b32 v83, 0
    v_cvt_pk_bf16_f32 v74, v8, v9
    v_cvt_pk_bf16_f32 v75, v10, v11
    v_lshlrev_b32 v8, 16, v74
    v_and_b32 v9, s51, v74
    v_lshlrev_b32 v10, 16, v75
    v_and_b32 v11, s51, v75
    s_waitcnt vmcnt(0)
    v_lshlrev_b32 v76, 16, v40
    v_and_b32 v77, s51, v40
    v_lshlrev_b32 v78, 16, v41
    v_and_b32 v79, s51, v41
    v_pk_add_f32 v[8:9], v[8:9], v[76:77]
    v_pk_add_f32 v[10:11], v[10:11], v[78:79]
    v_cvt_pk_bf16_f32 v40, v8, v9
    v_cvt_pk_bf16_f32 v41, v10, v11
    buffer_store_dwordx2 v[40:41], v2, s[20:23], 0 offen offset:0
    v_dot2c_f32_bf16 v82, v40, v80
    v_dot2c_f32_bf16 v83, v40, v40
    v_dot2c_f32_bf16 v82, v41, v80
    v_dot2c_f32_bf16 v83, v41, v41
    v_cvt_pk_bf16_f32 v74, v12, v13
    v_cvt_pk_bf16_f32 v75, v14, v15
    v_lshlrev_b32 v12, 16, v74
    v_and_b32 v13, s51, v74
    v_lshlrev_b32 v14, 16, v75
    v_and_b32 v15, s51, v75
    v_lshlrev_b32 v76, 16, v42
    v_and_b32 v77, s51, v42
    v_lshlrev_b32 v78, 16, v43
    v_and_b32 v79, s51, v43
    v_pk_add_f32 v[12:13], v[12:13], v[76:77]
    v_pk_add_f32 v[14:15], v[14:15], v[78:79]
    v_cvt_pk_bf16_f32 v42, v12, v13
    v_cvt_pk_bf16_f32 v43, v14, v15
    buffer_store_dwordx2 v[42:43], v2, s[20:23], 0 offen offset:16
    v_dot2c_f32_bf16 v82, v42, v80
    v_dot2c_f32_bf16 v83, v42, v42
    v_dot2c_f32_bf16 v82, v43, v80
    v_dot2c_f32_bf16 v83, v43, v43
    v_cvt_pk_bf16_f32 v74, v16, v17
    v_cvt_pk_bf16_f32 v75, v18, v19
    v_lshlrev_b32 v16, 16, v74
    v_and_b32 v17, s51, v74
    v_lshlrev_b32 v18, 16, v75
    v_and_b32 v19, s51, v75
    v_lshlrev_b32 v76, 16, v44
    v_and_b32 v77, s51, v44
    v_lshlrev_b32 v78, 16, v45
    v_and_b32 v79, s51, v45
    v_pk_add_f32 v[16:17], v[16:17], v[76:77]
    v_pk_add_f32 v[18:19], v[18:19], v[78:79]
    v_cvt_pk_bf16_f32 v44, v16, v17
    v_cvt_pk_bf16_f32 v45, v18, v19
    buffer_store_dwordx2 v[44:45], v2, s[20:23], 0 offen offset:32
    v_dot2c_f32_bf16 v82, v44, v80
    v_dot2c_f32_bf16 v83, v44, v44
    v_dot2c_f32_bf16 v82, v45, v80
    v_dot2c_f32_bf16 v83, v45, v45
    v_cvt_pk_bf16_f32 v74, v20, v21
    v_cvt_pk_bf16_f32 v75, v22, v23
    v_lshlrev_b32 v20, 16, v74
    v_and_b32 v21, s51, v74
    v_lshlrev_b32 v22, 16, v75
    v_and_b32 v23, s51, v75
    v_lshlrev_b32 v76, 16, v46
    v_and_b32 v77, s51, v46
    v_lshlrev_b32 v78, 16, v47
    v_and_b32 v79, s51, v47
    v_pk_add_f32 v[20:21], v[20:21], v[76:77]
    v_pk_add_f32 v[22:23], v[22:23], v[78:79]
    v_cvt_pk_bf16_f32 v46, v20, v21
    v_cvt_pk_bf16_f32 v47, v22, v23
    buffer_store_dwordx2 v[46:47], v2, s[20:23], 0 offen offset:48
    v_dot2c_f32_bf16 v82, v46, v80
    v_dot2c_f32_bf16 v83, v46, v46
    v_dot2c_f32_bf16 v82, v47, v80
    v_dot2c_f32_bf16 v83, v47, v47
    v_cvt_pk_bf16_f32 v74, v24, v25
    v_cvt_pk_bf16_f32 v75, v26, v27
    v_lshlrev_b32 v24, 16, v74
    v_and_b32 v25, s51, v74
    v_lshlrev_b32 v26, 16, v75
    v_and_b32 v27, s51, v75
    v_lshlrev_b32 v76, 16, v48
    v_and_b32 v77, s51, v48
    v_lshlrev_b32 v78, 16, v49
    v_and_b32 v79, s51, v49
    v_pk_add_f32 v[24:25], v[24:25], v[76:77]
    v_pk_add_f32 v[26:27], v[26:27], v[78:79]
    v_cvt_pk_bf16_f32 v48, v24, v25
    v_cvt_pk_bf16_f32 v49, v26, v27
    buffer_store_dwordx2 v[48:49], v2, s[20:23], 0 offen offset:128
    v_dot2c_f32_bf16 v82, v48, v80
    v_dot2c_f32_bf16 v83, v48, v48
    v_dot2c_f32_bf16 v82, v49, v80
    v_dot2c_f32_bf16 v83, v49, v49
    v_cvt_pk_bf16_f32 v74, v28, v29
    v_cvt_pk_bf16_f32 v75, v30, v31
    v_lshlrev_b32 v28, 16, v74
    v_and_b32 v29, s51, v74
    v_lshlrev_b32 v30, 16, v75
    v_and_b32 v31, s51, v75
    v_lshlrev_b32 v76, 16, v50
    v_and_b32 v77, s51, v50
    v_lshlrev_b32 v78, 16, v51
    v_and_b32 v79, s51, v51
    v_pk_add_f32 v[28:29], v[28:29], v[76:77]
    v_pk_add_f32 v[30:31], v[30:31], v[78:79]
    v_cvt_pk_bf16_f32 v50, v28, v29
    v_cvt_pk_bf16_f32 v51, v30, v31
    buffer_store_dwordx2 v[50:51], v2, s[20:23], 0 offen offset:144
    v_dot2c_f32_bf16 v82, v50, v80
    v_dot2c_f32_bf16 v83, v50, v50
    v_dot2c_f32_bf16 v82, v51, v80
    v_dot2c_f32_bf16 v83, v51, v51
    v_cvt_pk_bf16_f32 v74, v32, v33
    v_cvt_pk_bf16_f32 v75, v34, v35
    v_lshlrev_b32 v32, 16, v74
    v_and_b32 v33, s51, v74
    v_lshlrev_b32 v34, 16, v75
    v_and_b32 v35, s51, v75
    v_lshlrev_b32 v76, 16, v52
    v_and_b32 v77, s51, v52
    v_lshlrev_b32 v78, 16, v53
    v_and_b32 v79, s51, v53
    v_pk_add_f32 v[32:33], v[32:33], v[76:77]
    v_pk_add_f32 v[34:35], v[34:35], v[78:79]
    v_cvt_pk_bf16_f32 v52, v32, v33
    v_cvt_pk_bf16_f32 v53, v34, v35
    buffer_store_dwordx2 v[52:53], v2, s[20:23], 0 offen offset:160
    v_dot2c_f32_bf16 v82, v52, v80
    v_dot2c_f32_bf16 v83, v52, v52
    v_dot2c_f32_bf16 v82, v53, v80
    v_dot2c_f32_bf16 v83, v53, v53
    v_cvt_pk_bf16_f32 v74, v36, v37
    v_cvt_pk_bf16_f32 v75, v38, v39
    v_lshlrev_b32 v36, 16, v74
    v_and_b32 v37, s51, v74
    v_lshlrev_b32 v38, 16, v75
    v_and_b32 v39, s51, v75
    v_lshlrev_b32 v76, 16, v54
    v_and_b32 v77, s51, v54
    v_lshlrev_b32 v78, 16, v55
    v_and_b32 v79, s51, v55
    v_pk_add_f32 v[36:37], v[36:37], v[76:77]
    v_pk_add_f32 v[38:39], v[38:39], v[78:79]
    v_cvt_pk_bf16_f32 v54, v36, v37
    v_cvt_pk_bf16_f32 v55, v38, v39
    buffer_store_dwordx2 v[54:55], v2, s[20:23], 0 offen offset:176
    v_dot2c_f32_bf16 v82, v54, v80
    v_dot2c_f32_bf16 v83, v54, v54
    v_dot2c_f32_bf16 v82, v55, v80
    v_dot2c_f32_bf16 v83, v55, v55
    s_add_u32 s24, s6, 0x1628000
    s_addc_u32 s25, s7, 0
    s_mov_b32 s26, 0x50000
    s_mov_b32 s27, 0x20000
    v_mul_u32_u24 v2, 160, v1
    s_lshl_b32 s3, s29, 5
    s_lshl_b32 s50, s37, 4
    s_add_u32 s3, s3, s50
    v_add_u32 v2, s3, v2
    v_lshl_add_u32 v2, v7, 3, v2
    s_mov_b32 s52, 5120
    buffer_store_dwordx2 v[82:83], v2, s[24:27], 0 offen
L_wo2_kernel_end:
    s_endpgm
.globl gu2_kernel
.p2align 8
.type gu2_kernel,@function
gu2_kernel:
    s_cmp_ge_u32 s2, 432
    s_cbranch_scc1 L_gu2_kernel_end
    s_load_dwordx2 s[4:5], s[0:1], 88
    s_load_dwordx2 s[6:7], s[0:1], 88
    s_load_dwordx2 s[40:41], s[0:1], 48
    s_load_dwordx2 s[42:43], s[0:1], 56
    s_and_b32 s28, s2, 7
    s_mul_i32 s28, s28, 54
    s_lshr_b32 s29, s2, 3
    s_add_u32 s28, s28, s29
    s_lshr_b32 s29, s28, 4
    s_and_b32 s28, s28, 15
    v_lshrrev_b32 v1, 6, v0
    v_and_b32 v5, 63, v0
    v_readfirstlane_b32 s39, v1
    v_and_b32 v6, 31, v0
    v_lshrrev_b32 v7, 5, v5
    s_waitcnt lgkmcnt(0)
    s_and_b32 s37, s39, 1
    s_lshr_b32 s38, s39, 1
    s_add_u32 s24, s6, 0x1628000
    s_addc_u32 s25, s7, 0
    s_mov_b32 s26, 0x50000
    s_mov_b32 s27, 0x20000
    s_mul_i32 s3, s28, 128
    s_mul_i32 s50, s38, 64
    s_add_u32 s3, s3, s50
    v_add_u32 v2, s3, v6
    v_mul_u32_u24 v2, 160, v2
    s_mov_b32 s50, 5120
    buffer_load_dwordx4 v[8:11], v2, s[24:27], 0 offen offset:0
    buffer_load_dwordx4 v[12:15], v2, s[24:27], 0 offen offset:16
    buffer_load_dwordx4 v[16:19], v2, s[24:27], 0 offen offset:32
    buffer_load_dwordx4 v[20:23], v2, s[24:27], 0 offen offset:48
    buffer_load_dwordx4 v[24:27], v2, s[24:27], 0 offen offset:64
    buffer_load_dwordx4 v[28:31], v2, s[24:27], 0 offen offset:80
    buffer_load_dwordx4 v[32:35], v2, s[24:27], 0 offen offset:96
    buffer_load_dwordx4 v[36:39], v2, s[24:27], 0 offen offset:112
    buffer_load_dwordx4 v[40:43], v2, s[24:27], 0 offen offset:128
    buffer_load_dwordx4 v[44:47], v2, s[24:27], 0 offen offset:144
    buffer_load_dwordx4 v[48:51], v2, s[24:27], s50 offen offset:0
    buffer_load_dwordx4 v[52:55], v2, s[24:27], s50 offen offset:16
    buffer_load_dwordx4 v[56:59], v2, s[24:27], s50 offen offset:32
    buffer_load_dwordx4 v[60:63], v2, s[24:27], s50 offen offset:48
    buffer_load_dwordx4 v[64:67], v2, s[24:27], s50 offen offset:64
    buffer_load_dwordx4 v[68:71], v2, s[24:27], s50 offen offset:80
    buffer_load_dwordx4 v[72:75], v2, s[24:27], s50 offen offset:96
    buffer_load_dwordx4 v[76:79], v2, s[24:27], s50 offen offset:112
    buffer_load_dwordx4 v[80:83], v2, s[24:27], s50 offen offset:128
    buffer_load_dwordx4 v[84:87], v2, s[24:27], s50 offen offset:144
    s_add_u32 s8, s4, 0xce8000
    s_addc_u32 s9, s5, 0
    s_mov_b32 s10, 0x280000
    s_mov_b32 s11, 0x20000
    s_mul_i32 s30, s28, 163840
    s_lshl_b32 s3, s29, 7
    s_add_u32 s12, s40, s3
    s_addc_u32 s13, s41, 0
    s_sub_u32 s14, 0x21c000, s3
    s_mov_b32 s15, 0x20000
    s_add_u32 s16, s42, s3
    s_addc_u32 s17, s43, 0
    s_sub_u32 s18, 0x21c000, s3
    s_mov_b32 s19, 0x20000
    s_mov_b32 s33, 3456
    s_lshl_b32 s32, s33, 6
    s_mov_b32 s31, 0
    s_mul_i32 s34, s39, 4096
    s_lshl_b32 s35, s39, 11
    s_add_u32 s35, s35, 16384
    v_lshrrev_b32 v1, 3, v5
    v_lshrrev_b32 v2, 4, v5
    v_and_b32 v3, 7, v5
    s_mul_i32 s3, s39, 32
    v_add_u32 v4, 0, v2
    v_and_b32 v4, 7, v4
    v_xor_b32 v4, v4, v3
    v_add_u32 v104, s3, v1
    v_mul_u32_u24 v104, 0x500, v104
    v_lshl_add_u32 v104, v4, 4, v104
    v_add_u32 v4, 4, v2
    v_and_b32 v4, 7, v4
    v_xor_b32 v4, v4, v3
    v_add_u32 v105, s3, v1
    v_add_u32 v105, 8, v105
    v_mul_u32_u24 v105, 0x500, v105
    v_lshl_add_u32 v105, v4, 4, v105
    v_subrev_u32 v105, 1024, v105
    v_add_u32 v4, 8, v2
    v_and_b32 v4, 7, v4
    v_xor_b32 v4, v4, v3
    v_add_u32 v106, s3, v1
    v_add_u32 v106, 16, v106
    v_mul_u32_u24 v106, 0x500, v106
    v_lshl_add_u32 v106, v4, 4, v106
    v_subrev_u32 v106, 2048, v106
    v_add_u32 v4, 12, v2
    v_and_b32 v4, 7, v4
    v_xor_b32 v4, v4, v3
    v_add_u32 v107, s3, v1
    v_add_u32 v107, 24, v107
    v_mul_u32_u24 v107, 0x500, v107
    v_lshl_add_u32 v107, v4, 4, v107
    v_subrev_u32 v107, 3072, v107
    v_and_b32 v4, 1, v2
    v_lshlrev_b32 v4, 2, v4
    v_xor_b32 v4, v4, v3
    s_lshl_b32 s3, s39, 4
    v_add_u32 v108, s3, v1
    v_mul_lo_u32 v108, v108, s33
    v_lshl_add_u32 v108, v4, 4, v108
    v_add_u32 v109, s3, v1
    v_add_u32 v109, 8, v109
    v_mul_lo_u32 v109, v109, s33
    v_lshl_add_u32 v109, v4, 4, v109
    v_subrev_u32 v109, 1024, v109
    s_mul_i32 s3, s38, 64
    v_add_u32 v1, s3, v6
    v_lshlrev_b32 v1, 7, v1
    v_bfe_u32 v2, v5, 1, 3
    v_add_u32 v3, 0, v7
    v_xor_b32 v3, v3, v2
    v_lshl_add_u32 v110, v3, 4, v1
    v_add_u32 v3, 2, v7
    v_xor_b32 v3, v3, v2
    v_lshl_add_u32 v111, v3, 4, v1
    v_add_u32 v3, 4, v7
    v_xor_b32 v3, v3, v2
    v_lshl_add_u32 v112, v3, 4, v1
    v_add_u32 v3, 6, v7
    v_xor_b32 v3, v3, v2
    v_lshl_add_u32 v113, v3, 4, v1
    v_lshrrev_b32 v1, 5, v5
    v_lshlrev_b32 v1, 3, v1
    v_bfe_u32 v2, v5, 2, 2
    v_add_u32 v1, v1, v2
    v_lshlrev_b32 v114, 7, v1
    v_bfe_u32 v1, v5, 4, 1
    v_lshlrev_b32 v1, 1, v1
    v_bfe_u32 v2, v5, 1, 1
    v_add_u32 v1, v1, v2
    s_lshl_b32 s3, s37, 2
    v_add_u32 v1, s3, v1
    v_bfe_u32 v2, v5, 3, 1
    v_lshlrev_b32 v2, 2, v2
    v_xor_b32 v1, v1, v2
    v_lshl_add_u32 v114, v1, 4, v114
    v_and_b32 v1, 1, v5
    v_lshl_add_u32 v114, v1, 3, v114
    v_add_u32 v114, 16384, v114
    s_mov_b32 s36, 0
    s_mov_b32 s58, 0
    s_add_u32 m0, s36, s34
    s_nop 0
    buffer_load_dwordx4 v104, s[8:11], s30 offen offset:0 lds
    buffer_load_dwordx4 v105, s[8:11], s30 offen offset:1024 lds
    buffer_load_dwordx4 v106, s[8:11], s30 offen offset:2048 lds
    buffer_load_dwordx4 v107, s[8:11], s30 offen offset:3072 lds
    s_add_u32 m0, s36, s35
    s_nop 0
    buffer_load_dwordx4 v108, s[12:15], s31 offen lds
    buffer_load_dwordx4 v109, s[12:15], s31 offen offset:1024 lds
    s_add_u32 m0, m0, 0x2000
    s_nop 0
    buffer_load_dwordx4 v108, s[16:19], s31 offen lds
    buffer_load_dwordx4 v109, s[16:19], s31 offen offset:1024 lds
    s_add_u32 s30, s30, 128
    s_add_u32 s31, s31, s32
    s_add_u32 s36, s36, 32768
    s_add_u32 s58, s58, 1
    s_cmp_eq_u32 s58, 2
    s_cselect_b32 s36, 0, s36
    s_cselect_b32 s58, 0, s58
    s_mov_b32 s59, 0
    s_mov_b32 s60, 0xffff8000
    s_mov_b32 s61, 32768
    s_mov_b32 s49, 0
    s_waitcnt vmcnt(8)
    s_mov_b32 s51, 0xffff0000
    s_mov_b32 s52, 0x3acccccd
    s_mov_b32 s53, 0x3727c5ac
    v_pk_add_f32 v[8:9], v[8:9], v[10:11]
    v_pk_add_f32 v[8:9], v[8:9], v[12:13]
    v_pk_add_f32 v[8:9], v[8:9], v[14:15]
    v_pk_add_f32 v[8:9], v[8:9], v[16:17]
    v_pk_add_f32 v[8:9], v[8:9], v[18:19]
    v_pk_add_f32 v[8:9], v[8:9], v[20:21]
    v_pk_add_f32 v[8:9], v[8:9], v[22:23]
    v_pk_add_f32 v[8:9], v[8:9], v[24:25]
    v_pk_add_f32 v[8:9], v[8:9], v[26:27]
    v_pk_add_f32 v[8:9], v[8:9], v[28:29]
    v_pk_add_f32 v[8:9], v[8:9], v[30:31]
    v_pk_add_f32 v[8:9], v[8:9], v[32:33]
    v_pk_add_f32 v[8:9], v[8:9], v[34:35]
    v_pk_add_f32 v[8:9], v[8:9], v[36:37]
    v_pk_add_f32 v[8:9], v[8:9], v[38:39]
    v_pk_add_f32 v[8:9], v[8:9], v[40:41]
    v_pk_add_f32 v[8:9], v[8:9], v[42:43]
    v_pk_add_f32 v[8:9], v[8:9], v[44:45]
    v_pk_add_f32 v[8:9], v[8:9], v[46:47]
    v_mul_f32 v8, s52, v8
    v_mul_f32 v9, s52, v9
    v_fma_f32 v9, -v8, v8, v9
    v_max_f32 v9, 0, v9
    v_cvt_pk_bf16_f32 v10, v8, v9
    v_lshlrev_b32 v8, 16, v10
    v_and_b32 v9, s51, v10
    v_add_f32 v9, s53, v9
    v_cvt_pk_bf16_f32 v9, v9, v9
    v_lshlrev_b32 v9, 16, v9
    v_sqrt_f32 v9, v9
    s_nop 0
    v_cvt_pk_bf16_f32 v9, v9, v9
    v_lshlrev_b32 v9, 16, v9
    v_rcp_f32 v10, v9
    s_nop 0
    v_fma_f32 v11, -v9, v10, 2.0
    v_mul_f32 v10, v10, v11
    v_sub_f32 v116, 0, v8
    v_sub_f32 v117, 0, v8
    v_mov_b32 v120, v10
    v_mov_b32 v121, v10
    v_pk_add_f32 v[48:49], v[48:49], v[50:51]
    v_pk_add_f32 v[48:49], v[48:49], v[52:53]
    v_pk_add_f32 v[48:49], v[48:49], v[54:55]
    v_pk_add_f32 v[48:49], v[48:49], v[56:57]
    v_pk_add_f32 v[48:49], v[48:49], v[58:59]
    v_pk_add_f32 v[48:49], v[48:49], v[60:61]
    v_pk_add_f32 v[48:49], v[48:49], v[62:63]
    v_pk_add_f32 v[48:49], v[48:49], v[64:65]
    v_pk_add_f32 v[48:49], v[48:49], v[66:67]
    v_pk_add_f32 v[48:49], v[48:49], v[68:69]
    v_pk_add_f32 v[48:49], v[48:49], v[70:71]
    v_pk_add_f32 v[48:49], v[48:49], v[72:73]
    v_pk_add_f32 v[48:49], v[48:49], v[74:75]
    v_pk_add_f32 v[48:49], v[48:49], v[76:77]
    v_pk_add_f32 v[48:49], v[48:49], v[78:79]
    v_pk_add_f32 v[48:49], v[48:49], v[80:81]
    v_pk_add_f32 v[48:49], v[48:49], v[82:83]
    v_pk_add_f32 v[48:49], v[48:49], v[84:85]
    v_pk_add_f32 v[48:49], v[48:49], v[86:87]
    v_mul_f32 v48, s52, v48
    v_mul_f32 v49, s52, v49
    v_fma_f32 v49, -v48, v48, v49
    v_max_f32 v49, 0, v49
    v_cvt_pk_bf16_f32 v50, v48, v49
    v_lshlrev_b32 v48, 16, v50
    v_and_b32 v49, s51, v50
    v_add_f32 v49, s53, v49
    v_cvt_pk_bf16_f32 v49, v49, v49
    v_lshlrev_b32 v49, 16, v49
    v_sqrt_f32 v49, v49
    s_nop 0
    v_cvt_pk_bf16_f32 v49, v49, v49
    v_lshlrev_b32 v49, 16, v49
    v_rcp_f32 v50, v49
    s_nop 0
    v_fma_f32 v51, -v49, v50, 2.0
    v_mul_f32 v50, v50, v51
    v_sub_f32 v118, 0, v48
    v_sub_f32 v119, 0, v48
    v_mov_b32 v122, v50
    v_mov_b32 v123, v50
    v_mov_b32 v8, 0
    v_mov_b32 v9, 0
    v_mov_b32 v10, 0
    v_mov_b32 v11, 0
    v_mov_b32 v12, 0
    v_mov_b32 v13, 0
    v_mov_b32 v14, 0
    v_mov_b32 v15, 0
    v_mov_b32 v16, 0
    v_mov_b32 v17, 0
    v_mov_b32 v18, 0
    v_mov_b32 v19, 0
    v_mov_b32 v20, 0
    v_mov_b32 v21, 0
    v_mov_b32 v22, 0
    v_mov_b32 v23, 0
    v_mov_b32 v24, 0
    v_mov_b32 v25, 0
    v_mov_b32 v26, 0
    v_mov_b32 v27, 0
    v_mov_b32 v28, 0
    v_mov_b32 v29, 0
    v_mov_b32 v30, 0
    v_mov_b32 v31, 0
    v_mov_b32 v32, 0
    v_mov_b32 v33, 0
    v_mov_b32 v34, 0
    v_mov_b32 v35, 0
    v_mov_b32 v36, 0
    v_mov_b32 v37, 0
    v_mov_b32 v38, 0
    v_mov_b32 v39, 0
    v_mov_b32 v40, 0
    v_mov_b32 v41, 0
    v_mov_b32 v42, 0
    v_mov_b32 v43, 0
    v_mov_b32 v44, 0
    v_mov_b32 v45, 0
    v_mov_b32 v46, 0
    v_mov_b32 v47, 0
    v_mov_b32 v48, 0
    v_mov_b32 v49, 0
    v_mov_b32 v50, 0
    v_mov_b32 v51, 0
    v_mov_b32 v52, 0
    v_mov_b32 v53, 0
    v_mov_b32 v54, 0
    v_mov_b32 v55, 0
    v_mov_b32 v56, 0
    v_mov_b32 v57, 0
    v_mov_b32 v58, 0
    v_mov_b32 v59, 0
    v_mov_b32 v60, 0
    v_mov_b32 v61, 0
    v_mov_b32 v62, 0
    v_mov_b32 v63, 0
    v_mov_b32 v64, 0
    v_mov_b32 v65, 0
    v_mov_b32 v66, 0
    v_mov_b32 v67, 0
    v_mov_b32 v68, 0
    v_mov_b32 v69, 0
    v_mov_b32 v70, 0
    v_mov_b32 v71, 0
L_gu2_kernel_loop:
    s_waitcnt vmcnt(0)
    s_barrier
    s_add_u32 m0, s36, s34
    s_nop 0
    buffer_load_dwordx4 v104, s[8:11], s30 offen offset:0 lds
    buffer_load_dwordx4 v105, s[8:11], s30 offen offset:1024 lds
    buffer_load_dwordx4 v106, s[8:11], s30 offen offset:2048 lds
    buffer_load_dwordx4 v107, s[8:11], s30 offen offset:3072 lds
    s_add_u32 m0, s36, s35
    s_nop 0
    buffer_load_dwordx4 v108, s[12:15], s31 offen lds
    buffer_load_dwordx4 v109, s[12:15], s31 offen offset:1024 lds
    s_add_u32 m0, m0, 0x2000
    s_nop 0
    buffer_load_dwordx4 v108, s[16:19], s31 offen lds
    buffer_load_dwordx4 v109, s[16:19], s31 offen offset:1024 lds
    s_add_u32 s30, s30, 128
    s_add_u32 s31, s31, s32
    s_add_u32 s36, s36, 32768
    s_add_u32 s58, s58, 1
    s_cmp_eq_u32 s58, 2
    s_cselect_b32 s36, 0, s36
    s_cselect_b32 s58, 0, s58
    ds_read_b128 v[80:83], v110 offset:0
    ds_read_b128 v[84:87], v110 offset:4096
    ds_read_b64_tr_b16 v[72:73], v114 offset:0
    ds_read_b64_tr_b16 v[74:75], v114 offset:512
    ds_read_b64_tr_b16 v[76:77], v114 offset:8192
    ds_read_b64_tr_b16 v[78:79], v114 offset:8704
    ds_read_b128 v[96:99], v111 offset:0
    ds_read_b128 v[100:103], v111 offset:4096
    ds_read_b64_tr_b16 v[88:89], v114 offset:2048
    ds_read_b64_tr_b16 v[90:91], v114 offset:2560
    ds_read_b64_tr_b16 v[92:93], v114 offset:10240
    ds_read_b64_tr_b16 v[94:95], v114 offset:10752
    s_waitcnt lgkmcnt(6)
    v_mfma_f32_32x32x16_bf16 v[8:23], v[72:75], v[80:83], v[8:23]
    v_mfma_f32_32x32x16_bf16 v[24:39], v[72:75], v[84:87], v[24:39]
    v_mfma_f32_32x32x16_bf16 v[40:55], v[76:79], v[80:83], v[40:55]
    v_mfma_f32_32x32x16_bf16 v[56:71], v[76:79], v[84:87], v[56:71]
    ds_read_b128 v[80:83], v112 offset:0
    ds_read_b128 v[84:87], v112 offset:4096
    ds_read_b64_tr_b16 v[72:73], v114 offset:4096
    ds_read_b64_tr_b16 v[74:75], v114 offset:4608
    ds_read_b64_tr_b16 v[76:77], v114 offset:12288
    ds_read_b64_tr_b16 v[78:79], v114 offset:12800
    s_waitcnt lgkmcnt(6)
    v_mfma_f32_32x32x16_bf16 v[8:23], v[88:91], v[96:99], v[8:23]
    v_mfma_f32_32x32x16_bf16 v[24:39], v[88:91], v[100:103], v[24:39]
    v_mfma_f32_32x32x16_bf16 v[40:55], v[92:95], v[96:99], v[40:55]
    v_mfma_f32_32x32x16_bf16 v[56:71], v[92:95], v[100:103], v[56:71]
    ds_read_b128 v[96:99], v113 offset:0
    ds_read_b128 v[100:103], v113 offset:4096
    ds_read_b64_tr_b16 v[88:89], v114 offset:6144
    ds_read_b64_tr_b16 v[90:91], v114 offset:6656
    ds_read_b64_tr_b16 v[92:93], v114 offset:14336
    ds_read_b64_tr_b16 v[94:95], v114 offset:14848
    s_waitcnt lgkmcnt(6)
    v_mfma_f32_32x32x16_bf16 v[8:23], v[72:75], v[80:83], v[8:23]
    v_mfma_f32_32x32x16_bf16 v[24:39], v[72:75], v[84:87], v[24:39]
    v_mfma_f32_32x32x16_bf16 v[40:55], v[76:79], v[80:83], v[40:55]
    v_mfma_f32_32x32x16_bf16 v[56:71], v[76:79], v[84:87], v[56:71]
    s_waitcnt lgkmcnt(0)
    v_mfma_f32_32x32x16_bf16 v[8:23], v[88:91], v[96:99], v[8:23]
    v_mfma_f32_32x32x16_bf16 v[24:39], v[88:91], v[100:103], v[24:39]
    v_mfma_f32_32x32x16_bf16 v[40:55], v[92:95], v[96:99], v[40:55]
    v_mfma_f32_32x32x16_bf16 v[56:71], v[92:95], v[100:103], v[56:71]
    s_add_u32 s59, s59, 1
    s_cmp_eq_u32 s59, 2
    s_cselect_b32 s48, s60, s61
    s_cselect_b32 s59, 0, s59
    v_add_u32 v110, s48, v110
    v_add_u32 v111, s48, v111
    v_add_u32 v112, s48, v112
    v_add_u32 v113, s48, v113
    v_add_u32 v114, s48, v114
    s_add_u32 s49, s49, 1
    s_cmp_lt_u32 s49, 10
    s_cbranch_scc1 L_gu2_kernel_loop
    s_waitcnt vmcnt(0)
    s_mul_i32 s3, s28, 128
    s_mul_i32 s50, s38, 64
    s_add_u32 s3, s3, s50
    v_add_u32 v1, s3, v6
    s_mov_b32 s51, 0xffff0000
    s_add_u32 s24, s6, 0x1679000
    s_addc_u32 s25, s7, 0
    s_mov_b32 s26, 0x1b00
    s_mov_b32 s27, 0x20000
    s_lshl_b32 s3, s29, 8
    s_lshl_b32 s50, s37, 7
    s_add_u32 s3, s3, s50
    v_lshlrev_b32 v3, 4, v7
    v_add_u32 v3, s3, v3
    buffer_load_dwordx4 v[72:75], v3, s[24:27], 0 offen offset:0
    buffer_load_dwordx4 v[76:79], v3, s[24:27], 0 offen offset:32
    buffer_load_dwordx4 v[80:83], v3, s[24:27], 0 offen offset:64
    buffer_load_dwordx4 v[84:87], v3, s[24:27], 0 offen offset:96
    s_add_u32 s24, s6, 0x167b000
    s_addc_u32 s25, s7, 0
    s_mov_b32 s26, 0x1b00
    s_mov_b32 s27, 0x20000
    s_lshl_b32 s3, s29, 8
    s_lshl_b32 s50, s37, 7
    s_add_u32 s3, s3, s50
    v_lshlrev_b32 v3, 4, v7
    v_add_u32 v3, s3, v3
    buffer_load_dwordx4 v[88:91], v3, s[24:27], 0 offen offset:0
    buffer_load_dwordx4 v[92:95], v3, s[24:27], 0 offen offset:32
    buffer_load_dwordx4 v[96:99], v3, s[24:27], 0 offen offset:64
    buffer_load_dwordx4 v[100:103], v3, s[24:27], 0 offen offset:96
    s_waitcnt vmcnt(0)
    v_pk_fma_f32 v[8:9], v[72:73], v[116:117], v[8:9]
    v_pk_fma_f32 v[10:11], v[74:75], v[116:117], v[10:11]
    v_pk_mul_f32 v[8:9], v[8:9], v[120:121]
    v_pk_mul_f32 v[10:11], v[10:11], v[120:121]
    v_pk_fma_f32 v[12:13], v[76:77], v[116:117], v[12:13]
    v_pk_fma_f32 v[14:15], v[78:79], v[116:117], v[14:15]
    v_pk_mul_f32 v[12:13], v[12:13], v[120:121]
    v_pk_mul_f32 v[14:15], v[14:15], v[120:121]
    v_pk_fma_f32 v[16:17], v[80:81], v[116:117], v[16:17]
    v_pk_fma_f32 v[18:19], v[82:83], v[116:117], v[18:19]
    v_pk_mul_f32 v[16:17], v[16:17], v[120:121]
    v_pk_mul_f32 v[18:19], v[18:19], v[120:121]
    v_pk_fma_f32 v[20:21], v[84:85], v[116:117], v[20:21]
    v_pk_fma_f32 v[22:23], v[86:87], v[116:117], v[22:23]
    v_pk_mul_f32 v[20:21], v[20:21], v[120:121]
    v_pk_mul_f32 v[22:23], v[22:23], v[120:121]
    v_pk_fma_f32 v[24:25], v[72:73], v[118:119], v[24:25]
    v_pk_fma_f32 v[26:27], v[74:75], v[118:119], v[26:27]
    v_pk_mul_f32 v[24:25], v[24:25], v[122:123]
    v_pk_mul_f32 v[26:27], v[26:27], v[122:123]
    v_pk_fma_f32 v[28:29], v[76:77], v[118:119], v[28:29]
    v_pk_fma_f32 v[30:31], v[78:79], v[118:119], v[30:31]
    v_pk_mul_f32 v[28:29], v[28:29], v[122:123]
    v_pk_mul_f32 v[30:31], v[30:31], v[122:123]
    v_pk_fma_f32 v[32:33], v[80:81], v[118:119], v[32:33]
    v_pk_fma_f32 v[34:35], v[82:83], v[118:119], v[34:35]
    v_pk_mul_f32 v[32:33], v[32:33], v[122:123]
    v_pk_mul_f32 v[34:35], v[34:35], v[122:123]
    v_pk_fma_f32 v[36:37], v[84:85], v[118:119], v[36:37]
    v_pk_fma_f32 v[38:39], v[86:87], v[118:119], v[38:39]
    v_pk_mul_f32 v[36:37], v[36:37], v[122:123]
    v_pk_mul_f32 v[38:39], v[38:39], v[122:123]
    v_pk_fma_f32 v[40:41], v[88:89], v[116:117], v[40:41]
    v_pk_fma_f32 v[42:43], v[90:91], v[116:117], v[42:43]
    v_pk_mul_f32 v[40:41], v[40:41], v[120:121]
    v_pk_mul_f32 v[42:43], v[42:43], v[120:121]
    v_pk_fma_f32 v[44:45], v[92:93], v[116:117], v[44:45]
    v_pk_fma_f32 v[46:47], v[94:95], v[116:117], v[46:47]
    v_pk_mul_f32 v[44:45], v[44:45], v[120:121]
    v_pk_mul_f32 v[46:47], v[46:47], v[120:121]
    v_pk_fma_f32 v[48:49], v[96:97], v[116:117], v[48:49]
    v_pk_fma_f32 v[50:51], v[98:99], v[116:117], v[50:51]
    v_pk_mul_f32 v[48:49], v[48:49], v[120:121]
    v_pk_mul_f32 v[50:51], v[50:51], v[120:121]
    v_pk_fma_f32 v[52:53], v[100:101], v[116:117], v[52:53]
    v_pk_fma_f32 v[54:55], v[102:103], v[116:117], v[54:55]
    v_pk_mul_f32 v[52:53], v[52:53], v[120:121]
    v_pk_mul_f32 v[54:55], v[54:55], v[120:121]
    v_pk_fma_f32 v[56:57], v[88:89], v[118:119], v[56:57]
    v_pk_fma_f32 v[58:59], v[90:91], v[118:119], v[58:59]
    v_pk_mul_f32 v[56:57], v[56:57], v[122:123]
    v_pk_mul_f32 v[58:59], v[58:59], v[122:123]
    v_pk_fma_f32 v[60:61], v[92:93], v[118:119], v[60:61]
    v_pk_fma_f32 v[62:63], v[94:95], v[118:119], v[62:63]
    v_pk_mul_f32 v[60:61], v[60:61], v[122:123]
    v_pk_mul_f32 v[62:63], v[62:63], v[122:123]
    v_pk_fma_f32 v[64:65], v[96:97], v[118:119], v[64:65]
    v_pk_fma_f32 v[66:67], v[98:99], v[118:119], v[66:67]
    v_pk_mul_f32 v[64:65], v[64:65], v[122:123]
    v_pk_mul_f32 v[66:67], v[66:67], v[122:123]
    v_pk_fma_f32 v[68:69], v[100:101], v[118:119], v[68:69]
    v_pk_fma_f32 v[70:71], v[102:103], v[118:119], v[70:71]
    v_pk_mul_f32 v[68:69], v[68:69], v[122:123]
    v_pk_mul_f32 v[70:71], v[70:71], v[122:123]
    s_add_u32 s20, s6, 0xf68000
    s_addc_u32 s21, s7, 0
    s_mov_b32 s22, 0x6c0000
    s_mov_b32 s23, 0x20000
    v_mul_u32_u24 v2, 3456, v1
    s_lshl_b32 s3, s29, 7
    s_lshl_b32 s50, s37, 6
    s_add_u32 s3, s3, s50
    v_add_u32 v2, s3, v2
    v_lshl_add_u32 v2, v7, 3, v2
    s_mov_b32 s52, 0x1b000
    s_mov_b32 s54, 0xbdd2d3e8
    s_mov_b32 s55, 0xbdd2d3e8
    v_mov_b32 v130, 0xc0135761
    v_mov_b32 v131, 0xc0135761
    v_cvt_pk_bf16_f32 v124, v8, v9
    v_cvt_pk_bf16_f32 v125, v10, v11
    v_cvt_pk_bf16_f32 v126, v40, v41
    v_cvt_pk_bf16_f32 v127, v42, v43
    v_lshlrev_b32 v8, 16, v124
    v_and_b32 v9, s51, v124
    v_lshlrev_b32 v10, 16, v125
    v_and_b32 v11, s51, v125
    v_lshlrev_b32 v40, 16, v126
    v_and_b32 v41, s51, v126
    v_lshlrev_b32 v42, 16, v127
    v_and_b32 v43, s51, v127
    v_pk_mul_f32 v[128:129], v[8:9], v[8:9]
    v_pk_fma_f32 v[128:129], v[128:129], s[54:55], v[130:131]
    v_pk_mul_f32 v[128:129], v[128:129], v[8:9]
    v_exp_f32 v128, v128
    v_exp_f32 v129, v129
    v_add_f32 v128, 1.0, v128
    v_add_f32 v129, 1.0, v129
    v_rcp_f32 v128, v128
    v_rcp_f32 v129, v129
    s_nop 0
    v_pk_mul_f32 v[8:9], v[8:9], v[128:129]
    v_pk_mul_f32 v[128:129], v[10:11], v[10:11]
    v_pk_fma_f32 v[128:129], v[128:129], s[54:55], v[130:131]
    v_pk_mul_f32 v[128:129], v[128:129], v[10:11]
    v_exp_f32 v128, v128
    v_exp_f32 v129, v129
    v_add_f32 v128, 1.0, v128
    v_add_f32 v129, 1.0, v129
    v_rcp_f32 v128, v128
    v_rcp_f32 v129, v129
    s_nop 0
    v_pk_mul_f32 v[10:11], v[10:11], v[128:129]
    v_cvt_pk_bf16_f32 v124, v8, v9
    v_cvt_pk_bf16_f32 v125, v10, v11
    v_lshlrev_b32 v8, 16, v124
    v_and_b32 v9, s51, v124
    v_lshlrev_b32 v10, 16, v125
    v_and_b32 v11, s51, v125
    v_pk_mul_f32 v[8:9], v[8:9], v[40:41]
    v_pk_mul_f32 v[10:11], v[10:11], v[42:43]
    v_cvt_pk_bf16_f32 v40, v8, v9
    v_cvt_pk_bf16_f32 v41, v10, v11
    buffer_store_dwordx2 v[40:41], v2, s[20:23], 0 offen offset:0
    v_cvt_pk_bf16_f32 v124, v12, v13
    v_cvt_pk_bf16_f32 v125, v14, v15
    v_cvt_pk_bf16_f32 v126, v44, v45
    v_cvt_pk_bf16_f32 v127, v46, v47
    v_lshlrev_b32 v12, 16, v124
    v_and_b32 v13, s51, v124
    v_lshlrev_b32 v14, 16, v125
    v_and_b32 v15, s51, v125
    v_lshlrev_b32 v44, 16, v126
    v_and_b32 v45, s51, v126
    v_lshlrev_b32 v46, 16, v127
    v_and_b32 v47, s51, v127
    v_pk_mul_f32 v[128:129], v[12:13], v[12:13]
    v_pk_fma_f32 v[128:129], v[128:129], s[54:55], v[130:131]
    v_pk_mul_f32 v[128:129], v[128:129], v[12:13]
    v_exp_f32 v128, v128
    v_exp_f32 v129, v129
    v_add_f32 v128, 1.0, v128
    v_add_f32 v129, 1.0, v129
    v_rcp_f32 v128, v128
    v_rcp_f32 v129, v129
    s_nop 0
    v_pk_mul_f32 v[12:13], v[12:13], v[128:129]
    v_pk_mul_f32 v[128:129], v[14:15], v[14:15]
    v_pk_fma_f32 v[128:129], v[128:129], s[54:55], v[130:131]
    v_pk_mul_f32 v[128:129], v[128:129], v[14:15]
    v_exp_f32 v128, v128
    v_exp_f32 v129, v129
    v_add_f32 v128, 1.0, v128
    v_add_f32 v129, 1.0, v129
    v_rcp_f32 v128, v128
    v_rcp_f32 v129, v129
    s_nop 0
    v_pk_mul_f32 v[14:15], v[14:15], v[128:129]
    v_cvt_pk_bf16_f32 v124, v12, v13
    v_cvt_pk_bf16_f32 v125, v14, v15
    v_lshlrev_b32 v12, 16, v124
    v_and_b32 v13, s51, v124
    v_lshlrev_b32 v14, 16, v125
    v_and_b32 v15, s51, v125
    v_pk_mul_f32 v[12:13], v[12:13], v[44:45]
    v_pk_mul_f32 v[14:15], v[14:15], v[46:47]
    v_cvt_pk_bf16_f32 v44, v12, v13
    v_cvt_pk_bf16_f32 v45, v14, v15
    buffer_store_dwordx2 v[44:45], v2, s[20:23], 0 offen offset:16
    v_cvt_pk_bf16_f32 v124, v16, v17
    v_cvt_pk_bf16_f32 v125, v18, v19
    v_cvt_pk_bf16_f32 v126, v48, v49
    v_cvt_pk_bf16_f32 v127, v50, v51
    v_lshlrev_b32 v16, 16, v124
    v_and_b32 v17, s51, v124
    v_lshlrev_b32 v18, 16, v125
    v_and_b32 v19, s51, v125
    v_lshlrev_b32 v48, 16, v126
    v_and_b32 v49, s51, v126
    v_lshlrev_b32 v50, 16, v127
    v_and_b32 v51, s51, v127
    v_pk_mul_f32 v[128:129], v[16:17], v[16:17]
    v_pk_fma_f32 v[128:129], v[128:129], s[54:55], v[130:131]
    v_pk_mul_f32 v[128:129], v[128:129], v[16:17]
    v_exp_f32 v128, v128
    v_exp_f32 v129, v129
    v_add_f32 v128, 1.0, v128
    v_add_f32 v129, 1.0, v129
    v_rcp_f32 v128, v128
    v_rcp_f32 v129, v129
    s_nop 0
    v_pk_mul_f32 v[16:17], v[16:17], v[128:129]
    v_pk_mul_f32 v[128:129], v[18:19], v[18:19]
    v_pk_fma_f32 v[128:129], v[128:129], s[54:55], v[130:131]
    v_pk_mul_f32 v[128:129], v[128:129], v[18:19]
    v_exp_f32 v128, v128
    v_exp_f32 v129, v129
    v_add_f32 v128, 1.0, v128
    v_add_f32 v129, 1.0, v129
    v_rcp_f32 v128, v128
    v_rcp_f32 v129, v129
    s_nop 0
    v_pk_mul_f32 v[18:19], v[18:19], v[128:129]
    v_cvt_pk_bf16_f32 v124, v16, v17
    v_cvt_pk_bf16_f32 v125, v18, v19
    v_lshlrev_b32 v16, 16, v124
    v_and_b32 v17, s51, v124
    v_lshlrev_b32 v18, 16, v125
    v_and_b32 v19, s51, v125
    v_pk_mul_f32 v[16:17], v[16:17], v[48:49]
    v_pk_mul_f32 v[18:19], v[18:19], v[50:51]
    v_cvt_pk_bf16_f32 v48, v16, v17
    v_cvt_pk_bf16_f32 v49, v18, v19
    buffer_store_dwordx2 v[48:49], v2, s[20:23], 0 offen offset:32
    v_cvt_pk_bf16_f32 v124, v20, v21
    v_cvt_pk_bf16_f32 v125, v22, v23
    v_cvt_pk_bf16_f32 v126, v52, v53
    v_cvt_pk_bf16_f32 v127, v54, v55
    v_lshlrev_b32 v20, 16, v124
    v_and_b32 v21, s51, v124
    v_lshlrev_b32 v22, 16, v125
    v_and_b32 v23, s51, v125
    v_lshlrev_b32 v52, 16, v126
    v_and_b32 v53, s51, v126
    v_lshlrev_b32 v54, 16, v127
    v_and_b32 v55, s51, v127
    v_pk_mul_f32 v[128:129], v[20:21], v[20:21]
    v_pk_fma_f32 v[128:129], v[128:129], s[54:55], v[130:131]
    v_pk_mul_f32 v[128:129], v[128:129], v[20:21]
    v_exp_f32 v128, v128
    v_exp_f32 v129, v129
    v_add_f32 v128, 1.0, v128
    v_add_f32 v129, 1.0, v129
    v_rcp_f32 v128, v128
    v_rcp_f32 v129, v129
    s_nop 0
    v_pk_mul_f32 v[20:21], v[20:21], v[128:129]
    v_pk_mul_f32 v[128:129], v[22:23], v[22:23]
    v_pk_fma_f32 v[128:129], v[128:129], s[54:55], v[130:131]
    v_pk_mul_f32 v[128:129], v[128:129], v[22:23]
    v_exp_f32 v128, v128
    v_exp_f32 v129, v129
    v_add_f32 v128, 1.0, v128
    v_add_f32 v129, 1.0, v129
    v_rcp_f32 v128, v128
    v_rcp_f32 v129, v129
    s_nop 0
    v_pk_mul_f32 v[22:23], v[22:23], v[128:129]
    v_cvt_pk_bf16_f32 v124, v20, v21
    v_cvt_pk_bf16_f32 v125, v22, v23
    v_lshlrev_b32 v20, 16, v124
    v_and_b32 v21, s51, v124
    v_lshlrev_b32 v22, 16, v125
    v_and_b32 v23, s51, v125
    v_pk_mul_f32 v[20:21], v[20:21], v[52:53]
    v_pk_mul_f32 v[22:23], v[22:23], v[54:55]
    v_cvt_pk_bf16_f32 v52, v20, v21
    v_cvt_pk_bf16_f32 v53, v22, v23
    buffer_store_dwordx2 v[52:53], v2, s[20:23], 0 offen offset:48
    v_cvt_pk_bf16_f32 v124, v24, v25
    v_cvt_pk_bf16_f32 v125, v26, v27
    v_cvt_pk_bf16_f32 v126, v56, v57
    v_cvt_pk_bf16_f32 v127, v58, v59
    v_lshlrev_b32 v24, 16, v124
    v_and_b32 v25, s51, v124
    v_lshlrev_b32 v26, 16, v125
    v_and_b32 v27, s51, v125
    v_lshlrev_b32 v56, 16, v126
    v_and_b32 v57, s51, v126
    v_lshlrev_b32 v58, 16, v127
    v_and_b32 v59, s51, v127
    v_pk_mul_f32 v[128:129], v[24:25], v[24:25]
    v_pk_fma_f32 v[128:129], v[128:129], s[54:55], v[130:131]
    v_pk_mul_f32 v[128:129], v[128:129], v[24:25]
    v_exp_f32 v128, v128
    v_exp_f32 v129, v129
    v_add_f32 v128, 1.0, v128
    v_add_f32 v129, 1.0, v129
    v_rcp_f32 v128, v128
    v_rcp_f32 v129, v129
    s_nop 0
    v_pk_mul_f32 v[24:25], v[24:25], v[128:129]
    v_pk_mul_f32 v[128:129], v[26:27], v[26:27]
    v_pk_fma_f32 v[128:129], v[128:129], s[54:55], v[130:131]
    v_pk_mul_f32 v[128:129], v[128:129], v[26:27]
    v_exp_f32 v128, v128
    v_exp_f32 v129, v129
    v_add_f32 v128, 1.0, v128
    v_add_f32 v129, 1.0, v129
    v_rcp_f32 v128, v128
    v_rcp_f32 v129, v129
    s_nop 0
    v_pk_mul_f32 v[26:27], v[26:27], v[128:129]
    v_cvt_pk_bf16_f32 v124, v24, v25
    v_cvt_pk_bf16_f32 v125, v26, v27
    v_lshlrev_b32 v24, 16, v124
    v_and_b32 v25, s51, v124
    v_lshlrev_b32 v26, 16, v125
    v_and_b32 v27, s51, v125
    v_pk_mul_f32 v[24:25], v[24:25], v[56:57]
    v_pk_mul_f32 v[26:27], v[26:27], v[58:59]
    v_cvt_pk_bf16_f32 v56, v24, v25
    v_cvt_pk_bf16_f32 v57, v26, v27
    buffer_store_dwordx2 v[56:57], v2, s[20:23], s52 offen offset:0
    v_cvt_pk_bf16_f32 v124, v28, v29
    v_cvt_pk_bf16_f32 v125, v30, v31
    v_cvt_pk_bf16_f32 v126, v60, v61
    v_cvt_pk_bf16_f32 v127, v62, v63
    v_lshlrev_b32 v28, 16, v124
    v_and_b32 v29, s51, v124
    v_lshlrev_b32 v30, 16, v125
    v_and_b32 v31, s51, v125
    v_lshlrev_b32 v60, 16, v126
    v_and_b32 v61, s51, v126
    v_lshlrev_b32 v62, 16, v127
    v_and_b32 v63, s51, v127
    v_pk_mul_f32 v[128:129], v[28:29], v[28:29]
    v_pk_fma_f32 v[128:129], v[128:129], s[54:55], v[130:131]
    v_pk_mul_f32 v[128:129], v[128:129], v[28:29]
    v_exp_f32 v128, v128
    v_exp_f32 v129, v129
    v_add_f32 v128, 1.0, v128
    v_add_f32 v129, 1.0, v129
    v_rcp_f32 v128, v128
    v_rcp_f32 v129, v129
    s_nop 0
    v_pk_mul_f32 v[28:29], v[28:29], v[128:129]
    v_pk_mul_f32 v[128:129], v[30:31], v[30:31]
    v_pk_fma_f32 v[128:129], v[128:129], s[54:55], v[130:131]
    v_pk_mul_f32 v[128:129], v[128:129], v[30:31]
    v_exp_f32 v128, v128
    v_exp_f32 v129, v129
    v_add_f32 v128, 1.0, v128
    v_add_f32 v129, 1.0, v129
    v_rcp_f32 v128, v128
    v_rcp_f32 v129, v129
    s_nop 0
    v_pk_mul_f32 v[30:31], v[30:31], v[128:129]
    v_cvt_pk_bf16_f32 v124, v28, v29
    v_cvt_pk_bf16_f32 v125, v30, v31
    v_lshlrev_b32 v28, 16, v124
    v_and_b32 v29, s51, v124
    v_lshlrev_b32 v30, 16, v125
    v_and_b32 v31, s51, v125
    v_pk_mul_f32 v[28:29], v[28:29], v[60:61]
    v_pk_mul_f32 v[30:31], v[30:31], v[62:63]
    v_cvt_pk_bf16_f32 v60, v28, v29
    v_cvt_pk_bf16_f32 v61, v30, v31
    buffer_store_dwordx2 v[60:61], v2, s[20:23], s52 offen offset:16
    v_cvt_pk_bf16_f32 v124, v32, v33
    v_cvt_pk_bf16_f32 v125, v34, v35
    v_cvt_pk_bf16_f32 v126, v64, v65
    v_cvt_pk_bf16_f32 v127, v66, v67
    v_lshlrev_b32 v32, 16, v124
    v_and_b32 v33, s51, v124
    v_lshlrev_b32 v34, 16, v125
    v_and_b32 v35, s51, v125
    v_lshlrev_b32 v64, 16, v126
    v_and_b32 v65, s51, v126
    v_lshlrev_b32 v66, 16, v127
    v_and_b32 v67, s51, v127
    v_pk_mul_f32 v[128:129], v[32:33], v[32:33]
    v_pk_fma_f32 v[128:129], v[128:129], s[54:55], v[130:131]
    v_pk_mul_f32 v[128:129], v[128:129], v[32:33]
    v_exp_f32 v128, v128
    v_exp_f32 v129, v129
    v_add_f32 v128, 1.0, v128
    v_add_f32 v129, 1.0, v129
    v_rcp_f32 v128, v128
    v_rcp_f32 v129, v129
    s_nop 0
    v_pk_mul_f32 v[32:33], v[32:33], v[128:129]
    v_pk_mul_f32 v[128:129], v[34:35], v[34:35]
    v_pk_fma_f32 v[128:129], v[128:129], s[54:55], v[130:131]
    v_pk_mul_f32 v[128:129], v[128:129], v[34:35]
    v_exp_f32 v128, v128
    v_exp_f32 v129, v129
    v_add_f32 v128, 1.0, v128
    v_add_f32 v129, 1.0, v129
    v_rcp_f32 v128, v128
    v_rcp_f32 v129, v129
    s_nop 0
    v_pk_mul_f32 v[34:35], v[34:35], v[128:129]
    v_cvt_pk_bf16_f32 v124, v32, v33
    v_cvt_pk_bf16_f32 v125, v34, v35
    v_lshlrev_b32 v32, 16, v124
    v_and_b32 v33, s51, v124
    v_lshlrev_b32 v34, 16, v125
    v_and_b32 v35, s51, v125
    v_pk_mul_f32 v[32:33], v[32:33], v[64:65]
    v_pk_mul_f32 v[34:35], v[34:35], v[66:67]
    v_cvt_pk_bf16_f32 v64, v32, v33
    v_cvt_pk_bf16_f32 v65, v34, v35
    buffer_store_dwordx2 v[64:65], v2, s[20:23], s52 offen offset:32
    v_cvt_pk_bf16_f32 v124, v36, v37
    v_cvt_pk_bf16_f32 v125, v38, v39
    v_cvt_pk_bf16_f32 v126, v68, v69
    v_cvt_pk_bf16_f32 v127, v70, v71
    v_lshlrev_b32 v36, 16, v124
    v_and_b32 v37, s51, v124
    v_lshlrev_b32 v38, 16, v125
    v_and_b32 v39, s51, v125
    v_lshlrev_b32 v68, 16, v126
    v_and_b32 v69, s51, v126
    v_lshlrev_b32 v70, 16, v127
    v_and_b32 v71, s51, v127
    v_pk_mul_f32 v[128:129], v[36:37], v[36:37]
    v_pk_fma_f32 v[128:129], v[128:129], s[54:55], v[130:131]
    v_pk_mul_f32 v[128:129], v[128:129], v[36:37]
    v_exp_f32 v128, v128
    v_exp_f32 v129, v129
    v_add_f32 v128, 1.0, v128
    v_add_f32 v129, 1.0, v129
    v_rcp_f32 v128, v128
    v_rcp_f32 v129, v129
    s_nop 0
    v_pk_mul_f32 v[36:37], v[36:37], v[128:129]
    v_pk_mul_f32 v[128:129], v[38:39], v[38:39]
    v_pk_fma_f32 v[128:129], v[128:129], s[54:55], v[130:131]
    v_pk_mul_f32 v[128:129], v[128:129], v[38:39]
    v_exp_f32 v128, v128
    v_exp_f32 v129, v129
    v_add_f32 v128, 1.0, v128
    v_add_f32 v129, 1.0, v129
    v_rcp_f32 v128, v128
    v_rcp_f32 v129, v129
    s_nop 0
    v_pk_mul_f32 v[38:39], v[38:39], v[128:129]
    v_cvt_pk_bf16_f32 v124, v36, v37
    v_cvt_pk_bf16_f32 v125, v38, v39
    v_lshlrev_b32 v36, 16, v124
    v_and_b32 v37, s51, v124
    v_lshlrev_b32 v38, 16, v125
    v_and_b32 v39, s51, v125
    v_pk_mul_f32 v[36:37], v[36:37], v[68:69]
    v_pk_mul_f32 v[38:39], v[38:39], v[70:71]
    v_cvt_pk_bf16_f32 v68, v36, v37
    v_cvt_pk_bf16_f32 v69, v38, v39
    buffer_store_dwordx2 v[68:69], v2, s[20:23], s52 offen offset:48
L_gu2_kernel_end:
    s_endpgm
.globl dn2_kernel
.p2align 8
.type dn2_kernel,@function
dn2_kernel:
    s_cmp_ge_u32 s2, 160
    s_cbranch_scc1 L_dn2_kernel_end
    s_load_dwordx2 s[4:5], s[0:1], 88
    s_load_dwordx2 s[6:7], s[0:1], 88
    s_load_dwordx2 s[40:41], s[0:1], 64
    s_load_dwordx2 s[44:45], s[0:1], 72
    s_and_b32 s28, s2, 7
    s_mul_i32 s28, s28, 20
    s_lshr_b32 s29, s2, 3
    s_add_u32 s28, s28, s29
    s_lshr_b32 s29, s28, 5
    s_and_b32 s28, s28, 31
    v_lshrrev_b32 v1, 6, v0
    v_and_b32 v5, 63, v0
    v_readfirstlane_b32 s39, v1
    v_and_b32 v6, 31, v0
    v_lshrrev_b32 v7, 5, v5
    s_waitcnt lgkmcnt(0)
    s_and_b32 s37, s39, 1
    s_lshr_b32 s38, s39, 1
    s_add_u32 s8, s4, 0xf68000
    s_addc_u32 s9, s5, 0
    s_mov_b32 s10, 0x6c0000
    s_mov_b32 s11, 0x20000
    s_mul_i32 s30, s28, 221184
    s_lshl_b32 s3, s29, 8
    s_add_u32 s12, s40, s3
    s_addc_u32 s13, s41, 0
    s_sub_u32 s14, 0x21c000, s3
    s_mov_b32 s15, 0x20000
    s_add_u32 s16, s12, 128
    s_addc_u32 s17, s13, 0
    s_sub_u32 s18, s14, 128
    s_mov_b32 s19, 0x20000
    s_mov_b32 s33, 1280
    s_lshl_b32 s32, s33, 6
    s_mov_b32 s31, 0
    s_mul_i32 s34, s39, 2048
    s_lshl_b32 s35, s39, 11
    s_add_u32 s35, s35, 8192
    v_lshrrev_b32 v1, 3, v5
    v_lshrrev_b32 v2, 4, v5
    v_and_b32 v3, 7, v5
    s_mul_i32 s3, s39, 16
    v_add_u32 v4, 0, v2
    v_and_b32 v4, 7, v4
    v_xor_b32 v4, v4, v3
    v_add_u32 v64, s3, v1
    v_mul_u32_u24 v64, 0xd80, v64
    v_lshl_add_u32 v64, v4, 4, v64
    v_add_u32 v4, 4, v2
    v_and_b32 v4, 7, v4
    v_xor_b32 v4, v4, v3
    v_add_u32 v65, s3, v1
    v_add_u32 v65, 8, v65
    v_mul_u32_u24 v65, 0xd80, v65
    v_lshl_add_u32 v65, v4, 4, v65
    v_subrev_u32 v65, 1024, v65
    v_and_b32 v4, 1, v2
    v_lshlrev_b32 v4, 2, v4
    v_xor_b32 v4, v4, v3
    s_lshl_b32 s3, s39, 4
    v_add_u32 v66, s3, v1
    v_mul_lo_u32 v66, v66, s33
    v_lshl_add_u32 v66, v4, 4, v66
    v_add_u32 v67, s3, v1
    v_add_u32 v67, 8, v67
    v_mul_lo_u32 v67, v67, s33
    v_lshl_add_u32 v67, v4, 4, v67
    v_subrev_u32 v67, 1024, v67
    s_mul_i32 s3, s38, 32
    v_add_u32 v1, s3, v6
    v_lshlrev_b32 v1, 7, v1
    v_bfe_u32 v2, v5, 1, 3
    v_add_u32 v3, 0, v7
    v_xor_b32 v3, v3, v2
    v_lshl_add_u32 v68, v3, 4, v1
    v_add_u32 v3, 2, v7
    v_xor_b32 v3, v3, v2
    v_lshl_add_u32 v69, v3, 4, v1
    v_add_u32 v3, 4, v7
    v_xor_b32 v3, v3, v2
    v_lshl_add_u32 v70, v3, 4, v1
    v_add_u32 v3, 6, v7
    v_xor_b32 v3, v3, v2
    v_lshl_add_u32 v71, v3, 4, v1
    v_lshrrev_b32 v1, 5, v5
    v_lshlrev_b32 v1, 3, v1
    v_bfe_u32 v2, v5, 2, 2
    v_add_u32 v1, v1, v2
    v_lshlrev_b32 v72, 7, v1
    v_bfe_u32 v1, v5, 4, 1
    v_lshlrev_b32 v1, 1, v1
    v_bfe_u32 v2, v5, 1, 1
    v_add_u32 v1, v1, v2
    s_lshl_b32 s3, s37, 2
    v_add_u32 v1, s3, v1
    v_bfe_u32 v2, v5, 3, 1
    v_lshlrev_b32 v2, 2, v2
    v_xor_b32 v1, v1, v2
    v_lshl_add_u32 v72, v1, 4, v72
    v_and_b32 v1, 1, v5
    v_lshl_add_u32 v72, v1, 3, v72
    v_add_u32 v72, 8192, v72
    s_mov_b32 s36, 0
    s_mov_b32 s58, 0
    s_add_u32 m0, s36, s34
    s_nop 0
    buffer_load_dwordx4 v64, s[8:11], s30 offen offset:0 lds
    buffer_load_dwordx4 v65, s[8:11], s30 offen offset:1024 lds
    s_add_u32 m0, s36, s35
    s_nop 0
    buffer_load_dwordx4 v66, s[12:15], s31 offen lds
    buffer_load_dwordx4 v67, s[12:15], s31 offen offset:1024 lds
    s_add_u32 m0, m0, 0x2000
    s_nop 0
    buffer_load_dwordx4 v66, s[16:19], s31 offen lds
    buffer_load_dwordx4 v67, s[16:19], s31 offen offset:1024 lds
    s_add_u32 s30, s30, 128
    s_add_u32 s31, s31, s32
    s_add_u32 s36, s36, 24576
    s_add_u32 s58, s58, 1
    s_cmp_eq_u32 s58, 5
    s_cselect_b32 s36, 0, s36
    s_cselect_b32 s58, 0, s58
    s_add_u32 m0, s36, s34
    s_nop 0
    buffer_load_dwordx4 v64, s[8:11], s30 offen offset:0 lds
    buffer_load_dwordx4 v65, s[8:11], s30 offen offset:1024 lds
    s_add_u32 m0, s36, s35
    s_nop 0
    buffer_load_dwordx4 v66, s[12:15], s31 offen lds
    buffer_load_dwordx4 v67, s[12:15], s31 offen offset:1024 lds
    s_add_u32 m0, m0, 0x2000
    s_nop 0
    buffer_load_dwordx4 v66, s[16:19], s31 offen lds
    buffer_load_dwordx4 v67, s[16:19], s31 offen offset:1024 lds
    s_add_u32 s30, s30, 128
    s_add_u32 s31, s31, s32
    s_add_u32 s36, s36, 24576
    s_add_u32 s58, s58, 1
    s_cmp_eq_u32 s58, 5
    s_cselect_b32 s36, 0, s36
    s_cselect_b32 s58, 0, s58
    s_add_u32 m0, s36, s34
    s_nop 0
    buffer_load_dwordx4 v64, s[8:11], s30 offen offset:0 lds
    buffer_load_dwordx4 v65, s[8:11], s30 offen offset:1024 lds
    s_add_u32 m0, s36, s35
    s_nop 0
    buffer_load_dwordx4 v66, s[12:15], s31 offen lds
    buffer_load_dwordx4 v67, s[12:15], s31 offen offset:1024 lds
    s_add_u32 m0, m0, 0x2000
    s_nop 0
    buffer_load_dwordx4 v66, s[16:19], s31 offen lds
    buffer_load_dwordx4 v67, s[16:19], s31 offen offset:1024 lds
    s_add_u32 s30, s30, 128
    s_add_u32 s31, s31, s32
    s_add_u32 s36, s36, 24576
    s_add_u32 s58, s58, 1
    s_cmp_eq_u32 s58, 5
    s_cselect_b32 s36, 0, s36
    s_cselect_b32 s58, 0, s58
    s_add_u32 m0, s36, s34
    s_nop 0
    buffer_load_dwordx4 v64, s[8:11], s30 offen offset:0 lds
    buffer_load_dwordx4 v65, s[8:11], s30 offen offset:1024 lds
    s_add_u32 m0, s36, s35
    s_nop 0
    buffer_load_dwordx4 v66, s[12:15], s31 offen lds
    buffer_load_dwordx4 v67, s[12:15], s31 offen offset:1024 lds
    s_add_u32 m0, m0, 0x2000
    s_nop 0
    buffer_load_dwordx4 v66, s[16:19], s31 offen lds
    buffer_load_dwordx4 v67, s[16:19], s31 offen offset:1024 lds
    s_add_u32 s30, s30, 128
    s_add_u32 s31, s31, s32
    s_add_u32 s36, s36, 24576
    s_add_u32 s58, s58, 1
    s_cmp_eq_u32 s58, 5
    s_cselect_b32 s36, 0, s36
    s_cselect_b32 s58, 0, s58
    s_mov_b32 s59, 0
    s_mov_b32 s60, 0xfffe8000
    s_mov_b32 s61, 24576
    s_mov_b32 s49, 0
    v_mov_b32 v8, 0
    v_mov_b32 v9, 0
    v_mov_b32 v10, 0
    v_mov_b32 v11, 0
    v_mov_b32 v12, 0
    v_mov_b32 v13, 0
    v_mov_b32 v14, 0
    v_mov_b32 v15, 0
    v_mov_b32 v16, 0
    v_mov_b32 v17, 0
    v_mov_b32 v18, 0
    v_mov_b32 v19, 0
    v_mov_b32 v20, 0
    v_mov_b32 v21, 0
    v_mov_b32 v22, 0
    v_mov_b32 v23, 0
    v_mov_b32 v24, 0
    v_mov_b32 v25, 0
    v_mov_b32 v26, 0
    v_mov_b32 v27, 0
    v_mov_b32 v28, 0
    v_mov_b32 v29, 0
    v_mov_b32 v30, 0
    v_mov_b32 v31, 0
    v_mov_b32 v32, 0
    v_mov_b32 v33, 0
    v_mov_b32 v34, 0
    v_mov_b32 v35, 0
    v_mov_b32 v36, 0
    v_mov_b32 v37, 0
    v_mov_b32 v38, 0
    v_mov_b32 v39, 0
L_dn2_kernel_loop:
    s_waitcnt vmcnt(18)
    s_barrier
    s_add_u32 m0, s36, s34
    s_nop 0
    buffer_load_dwordx4 v64, s[8:11], s30 offen offset:0 lds
    buffer_load_dwordx4 v65, s[8:11], s30 offen offset:1024 lds
    s_add_u32 m0, s36, s35
    s_nop 0
    buffer_load_dwordx4 v66, s[12:15], s31 offen lds
    buffer_load_dwordx4 v67, s[12:15], s31 offen offset:1024 lds
    s_add_u32 m0, m0, 0x2000
    s_nop 0
    buffer_load_dwordx4 v66, s[16:19], s31 offen lds
    buffer_load_dwordx4 v67, s[16:19], s31 offen offset:1024 lds
    s_add_u32 s30, s30, 128
    s_add_u32 s31, s31, s32
    s_add_u32 s36, s36, 24576
    s_add_u32 s58, s58, 1
    s_cmp_eq_u32 s58, 5
    s_cselect_b32 s36, 0, s36
    s_cselect_b32 s58, 0, s58
    ds_read_b128 v[48:51], v68 offset:0
    ds_read_b64_tr_b16 v[40:41], v72 offset:0
    ds_read_b64_tr_b16 v[42:43], v72 offset:512
    ds_read_b64_tr_b16 v[44:45], v72 offset:8192
    ds_read_b64_tr_b16 v[46:47], v72 offset:8704
    ds_read_b128 v[60:63], v69 offset:0
    ds_read_b64_tr_b16 v[52:53], v72 offset:2048
    ds_read_b64_tr_b16 v[54:55], v72 offset:2560
    ds_read_b64_tr_b16 v[56:57], v72 offset:10240
    ds_read_b64_tr_b16 v[58:59], v72 offset:10752
    s_waitcnt lgkmcnt(5)
    v_mfma_f32_32x32x16_bf16 v[8:23], v[40:43], v[48:51], v[8:23]
    v_mfma_f32_32x32x16_bf16 v[24:39], v[44:47], v[48:51], v[24:39]
    ds_read_b128 v[48:51], v70 offset:0
    ds_read_b64_tr_b16 v[40:41], v72 offset:4096
    ds_read_b64_tr_b16 v[42:43], v72 offset:4608
    ds_read_b64_tr_b16 v[44:45], v72 offset:12288
    ds_read_b64_tr_b16 v[46:47], v72 offset:12800
    s_waitcnt lgkmcnt(5)
    v_mfma_f32_32x32x16_bf16 v[8:23], v[52:55], v[60:63], v[8:23]
    v_mfma_f32_32x32x16_bf16 v[24:39], v[56:59], v[60:63], v[24:39]
    ds_read_b128 v[60:63], v71 offset:0
    ds_read_b64_tr_b16 v[52:53], v72 offset:6144
    ds_read_b64_tr_b16 v[54:55], v72 offset:6656
    ds_read_b64_tr_b16 v[56:57], v72 offset:14336
    ds_read_b64_tr_b16 v[58:59], v72 offset:14848
    s_waitcnt lgkmcnt(5)
    v_mfma_f32_32x32x16_bf16 v[8:23], v[40:43], v[48:51], v[8:23]
    v_mfma_f32_32x32x16_bf16 v[24:39], v[44:47], v[48:51], v[24:39]
    s_waitcnt lgkmcnt(0)
    v_mfma_f32_32x32x16_bf16 v[8:23], v[52:55], v[60:63], v[8:23]
    v_mfma_f32_32x32x16_bf16 v[24:39], v[56:59], v[60:63], v[24:39]
    s_add_u32 s59, s59, 1
    s_cmp_eq_u32 s59, 5
    s_cselect_b32 s48, s60, s61
    s_cselect_b32 s59, 0, s59
    v_add_u32 v68, s48, v68
    v_add_u32 v69, s48, v69
    v_add_u32 v70, s48, v70
    v_add_u32 v71, s48, v71
    v_add_u32 v72, s48, v72
    s_add_u32 s49, s49, 1
    s_cmp_lt_u32 s49, 27
    s_cbranch_scc1 L_dn2_kernel_loop
    s_waitcnt vmcnt(0)
    s_mul_i32 s3, s28, 64
    s_mul_i32 s50, s38, 32
    s_add_u32 s3, s3, s50
    v_add_u32 v1, s3, v6
    s_mov_b32 s51, 0xffff0000
    s_mov_b32 s20, s44
    s_mov_b32 s21, s45
    s_mov_b32 s22, 0x280000
    s_mov_b32 s23, 0x20000
    s_add_u32 s24, s6, 0xce8000
    s_addc_u32 s25, s7, 0
    s_mov_b32 s26, 0x280000
    s_mov_b32 s27, 0x20000
    v_mul_u32_u24 v2, 0x500, v1
    s_lshl_b32 s3, s29, 8
    s_lshl_b32 s50, s37, 6
    s_add_u32 s3, s3, s50
    v_add_u32 v2, s3, v2
    v_lshl_add_u32 v2, v7, 3, v2
    s_mov_b32 s52, 0xa000
    buffer_load_dwordx2 v[40:41], v2, s[24:27], 0 offen offset:0
    buffer_load_dwordx2 v[42:43], v2, s[24:27], 0 offen offset:16
    buffer_load_dwordx2 v[44:45], v2, s[24:27], 0 offen offset:32
    buffer_load_dwordx2 v[46:47], v2, s[24:27], 0 offen offset:48
    buffer_load_dwordx2 v[48:49], v2, s[24:27], 0 offen offset:128
    buffer_load_dwordx2 v[50:51], v2, s[24:27], 0 offen offset:144
    buffer_load_dwordx2 v[52:53], v2, s[24:27], 0 offen offset:160
    buffer_load_dwordx2 v[54:55], v2, s[24:27], 0 offen offset:176
    v_mov_b32 v80, 0x3f803f80
    v_mov_b32 v82, 0
    v_mov_b32 v83, 0
    v_cvt_pk_bf16_f32 v74, v8, v9
    v_cvt_pk_bf16_f32 v75, v10, v11
    v_lshlrev_b32 v8, 16, v74
    v_and_b32 v9, s51, v74
    v_lshlrev_b32 v10, 16, v75
    v_and_b32 v11, s51, v75
    s_waitcnt vmcnt(0)
    v_lshlrev_b32 v76, 16, v40
    v_and_b32 v77, s51, v40
    v_lshlrev_b32 v78, 16, v41
    v_and_b32 v79, s51, v41
    v_pk_add_f32 v[8:9], v[8:9], v[76:77]
    v_pk_add_f32 v[10:11], v[10:11], v[78:79]
    v_cvt_pk_bf16_f32 v40, v8, v9
    v_cvt_pk_bf16_f32 v41, v10, v11
    buffer_store_dwordx2 v[40:41], v2, s[20:23], 0 offen offset:0
    v_dot2c_f32_bf16 v82, v40, v80
    v_dot2c_f32_bf16 v83, v40, v40
    v_dot2c_f32_bf16 v82, v41, v80
    v_dot2c_f32_bf16 v83, v41, v41
    v_cvt_pk_bf16_f32 v74, v12, v13
    v_cvt_pk_bf16_f32 v75, v14, v15
    v_lshlrev_b32 v12, 16, v74
    v_and_b32 v13, s51, v74
    v_lshlrev_b32 v14, 16, v75
    v_and_b32 v15, s51, v75
    v_lshlrev_b32 v76, 16, v42
    v_and_b32 v77, s51, v42
    v_lshlrev_b32 v78, 16, v43
    v_and_b32 v79, s51, v43
    v_pk_add_f32 v[12:13], v[12:13], v[76:77]
    v_pk_add_f32 v[14:15], v[14:15], v[78:79]
    v_cvt_pk_bf16_f32 v42, v12, v13
    v_cvt_pk_bf16_f32 v43, v14, v15
    buffer_store_dwordx2 v[42:43], v2, s[20:23], 0 offen offset:16
    v_dot2c_f32_bf16 v82, v42, v80
    v_dot2c_f32_bf16 v83, v42, v42
    v_dot2c_f32_bf16 v82, v43, v80
    v_dot2c_f32_bf16 v83, v43, v43
    v_cvt_pk_bf16_f32 v74, v16, v17
    v_cvt_pk_bf16_f32 v75, v18, v19
    v_lshlrev_b32 v16, 16, v74
    v_and_b32 v17, s51, v74
    v_lshlrev_b32 v18, 16, v75
    v_and_b32 v19, s51, v75
    v_lshlrev_b32 v76, 16, v44
    v_and_b32 v77, s51, v44
    v_lshlrev_b32 v78, 16, v45
    v_and_b32 v79, s51, v45
    v_pk_add_f32 v[16:17], v[16:17], v[76:77]
    v_pk_add_f32 v[18:19], v[18:19], v[78:79]
    v_cvt_pk_bf16_f32 v44, v16, v17
    v_cvt_pk_bf16_f32 v45, v18, v19
    buffer_store_dwordx2 v[44:45], v2, s[20:23], 0 offen offset:32
    v_dot2c_f32_bf16 v82, v44, v80
    v_dot2c_f32_bf16 v83, v44, v44
    v_dot2c_f32_bf16 v82, v45, v80
    v_dot2c_f32_bf16 v83, v45, v45
    v_cvt_pk_bf16_f32 v74, v20, v21
    v_cvt_pk_bf16_f32 v75, v22, v23
    v_lshlrev_b32 v20, 16, v74
    v_and_b32 v21, s51, v74
    v_lshlrev_b32 v22, 16, v75
    v_and_b32 v23, s51, v75
    v_lshlrev_b32 v76, 16, v46
    v_and_b32 v77, s51, v46
    v_lshlrev_b32 v78, 16, v47
    v_and_b32 v79, s51, v47
    v_pk_add_f32 v[20:21], v[20:21], v[76:77]
    v_pk_add_f32 v[22:23], v[22:23], v[78:79]
    v_cvt_pk_bf16_f32 v46, v20, v21
    v_cvt_pk_bf16_f32 v47, v22, v23
    buffer_store_dwordx2 v[46:47], v2, s[20:23], 0 offen offset:48
    v_dot2c_f32_bf16 v82, v46, v80
    v_dot2c_f32_bf16 v83, v46, v46
    v_dot2c_f32_bf16 v82, v47, v80
    v_dot2c_f32_bf16 v83, v47, v47
    v_cvt_pk_bf16_f32 v74, v24, v25
    v_cvt_pk_bf16_f32 v75, v26, v27
    v_lshlrev_b32 v24, 16, v74
    v_and_b32 v25, s51, v74
    v_lshlrev_b32 v26, 16, v75
    v_and_b32 v27, s51, v75
    v_lshlrev_b32 v76, 16, v48
    v_and_b32 v77, s51, v48
    v_lshlrev_b32 v78, 16, v49
    v_and_b32 v79, s51, v49
    v_pk_add_f32 v[24:25], v[24:25], v[76:77]
    v_pk_add_f32 v[26:27], v[26:27], v[78:79]
    v_cvt_pk_bf16_f32 v48, v24, v25
    v_cvt_pk_bf16_f32 v49, v26, v27
    buffer_store_dwordx2 v[48:49], v2, s[20:23], 0 offen offset:128
    v_dot2c_f32_bf16 v82, v48, v80
    v_dot2c_f32_bf16 v83, v48, v48
    v_dot2c_f32_bf16 v82, v49, v80
    v_dot2c_f32_bf16 v83, v49, v49
    v_cvt_pk_bf16_f32 v74, v28, v29
    v_cvt_pk_bf16_f32 v75, v30, v31
    v_lshlrev_b32 v28, 16, v74
    v_and_b32 v29, s51, v74
    v_lshlrev_b32 v30, 16, v75
    v_and_b32 v31, s51, v75
    v_lshlrev_b32 v76, 16, v50
    v_and_b32 v77, s51, v50
    v_lshlrev_b32 v78, 16, v51
    v_and_b32 v79, s51, v51
    v_pk_add_f32 v[28:29], v[28:29], v[76:77]
    v_pk_add_f32 v[30:31], v[30:31], v[78:79]
    v_cvt_pk_bf16_f32 v50, v28, v29
    v_cvt_pk_bf16_f32 v51, v30, v31
    buffer_store_dwordx2 v[50:51], v2, s[20:23], 0 offen offset:144
    v_dot2c_f32_bf16 v82, v50, v80
    v_dot2c_f32_bf16 v83, v50, v50
    v_dot2c_f32_bf16 v82, v51, v80
    v_dot2c_f32_bf16 v83, v51, v51
    v_cvt_pk_bf16_f32 v74, v32, v33
    v_cvt_pk_bf16_f32 v75, v34, v35
    v_lshlrev_b32 v32, 16, v74
    v_and_b32 v33, s51, v74
    v_lshlrev_b32 v34, 16, v75
    v_and_b32 v35, s51, v75
    v_lshlrev_b32 v76, 16, v52
    v_and_b32 v77, s51, v52
    v_lshlrev_b32 v78, 16, v53
    v_and_b32 v79, s51, v53
    v_pk_add_f32 v[32:33], v[32:33], v[76:77]
    v_pk_add_f32 v[34:35], v[34:35], v[78:79]
    v_cvt_pk_bf16_f32 v52, v32, v33
    v_cvt_pk_bf16_f32 v53, v34, v35
    buffer_store_dwordx2 v[52:53], v2, s[20:23], 0 offen offset:160
    v_dot2c_f32_bf16 v82, v52, v80
    v_dot2c_f32_bf16 v83, v52, v52
    v_dot2c_f32_bf16 v82, v53, v80
    v_dot2c_f32_bf16 v83, v53, v53
    v_cvt_pk_bf16_f32 v74, v36, v37
    v_cvt_pk_bf16_f32 v75, v38, v39
    v_lshlrev_b32 v36, 16, v74
    v_and_b32 v37, s51, v74
    v_lshlrev_b32 v38, 16, v75
    v_and_b32 v39, s51, v75
    v_lshlrev_b32 v76, 16, v54
    v_and_b32 v77, s51, v54
    v_lshlrev_b32 v78, 16, v55
    v_and_b32 v79, s51, v55
    v_pk_add_f32 v[36:37], v[36:37], v[76:77]
    v_pk_add_f32 v[38:39], v[38:39], v[78:79]
    v_cvt_pk_bf16_f32 v54, v36, v37
    v_cvt_pk_bf16_f32 v55, v38, v39
    buffer_store_dwordx2 v[54:55], v2, s[20:23], 0 offen offset:176
    v_dot2c_f32_bf16 v82, v54, v80
    v_dot2c_f32_bf16 v83, v54, v54
    v_dot2c_f32_bf16 v82, v55, v80
    v_dot2c_f32_bf16 v83, v55, v55
L_dn2_kernel_end:
    s_endpgm
.section .rodata,"a"
.p2align 6
.amdhsa_kernel prep_kernel
  .amdhsa_next_free_vgpr 104
  .amdhsa_next_free_sgpr 46
  .amdhsa_accum_offset 104
  .amdhsa_group_segment_fixed_size 0
  .amdhsa_kernarg_size 96
  .amdhsa_user_sgpr_count 2
  .amdhsa_user_sgpr_kernarg_segment_ptr 1
  .amdhsa_system_sgpr_workgroup_id_x 1
  .amdhsa_float_denorm_mode_32 3
  .amdhsa_float_denorm_mode_16_64 3
.end_amdhsa_kernel
.p2align 6
.amdhsa_kernel qkv1_kernel
  .amdhsa_next_free_vgpr 116
  .amdhsa_next_free_sgpr 62
  .amdhsa_accum_offset 116
  .amdhsa_group_segment_fixed_size 0
  .amdhsa_kernarg_size 96
  .amdhsa_user_sgpr_count 2
  .amdhsa_user_sgpr_kernarg_segment_ptr 1
  .amdhsa_system_sgpr_workgroup_id_x 1
  .amdhsa_float_denorm_mode_32 3
  .amdhsa_float_denorm_mode_16_64 3
.end_amdhsa_kernel
.p2align 6
.amdhsa_kernel attn1_kernel
  .amdhsa_next_free_vgpr 114
  .amdhsa_next_free_sgpr 40
  .amdhsa_accum_offset 116
  .amdhsa_group_segment_fixed_size 0
  .amdhsa_kernarg_size 96
  .amdhsa_user_sgpr_count 2
  .amdhsa_user_sgpr_kernarg_segment_ptr 1
  .amdhsa_system_sgpr_workgroup_id_x 1
  .amdhsa_float_denorm_mode_32 3
  .amdhsa_float_denorm_mode_16_64 3
.end_amdhsa_kernel
.p2align 6
.amdhsa_kernel wo1_kernel
  .amdhsa_next_free_vgpr 84
  .amdhsa_next_free_sgpr 62
  .amdhsa_accum_offset 84
  .amdhsa_group_segment_fixed_size 0
  .amdhsa_kernarg_size 96
  .amdhsa_user_sgpr_count 2
  .amdhsa_user_sgpr_kernarg_segment_ptr 1
  .amdhsa_system_sgpr_workgroup_id_x 1
  .amdhsa_float_denorm_mode_32 3
  .amdhsa_float_denorm_mode_16_64 3
.end_amdhsa_kernel
.p2align 6
.amdhsa_kernel gu1_kernel
  .amdhsa_next_free_vgpr 132
  .amdhsa_next_free_sgpr 62
  .amdhsa_accum_offset 132
  .amdhsa_group_segment_fixed_size 0
  .amdhsa_kernarg_size 96
  .amdhsa_user_sgpr_count 2
  .amdhsa_user_sgpr_kernarg_segment_ptr 1
  .amdhsa_system_sgpr_workgroup_id_x 1
  .amdhsa_float_denorm_mode_32 3
  .amdhsa_float_denorm_mode_16_64 3
.end_amdhsa_kernel
.p2align 6
.amdhsa_kernel dn1_kernel
  .amdhsa_next_free_vgpr 84
  .amdhsa_next_free_sgpr 62
  .amdhsa_accum_offset 84
  .amdhsa_group_segment_fixed_size 0
  .amdhsa_kernarg_size 96
  .amdhsa_user_sgpr_count 2
  .amdhsa_user_sgpr_kernarg_segment_ptr 1
  .amdhsa_system_sgpr_workgroup_id_x 1
  .amdhsa_float_denorm_mode_32 3
  .amdhsa_float_denorm_mode_16_64 3
.end_amdhsa_kernel
.p2align 6
.amdhsa_kernel qkv2_kernel
  .amdhsa_next_free_vgpr 116
  .amdhsa_next_free_sgpr 62
  .amdhsa_accum_offset 116
  .amdhsa_group_segment_fixed_size 0
  .amdhsa_kernarg_size 96
  .amdhsa_user_sgpr_count 2
  .amdhsa_user_sgpr_kernarg_segment_ptr 1
  .amdhsa_system_sgpr_workgroup_id_x 1
  .amdhsa_float_denorm_mode_32 3
  .amdhsa_float_denorm_mode_16_64 3
.end_amdhsa_kernel
.p2align 6
.amdhsa_kernel attn2_kernel
  .amdhsa_next_free_vgpr 114
  .amdhsa_next_free_sgpr 40
  .amdhsa_accum_offset 116
  .amdhsa_group_segment_fixed_size 0
  .amdhsa_kernarg_size 96
  .amdhsa_user_sgpr_count 2
  .amdhsa_user_sgpr_kernarg_segment_ptr 1
  .amdhsa_system_sgpr_workgroup_id_x 1
  .amdhsa_float_denorm_mode_32 3
  .amdhsa_float_denorm_mode_16_64 3
.end_amdhsa_kernel
.p2align 6
.amdhsa_kernel wo2_kernel
  .amdhsa_next_free_vgpr 84
  .amdhsa_next_free_sgpr 62
  .amdhsa_accum_offset 84
  .amdhsa_group_segment_fixed_size 0
  .amdhsa_kernarg_size 96
  .amdhsa_user_sgpr_count 2
  .amdhsa_user_sgpr_kernarg_segment_ptr 1
  .amdhsa_system_sgpr_workgroup_id_x 1
  .amdhsa_float_denorm_mode_32 3
  .amdhsa_float_denorm_mode_16_64 3
.end_amdhsa_kernel
.p2align 6
.amdhsa_kernel gu2_kernel
  .amdhsa_next_free_vgpr 132
  .amdhsa_next_free_sgpr 62
  .amdhsa_accum_offset 132
  .amdhsa_group_segment_fixed_size 0
  .amdhsa_kernarg_size 96
  .amdhsa_user_sgpr_count 2
  .amdhsa_user_sgpr_kernarg_segment_ptr 1
  .amdhsa_system_sgpr_workgroup_id_x 1
  .amdhsa_float_denorm_mode_32 3
  .amdhsa_float_denorm_mode_16_64 3
.end_amdhsa_kernel
.p2align 6
.amdhsa_kernel dn2_kernel
  .amdhsa_next_free_vgpr 84
  .amdhsa_next_free_sgpr 62
  .amdhsa_accum_offset 84
  .amdhsa_group_segment_fixed_size 0
  .amdhsa_kernarg_size 96
  .amdhsa_user_sgpr_count 2
  .amdhsa_user_sgpr_kernarg_segment_ptr 1
  .amdhsa_system_sgpr_workgroup_id_x 1
  .amdhsa_float_denorm_mode_32 3
  .amdhsa_float_denorm_mode_16_64 3
.end_amdhsa_kernel
```
